```python
import torch

def _softmax(x, axis=-1):
    return torch.softmax(x, dim=axis)
def _gelu(x):
    return torch.nn.functional.gelu(x, approximate="tanh")
def _silu(x):
    return torch.nn.functional.silu(x)
def _sigmoid(x):
    return torch.sigmoid(x)
def _layernorm(x, axis=-1, eps=1e-5):
    m = x.mean(dim=axis, keepdim=True)
    v = x.var(dim=axis, keepdim=True, unbiased=False)
    return (x - m) / torch.sqrt(v + eps)
def _scatter_add(tgt, idx, src, axis=0):
    return tgt.clone().index_add_(axis, idx, src)
def _segment_sum(src, seg, n):
    out = torch.zeros((n,) + src.shape[1:], dtype=src.dtype)
    return out.index_add_(0, seg, src)
def _pad(x, pw):
    flat = tuple(v for pair in reversed(pw) for v in pair)
    return torch.nn.functional.pad(x, flat)

kernel_name = 'recurrent_scan__spectral_fnet__glu_gated_geglu__prompt'

def setup_inputs():

    _w = (lambda a: (lambda t: t.to(torch.bfloat16) if t.is_floating_point() else t)(torch.as_tensor(a)))
    def _A_setup():
        B, S, D = 1, 2048, 640
        ns = torch.arange(S)[:, None] * torch.arange(S)[None, :]
        nd = torch.arange(D)[:, None] * torch.arange(D)[None, :]
        Ws_re = torch.cos(-2.0 * torch.pi * ns / S).to(float)
        Ws_im = torch.sin(-2.0 * torch.pi * ns / S).to(float)
        Wd_re = torch.cos(-2.0 * torch.pi * nd / D).to(float)
        Wd_im = torch.sin(-2.0 * torch.pi * nd / D).to(float)
        return {
            "x": _w((lambda *s: torch.randn(*s, dtype=torch.bfloat16) * 0.05)(B, S, D)),
            "dft_seq_re": _w(Ws_re),
            "dft_seq_im": _w(Ws_im),
            "dft_hid_re": _w(Wd_re),
            "dft_hid_im": _w(Wd_im),
        }
    _A_in = _A_setup()

    def _B_setup():
        B, S, Dm, Df = 1, 2048, 640, 1536
        return {
            "x": _w((lambda *s: torch.randn(*s, dtype=torch.bfloat16) * 0.05)(B, S, Dm)),
            "w_gate": _w((lambda *s: torch.randn(*s, dtype=torch.bfloat16) * 0.05)(Dm, Df) * (Dm ** -0.5)),
            "w_up": _w((lambda *s: torch.randn(*s, dtype=torch.bfloat16) * 0.05)(Dm, Df) * (Dm ** -0.5)),
            "w_down": _w((lambda *s: torch.randn(*s, dtype=torch.bfloat16) * 0.05)(Df, Dm) * (Df ** -0.5)),
        }
    _B_in = _B_setup()

    return {
        "A_x": _A_in["x"],
        "A_dft_seq_re": _A_in["dft_seq_re"],
        "A_dft_seq_im": _A_in["dft_seq_im"],
        "A_dft_hid_re": _A_in["dft_hid_re"],
        "A_dft_hid_im": _A_in["dft_hid_im"],
        "B_x": _B_in["x"],
        "B_w_gate": _B_in["w_gate"],
        "B_w_up": _B_in["w_up"],
        "B_w_down": _B_in["w_down"],
    }

def reference(A_x, A_dft_seq_re, A_dft_seq_im, A_dft_hid_re, A_dft_hid_im, B_x, B_w_gate, B_w_up, B_w_down):
    def _A_ref(x, dft_seq_re, dft_seq_im, dft_hid_re, dft_hid_im):
        a = torch.einsum("bsd,ed->bse", x, dft_hid_re)
        b = torch.einsum("bsd,ed->bse", x, dft_hid_im)
        y = torch.einsum("ts,bse->bte", dft_seq_re, a) - torch.einsum("ts,bse->bte", dft_seq_im, b)
        return y

    def _B_ref(x, w_gate, w_up, w_down):
        g = torch.einsum("bsd,df->bsf", x, w_gate)
        u = torch.einsum("bsd,df->bsf", x, w_up)
        h = _gelu(g) * u
        return torch.einsum("bsf,fd->bsd", h, w_down)

    x = A_x
    xn = _layernorm(x, axis=-1)
    s = _A_ref(xn, A_dft_seq_re, A_dft_seq_im, A_dft_hid_re, A_dft_hid_im)
    g = _silu(_B_ref(xn, B_w_gate, B_w_up, B_w_down))
    return x + s * g
```

```asm
; @launch grid=(256,1,1) block=(512,1,1) lds=163840
.amdgcn_target "amdgcn-amd-amdhsa--gfx950"
.text
.globl recurrent_scan__spectral_fnet__glu_gated_geglu__prompt_kernel
.p2align 8
.type recurrent_scan__spectral_fnet__glu_gated_geglu__prompt_kernel,@function
recurrent_scan__spectral_fnet__glu_gated_geglu__prompt_kernel:

    s_cmp_ge_u32 s2, 256
    s_cbranch_scc1 .f_done
    s_load_dwordx8 s[4:11], s[0:1], 0
    s_load_dwordx2 s[12:13], s[0:1], 32
    s_load_dwordx4 s[16:19], s[0:1], 48
    s_load_dwordx8 s[20:27], s[0:1], 64
    v_lshrrev_b32 v2, 6, v0
    v_and_b32 v1, 63, v0
    s_bfe_u32 s33, s2, 0x30003
    v_readfirstlane_b32 s28, v2
    s_lshr_b32 s32, s2, 6
    s_bfe_u32 s31, s2, 0x20001
    s_and_b32 s29, s2, 1
    s_lshl_b32 s29, s29, 3
    s_add_u32 s29, s29, s33
    s_lshl_b32 s30, s31, 2
    s_add_u32 s30, s30, s32
    s_cmp_lt_u32 s28, 4
    s_cbranch_scc1 .f_cons
    s_sub_u32 s34, s28, 4
    s_memrealtime s[74:75]
    s_mul_i32 s40, s33, 4
    s_mul_i32 s41, s32, 4
    s_lshr_b32 s40, s40, 2
    s_lshr_b32 s41, s41, 2
    s_add_u32 s40, s40, s41
    s_cmp_ge_u32 s40, 10
    s_cselect_b32 s41, 10, 0
    s_sub_u32 s40, s40, s41
    s_cmp_ge_u32 s40, 10
    s_cselect_b32 s41, 10, 0
    s_sub_u32 s40, s40, s41
    s_lshl_b32 s43, s40, 7
    s_lshr_b32 s41, s34, 1
    s_lshl_b32 s41, s41, 7
    s_add_u32 s42, s43, s41
    s_cmp_eq_u32 s42, 1280
    s_cselect_b32 s42, 0, s42
    v_lshrrev_b32 v3, 3, v1
    v_and_b32 v2, 7, v1
    v_xor_b32 v4, v2, v3
    v_lshlrev_b32 v4, 4, v4
    v_mul_u32_u24 v5, 1280, v3
    v_add_u32 v5, v5, v4
    v_add_u32 v6, 9216, v5
    v_add_u32 v7, 18432, v5
    v_add_u32 v8, 27648, v5
    v_add_u32 v9, 40960, v5
    s_lshl_b32 s68, s34, 12
    s_mul_i32 s79, s34, 5120
    s_lshl_b32 s70, s29, 2
    s_add_u32 s70, s70, s34
    s_mul_i32 s70, s70, 40960
    s_and_b32 s71, s30, 7
    s_lshl_b32 s71, s71, 1
    s_and_b32 s72, s34, 1
    s_add_u32 s71, s71, s72
    s_mul_i32 s71, s71, 51200
    s_waitcnt lgkmcnt(0)
    s_add_u32 s80, s4, s70
    s_addc_u32 s81, s5, 0
    s_and_b32 s81, s81, 0xffff
    s_mov_b32 s82, 40960
    s_mov_b32 s83, 0x20000
    s_cmp_lt_u32 s30, 8
    s_cselect_b32 s84, s10, s12
    s_cselect_b32 s85, s11, s13
    s_add_u32 s84, s84, s71
    s_addc_u32 s85, s85, 0
    s_and_b32 s85, s85, 0xffff
    s_mov_b32 s86, 51200
    s_mov_b32 s87, 0x20000
    s_add_u32 m0, s68, 0
    s_nop 0
    buffer_load_dwordx4 v5, s[80:83], s43 offen offset:0 lds
    buffer_load_dwordx4 v6, s[80:83], s43 offen offset:1024 lds
    buffer_load_dwordx4 v7, s[80:83], s43 offen offset:2048 lds
    buffer_load_dwordx4 v8, s[80:83], s43 offen offset:3072 lds
    s_add_u32 s43, s43, 128
    s_cmp_eq_u32 s43, 1280
    s_cselect_b32 s43, 0, s43
    s_add_u32 m0, s79, 106496
    s_nop 0
    buffer_load_dwordx4 v5, s[84:87], s42 offen offset:0 lds
    buffer_load_dwordx4 v6, s[84:87], s42 offen offset:1024 lds
    buffer_load_dwordx4 v7, s[84:87], s42 offen offset:2048 lds
    s_add_u32 m0, s79, 106496
    s_nop 0
    buffer_load_dwordx4 v8, s[84:87], s42 offen offset:3072 lds
    s_add_u32 m0, s79, 110592
    s_nop 0
    buffer_load_dwordx4 v9, s[84:87], s42 offen offset:0 lds
    s_add_u32 s42, s42, 256
    s_cmp_ge_u32 s42, 1280
    s_cselect_b32 s70, 1280, 0
    s_sub_u32 s42, s42, s70
    s_add_u32 m0, s68, 16384
    s_nop 0
    buffer_load_dwordx4 v5, s[80:83], s43 offen offset:0 lds
    buffer_load_dwordx4 v6, s[80:83], s43 offen offset:1024 lds
    buffer_load_dwordx4 v7, s[80:83], s43 offen offset:2048 lds
    buffer_load_dwordx4 v8, s[80:83], s43 offen offset:3072 lds
    s_add_u32 s43, s43, 128
    s_cmp_eq_u32 s43, 1280
    s_cselect_b32 s43, 0, s43
    s_mov_b32 s36, s24
    s_and_b32 s37, s25, 0xffff
    s_mov_b32 s38, 4
    s_mov_b32 s39, 0x20000
    s_lshl_b32 s70, s2, 3
    s_add_u32 s70, s70, s28
    s_cmp_lg_u32 s70, 7
    s_cbranch_scc1 .h_n1
    s_mul_i32 s74, s74, 0x9e3779b1
    s_and_b32 s74, s74, 0x9fff9fff
    s_or_b32 s74, s74, 0x40004000
    v_mov_b32 v55, s74
    buffer_store_dword v55, off, s[36:39], 0 sc1
.h_n1:
    s_mov_b64 s[50:51], s[36:37]
    s_add_u32 s40, s40, 5
    s_cmp_ge_u32 s40, 10
    s_cselect_b32 s41, 10, 0
    s_sub_u32 s40, s40, s41
    s_mul_i32 s49, s40, 196608
    s_mul_i32 s70, s30, 192
    s_sub_u32 s71, 1966080, s70
    s_bitcmp0_b32 s34, 0
    s_cselect_b32 s12, s16, s18
    s_cselect_b32 s13, s17, s19
    s_add_u32 s12, s12, s70
    s_addc_u32 s13, s13, 0
    s_and_b32 s13, s13, 0xffff
    s_mov_b32 s14, s71
    s_mov_b32 s15, 0x20000
    s_lshr_b32 s70, s34, 1
    s_mul_i32 s71, s70, 98304
    v_add_u32 v54, 0, v1
    v_mul_u32_u24 v55, 43691, v54
    v_lshrrev_b32 v55, 19, v55
    v_mul_u32_u24 v56, 12, v55
    v_sub_u32 v56, v54, v56
    v_bfe_u32 v54, v55, 3, 1
    v_lshlrev_b32 v54, 1, v54
    v_xor_b32 v56, v56, v54
    v_mul_u32_u24 v55, 3072, v55
    v_lshl_add_u32 v13, v56, 4, v55
    v_add_u32 v13, s71, v13
    v_add_u32 v16, 49152, v13
    s_sub_u32 s71, s71, 1024
    v_add_u32 v54, 64, v1
    v_mul_u32_u24 v55, 43691, v54
    v_lshrrev_b32 v55, 19, v55
    v_mul_u32_u24 v56, 12, v55
    v_sub_u32 v56, v54, v56
    v_bfe_u32 v54, v55, 3, 1
    v_lshlrev_b32 v54, 1, v54
    v_xor_b32 v56, v56, v54
    v_mul_u32_u24 v55, 3072, v55
    v_lshl_add_u32 v14, v56, 4, v55
    v_add_u32 v14, s71, v14
    v_add_u32 v17, 49152, v14
    s_sub_u32 s71, s71, 1024
    v_add_u32 v54, 128, v1
    v_mul_u32_u24 v55, 43691, v54
    v_lshrrev_b32 v55, 19, v55
    v_mul_u32_u24 v56, 12, v55
    v_sub_u32 v56, v54, v56
    v_bfe_u32 v54, v55, 3, 1
    v_lshlrev_b32 v54, 1, v54
    v_xor_b32 v56, v56, v54
    v_mul_u32_u24 v55, 3072, v55
    v_lshl_add_u32 v15, v56, 4, v55
    v_add_u32 v15, s71, v15
    v_add_u32 v18, 49152, v15
    s_sub_u32 s71, s71, 1024
    s_mul_i32 s69, s70, 6144
    s_and_b32 s71, s34, 1
    s_mul_i32 s71, s71, 12288
    s_add_u32 s69, s69, s71
    s_lshl_b32 s70, s34, 1
    s_xor_b32 s70, s70, s31
    s_lshl_b32 s70, s70, 16
    v_lshlrev_b32 v20, 12, v3
    v_add3_u32 v20, v20, v4, s70
    v_xor_b32 v22, 0x10000, v20
    v_add_u32 v21, 31744, v20
    v_add_u32 v23, 31744, v22
    s_lshl_b32 s70, s34, 12
    s_xor_b32 s71, s31, 0
    s_lshl_b32 s71, s71, 10
    s_add_u32 s71, s71, 4096
    s_add_u32 s71, s71, s70
    v_lshl_add_u32 v32, v1, 4, s71
    s_xor_b32 s71, s31, 1
    s_lshl_b32 s71, s71, 10
    s_add_u32 s71, s71, 3072
    s_add_u32 s71, s71, s70
    v_lshl_add_u32 v33, v1, 4, s71
    s_xor_b32 s71, s31, 2
    s_lshl_b32 s71, s71, 10
    s_add_u32 s71, s71, 2048
    s_add_u32 s71, s71, s70
    v_lshl_add_u32 v34, v1, 4, s71
    s_xor_b32 s71, s31, 3
    s_lshl_b32 s71, s71, 10
    s_add_u32 s71, s71, 1024
    s_add_u32 s71, s71, s70
    v_lshl_add_u32 v35, v1, 4, s71
    s_mov_b32 s36, s70
    s_add_u32 s38, s70, 81920
    s_mul_i32 s70, s34, 5120
    v_lshl_add_u32 v25, v1, 4, s70
    v_add_u32 v26, 4096, v25
    s_add_u32 s37, s70, 81920
    s_add_u32 s39, s70, 163840
    s_mul_i32 s70, s34, 20480
    v_add_u32 v54, 0, v1
    v_mul_u32_u24 v55, 52429, v54
    v_lshrrev_b32 v55, 20, v55
    v_mul_u32_u24 v56, 20, v55
    v_sub_u32 v56, v54, v56
    v_bfe_u32 v54, v55, 3, 1
    v_lshlrev_b32 v54, 1, v54
    v_xor_b32 v56, v56, v54
    v_mul_u32_u24 v55, 1280, v55
    v_lshl_add_u32 v27, v56, 4, v55
    v_add_u32 v27, s70, v27
    v_add_u32 v54, 64, v1
    v_mul_u32_u24 v55, 52429, v54
    v_lshrrev_b32 v55, 20, v55
    v_mul_u32_u24 v56, 20, v55
    v_sub_u32 v56, v54, v56
    v_bfe_u32 v54, v55, 3, 1
    v_lshlrev_b32 v54, 1, v54
    v_xor_b32 v56, v56, v54
    v_mul_u32_u24 v55, 1280, v55
    v_lshl_add_u32 v28, v56, 4, v55
    v_add_u32 v28, s70, v28
    v_subrev_u32 v28, 1024, v28
    v_add_u32 v54, 128, v1
    v_mul_u32_u24 v55, 52429, v54
    v_lshrrev_b32 v55, 20, v55
    v_mul_u32_u24 v56, 20, v55
    v_sub_u32 v56, v54, v56
    v_bfe_u32 v54, v55, 3, 1
    v_lshlrev_b32 v54, 1, v54
    v_xor_b32 v56, v56, v54
    v_mul_u32_u24 v55, 1280, v55
    v_lshl_add_u32 v29, v56, 4, v55
    v_add_u32 v29, s70, v29
    v_subrev_u32 v29, 2048, v29
    v_add_u32 v54, 192, v1
    v_mul_u32_u24 v55, 52429, v54
    v_lshrrev_b32 v55, 20, v55
    v_mul_u32_u24 v56, 20, v55
    v_sub_u32 v56, v54, v56
    v_bfe_u32 v54, v55, 3, 1
    v_lshlrev_b32 v54, 1, v54
    v_xor_b32 v56, v56, v54
    v_mul_u32_u24 v55, 1280, v55
    v_lshl_add_u32 v30, v56, 4, v55
    v_add_u32 v30, s70, v30
    v_subrev_u32 v30, 3072, v30
    v_add_u32 v54, 256, v1
    v_mul_u32_u24 v55, 52429, v54
    v_lshrrev_b32 v55, 20, v55
    v_mul_u32_u24 v56, 20, v55
    v_sub_u32 v56, v54, v56
    v_bfe_u32 v54, v55, 3, 1
    v_lshlrev_b32 v54, 1, v54
    v_xor_b32 v56, v56, v54
    v_mul_u32_u24 v55, 1280, v55
    v_lshl_add_u32 v31, v56, 4, v55
    v_add_u32 v31, s70, v31
    s_lshl_b32 s70, s29, 19
    s_add_u32 s44, s6, s70
    s_addc_u32 s45, s7, 0
    s_and_b32 s45, s45, 0xffff
    s_add_u32 s46, s8, s70
    s_addc_u32 s47, s9, 0
    s_and_b32 s47, s47, 0xffff
    s_mov_b32 s64, s44
    s_mov_b32 s65, s45
    s_mov_b32 s66, 0x80000
    s_mov_b32 s67, 0x20000
    s_mul_i32 s70, s29, 393216
    s_add_u32 s70, s70, 6287360
    s_add_u32 s52, s26, s70
    s_addc_u32 s53, s27, 0
    s_and_b32 s53, s53, 0xffff
    s_mov_b32 s54, 397312
    s_mov_b32 s55, 0x20000
    s_mul_i32 s70, s32, 655360
    s_add_u32 s70, s70, 0
    s_add_u32 s56, s26, s70
    s_addc_u32 s57, s27, 0
    s_and_b32 s57, s57, 0xffff
    s_mov_b32 s58, 3276800
    s_mov_b32 s59, 0x20000
    s_mul_i32 s70, s32, 320
    s_add_u32 s60, s20, s70
    s_addc_u32 s61, s21, 0
    s_sub_u32 s48, 1966080, s70
    s_and_b32 s61, s61, 0xffff
    s_mov_b32 s62, s48
    s_mov_b32 s63, 0x20000
    s_mov_b32 s70, 1050624
    s_cmp_eq_u32 s31, 1
    s_cselect_b32 s70, 2564119, s70
    s_cmp_eq_u32 s31, 2
    s_cselect_b32 s70, 4603950, s70
    s_cmp_eq_u32 s31, 3
    s_cselect_b32 s70, 5393463, s70
    s_mov_b32 s71, 460808
    s_cmp_eq_u32 s31, 1
    s_cselect_b32 s71, 460553, s71
    s_cmp_eq_u32 s31, 2
    s_cselect_b32 s71, 394761, s71
    s_cmp_eq_u32 s31, 3
    s_cselect_b32 s71, 394761, s71
    s_mul_i32 s72, s33, 1
    s_mul_i32 s73, s32, 2
    s_add_u32 s72, s72, s73
    s_and_b32 s72, s72, 7
    v_mov_b32 v52, 127
    v_mov_b32 v53, v1
    s_bfe_u32 s73, s70, 524288
    s_bfe_u32 s74, s71, 524288
    s_mul_i32 s75, s74, s72
    s_lshr_b32 s75, s75, 3
    v_add_u32 v54, s75, v53
    v_subrev_u32 v55, s74, v54
    v_min_u32 v54, v54, v55
    v_add_u32 v54, s73, v54
    v_cmp_gt_u32 vcc, s74, v53
    v_cndmask_b32 v52, v52, v54, vcc
    v_subrev_u32 v53, s74, v53
    s_bfe_u32 s73, s70, 524296
    s_bfe_u32 s74, s71, 524296
    s_mul_i32 s75, s74, s72
    s_lshr_b32 s75, s75, 3
    v_add_u32 v54, s75, v53
    v_subrev_u32 v55, s74, v54
    v_min_u32 v54, v54, v55
    v_add_u32 v54, s73, v54
    v_cmp_gt_u32 vcc, s74, v53
    v_cndmask_b32 v52, v52, v54, vcc
    v_subrev_u32 v53, s74, v53
    s_bfe_u32 s73, s70, 524304
    s_bfe_u32 s74, s71, 524304
    s_mul_i32 s75, s74, s72
    s_lshr_b32 s75, s75, 3
    v_add_u32 v54, s75, v53
    v_subrev_u32 v55, s74, v54
    v_min_u32 v54, v54, v55
    v_add_u32 v54, s73, v54
    v_cmp_gt_u32 vcc, s74, v53
    v_cndmask_b32 v52, v52, v54, vcc
    v_subrev_u32 v53, s74, v53
    s_mov_b32 s76, 0
    s_mov_b32 s77, 0
    s_waitcnt vmcnt(4)
    s_waitcnt lgkmcnt(0)
    s_barrier
    s_add_u32 m0, s68, 32768
    s_nop 0
    buffer_load_dwordx4 v5, s[80:83], s43 offen offset:0 lds
    buffer_load_dwordx4 v6, s[80:83], s43 offen offset:1024 lds
    buffer_load_dwordx4 v7, s[80:83], s43 offen offset:2048 lds
    buffer_load_dwordx4 v8, s[80:83], s43 offen offset:3072 lds
    s_add_u32 s43, s43, 128
    s_cmp_eq_u32 s43, 1280
    s_cselect_b32 s43, 0, s43
    s_add_u32 m0, s79, 81920
    s_nop 0
    buffer_load_dwordx4 v5, s[84:87], s42 offen offset:0 lds
    buffer_load_dwordx4 v6, s[84:87], s42 offen offset:1024 lds
    buffer_load_dwordx4 v7, s[84:87], s42 offen offset:2048 lds
    s_waitcnt vmcnt(7)
    s_waitcnt lgkmcnt(0)
    s_barrier
    s_add_u32 m0, s79, 81920
    s_nop 0
    buffer_load_dwordx4 v8, s[84:87], s42 offen offset:3072 lds
    s_add_u32 m0, s79, 86016
    s_nop 0
    buffer_load_dwordx4 v9, s[84:87], s42 offen offset:0 lds
    s_add_u32 s42, s42, 256
    s_cmp_ge_u32 s42, 1280
    s_cselect_b32 s70, 1280, 0
    s_sub_u32 s42, s42, s70
    s_add_u32 m0, s68, 49152
    s_nop 0
    buffer_load_dwordx4 v5, s[80:83], s43 offen offset:0 lds
    buffer_load_dwordx4 v6, s[80:83], s43 offen offset:1024 lds
    buffer_load_dwordx4 v7, s[80:83], s43 offen offset:2048 lds
    buffer_load_dwordx4 v8, s[80:83], s43 offen offset:3072 lds
    s_add_u32 s43, s43, 128
    s_cmp_eq_u32 s43, 1280
    s_cselect_b32 s43, 0, s43
    s_waitcnt vmcnt(4)
    s_waitcnt lgkmcnt(0)
    s_barrier
    s_add_u32 m0, s68, 65536
    s_nop 0
    buffer_load_dwordx4 v5, s[80:83], s43 offen offset:0 lds
    buffer_load_dwordx4 v6, s[80:83], s43 offen offset:1024 lds
    buffer_load_dwordx4 v7, s[80:83], s43 offen offset:2048 lds
    buffer_load_dwordx4 v8, s[80:83], s43 offen offset:3072 lds
    s_add_u32 s43, s43, 128
    s_cmp_eq_u32 s43, 1280
    s_cselect_b32 s43, 0, s43
    s_add_u32 m0, s79, 131072
    s_nop 0
    buffer_load_dwordx4 v5, s[84:87], s42 offen offset:0 lds
    buffer_load_dwordx4 v6, s[84:87], s42 offen offset:1024 lds
    buffer_load_dwordx4 v7, s[84:87], s42 offen offset:2048 lds
    s_add_u32 m0, s79, 131072
    s_nop 0
    buffer_load_dwordx4 v8, s[84:87], s42 offen offset:3072 lds
    s_add_u32 m0, s79, 135168
    s_nop 0
    buffer_load_dwordx4 v9, s[84:87], s42 offen offset:0 lds
    s_add_u32 s42, s42, 256
    s_cmp_ge_u32 s42, 1280
    s_cselect_b32 s70, 1280, 0
    s_sub_u32 s42, s42, s70
    s_add_u32 m0, s68, 0
    s_nop 0
    buffer_load_dwordx4 v5, s[80:83], s43 offen offset:0 lds
    buffer_load_dwordx4 v6, s[80:83], s43 offen offset:1024 lds
    buffer_load_dwordx4 v7, s[80:83], s43 offen offset:2048 lds
    buffer_load_dwordx4 v8, s[80:83], s43 offen offset:3072 lds
    s_add_u32 s43, s43, 128
    s_cmp_eq_u32 s43, 1280
    s_cselect_b32 s43, 0, s43
    s_waitcnt vmcnt(13)
    s_waitcnt lgkmcnt(0)
    s_barrier
    s_add_u32 m0, s68, 16384
    s_nop 0
    buffer_load_dwordx4 v5, s[80:83], s43 offen offset:0 lds
    buffer_load_dwordx4 v6, s[80:83], s43 offen offset:1024 lds
    buffer_load_dwordx4 v7, s[80:83], s43 offen offset:2048 lds
    buffer_load_dwordx4 v8, s[80:83], s43 offen offset:3072 lds
    s_add_u32 s43, s43, 128
    s_cmp_eq_u32 s43, 1280
    s_cselect_b32 s43, 0, s43
    s_add_u32 m0, s79, 106496
    s_nop 0
    buffer_load_dwordx4 v5, s[84:87], s42 offen offset:0 lds
    buffer_load_dwordx4 v6, s[84:87], s42 offen offset:1024 lds
    buffer_load_dwordx4 v7, s[84:87], s42 offen offset:2048 lds
    s_waitcnt vmcnt(11)
    s_waitcnt lgkmcnt(0)
    s_barrier
    s_add_u32 m0, s79, 106496
    s_nop 0
    buffer_load_dwordx4 v8, s[84:87], s42 offen offset:3072 lds
    s_add_u32 m0, s79, 110592
    s_nop 0
    buffer_load_dwordx4 v9, s[84:87], s42 offen offset:0 lds
    s_add_u32 s42, s42, 256
    s_cmp_ge_u32 s42, 1280
    s_cselect_b32 s70, 1280, 0
    s_sub_u32 s42, s42, s70
    s_add_u32 m0, s68, 32768
    s_nop 0
    buffer_load_dwordx4 v5, s[80:83], s43 offen offset:0 lds
    buffer_load_dwordx4 v6, s[80:83], s43 offen offset:1024 lds
    buffer_load_dwordx4 v7, s[80:83], s43 offen offset:2048 lds
    buffer_load_dwordx4 v8, s[80:83], s43 offen offset:3072 lds
    s_add_u32 s43, s43, 128
    s_cmp_eq_u32 s43, 1280
    s_cselect_b32 s43, 0, s43
    s_waitcnt vmcnt(13)
    s_waitcnt lgkmcnt(0)
    s_barrier
    s_add_u32 m0, s68, 49152
    s_nop 0
    buffer_load_dwordx4 v5, s[80:83], s43 offen offset:0 lds
    buffer_load_dwordx4 v6, s[80:83], s43 offen offset:1024 lds
    buffer_load_dwordx4 v7, s[80:83], s43 offen offset:2048 lds
    buffer_load_dwordx4 v8, s[80:83], s43 offen offset:3072 lds
    s_add_u32 s43, s43, 128
    s_cmp_eq_u32 s43, 1280
    s_cselect_b32 s43, 0, s43
    s_add_u32 m0, s79, 81920
    s_nop 0
    buffer_load_dwordx4 v5, s[84:87], s42 offen offset:0 lds
    buffer_load_dwordx4 v6, s[84:87], s42 offen offset:1024 lds
    buffer_load_dwordx4 v7, s[84:87], s42 offen offset:2048 lds
    s_waitcnt vmcnt(11)
    s_waitcnt lgkmcnt(0)
    s_barrier
    s_add_u32 m0, s79, 81920
    s_nop 0
    buffer_load_dwordx4 v8, s[84:87], s42 offen offset:3072 lds
    s_add_u32 m0, s79, 86016
    s_nop 0
    buffer_load_dwordx4 v9, s[84:87], s42 offen offset:0 lds
    s_add_u32 s42, s42, 256
    s_cmp_ge_u32 s42, 1280
    s_cselect_b32 s70, 1280, 0
    s_sub_u32 s42, s42, s70
    s_add_u32 m0, s68, 65536
    s_nop 0
    buffer_load_dwordx4 v5, s[80:83], s43 offen offset:0 lds
    buffer_load_dwordx4 v6, s[80:83], s43 offen offset:1024 lds
    buffer_load_dwordx4 v7, s[80:83], s43 offen offset:2048 lds
    buffer_load_dwordx4 v8, s[80:83], s43 offen offset:3072 lds
    s_add_u32 s43, s43, 128
    s_cmp_eq_u32 s43, 1280
    s_cselect_b32 s43, 0, s43
    s_waitcnt vmcnt(13)
    s_waitcnt lgkmcnt(0)
    s_barrier
    s_add_u32 m0, s69, 131072
    s_nop 0
    buffer_load_dwordx4 v13, s[12:15], s49 offen offset:0 lds
    buffer_load_dwordx4 v14, s[12:15], s49 offen offset:1024 lds
    buffer_load_dwordx4 v15, s[12:15], s49 offen offset:2048 lds
    s_add_u32 m0, s69, 134144
    s_nop 0
    buffer_load_dwordx4 v16, s[12:15], s49 offen offset:0 lds
    buffer_load_dwordx4 v17, s[12:15], s49 offen offset:1024 lds
    buffer_load_dwordx4 v18, s[12:15], s49 offen offset:2048 lds
    s_add_u32 s49, s49, 196608
    s_cmp_eq_u32 s49, 1966080
    s_cselect_b32 s49, 0, s49
    s_waitcnt vmcnt(10)
    s_waitcnt lgkmcnt(0)
    s_barrier
    s_mov_b32 s84, s50
    s_and_b32 s85, s51, 0xffff
    s_mov_b32 s86, 4
    s_mov_b32 s87, 0x20000
    buffer_load_dword v55, off, s[84:87], 0 sc1
    s_add_u32 m0, s69, 106496
    s_nop 0
    buffer_load_dwordx4 v13, s[12:15], s49 offen offset:0 lds
    buffer_load_dwordx4 v14, s[12:15], s49 offen offset:1024 lds
    buffer_load_dwordx4 v15, s[12:15], s49 offen offset:2048 lds
    s_add_u32 m0, s69, 109568
    s_nop 0
    buffer_load_dwordx4 v16, s[12:15], s49 offen offset:0 lds
    buffer_load_dwordx4 v17, s[12:15], s49 offen offset:1024 lds
    buffer_load_dwordx4 v18, s[12:15], s49 offen offset:2048 lds
    s_add_u32 s49, s49, 196608
    s_cmp_eq_u32 s49, 1966080
    s_cselect_b32 s49, 0, s49
    s_waitcnt vmcnt(13)
    s_waitcnt lgkmcnt(0)
    s_barrier
    v_mul_u32_u24 v54, 3072, v3
    v_mul_u32_u24 v56, 12, v2
    s_lshr_b32 s70, s34, 1
    s_mul_i32 s70, s70, 96
    v_add3_u32 v54, v54, v56, s70
    s_mul_i32 s70, s29, 122880
    buffer_load_dwordx3 v[96:98], v54, s[12:15], s70 offen
    s_add_u32 s70, s70, 24576
    buffer_load_dwordx3 v[100:102], v54, s[12:15], s70 offen
    s_add_u32 s70, s70, 24576
    buffer_load_dwordx3 v[104:106], v54, s[12:15], s70 offen
    s_add_u32 s70, s70, 24576
    buffer_load_dwordx3 v[108:110], v54, s[12:15], s70 offen
    s_add_u32 s70, s70, 24576
    buffer_load_dwordx3 v[112:114], v54, s[12:15], s70 offen
    s_add_u32 s70, s70, 24576
    s_waitcnt vmcnt(12)
    s_waitcnt lgkmcnt(0)
    s_barrier
    s_add_u32 m0, s69, 81920
    s_nop 0
    buffer_load_dwordx4 v13, s[12:15], s49 offen offset:0 lds
    s_mov_b32 s16, 0
    s_cmp_eq_u32 s31, 1
    s_cselect_b32 s16, 22, s16
    s_cmp_eq_u32 s31, 2
    s_cselect_b32 s16, 46, s16
    s_cmp_eq_u32 s31, 3
    s_cselect_b32 s16, 54, s16
    buffer_load_dwordx4 v14, s[12:15], s49 offen offset:1024 lds
    s_mov_b32 s17, 23
    s_cmp_eq_u32 s31, 1
    s_cselect_b32 s17, 45, s17
    s_cmp_eq_u32 s31, 2
    s_cselect_b32 s17, 55, s17
    s_cmp_eq_u32 s31, 3
    s_cselect_b32 s17, 63, s17
    buffer_load_dwordx4 v15, s[12:15], s49 offen offset:2048 lds
    v_add_u32 v53, s16, v1
    v_min_u32 v53, s17, v53
    s_lshl_b32 s16, s32, 11
    s_add_u32 s16, s16, 393216
    v_lshl_add_u32 v53, v53, 5, s16
    s_mov_b32 s16, 0
    s_add_u32 m0, s69, 84992
    s_nop 0
    buffer_load_dwordx4 v16, s[12:15], s49 offen offset:0 lds
    s_cmp_eq_u32 s31, 3
    s_cselect_b32 s16, 8, s16
    s_mov_b32 s17, 0
    s_cmp_eq_u32 s31, 2
    s_cselect_b32 s17, 7, s17
    s_cmp_eq_u32 s31, 3
    s_cselect_b32 s17, 15, s17
    buffer_load_dwordx4 v17, s[12:15], s49 offen offset:1024 lds
    v_add_u32 v54, s16, v1
    v_min_u32 v54, s17, v54
    s_lshl_b32 s16, s29, 9
    s_add_u32 s16, s16, 458752
    v_lshl_add_u32 v54, v54, 5, s16
    buffer_load_dwordx4 v18, s[12:15], s49 offen offset:2048 lds
    s_add_u32 s49, s49, 196608
    s_cmp_eq_u32 s49, 1966080
    s_cselect_b32 s49, 0, s49
    s_waitcnt vmcnt(17)
    s_mov_b32 s88, 20000
.h_np:
    v_readfirstlane_b32 s35, v55
    s_sub_u32 s88, s88, 1
    s_cmp_eq_u32 s88, 0
    s_cbranch_scc1 .h_nok
    s_cmp_lg_u32 s35, 0
    s_cbranch_scc1 .h_nok
    s_sleep 4
    buffer_load_dword v55, off, s[84:87], 0 sc1
    s_waitcnt vmcnt(0)
    s_branch .h_np
.h_nok:
    v_mov_b32 v56, 159616
    ds_write_b32 v56, v55
    s_add_u32 s84, s26, 5242880
    s_addc_u32 s85, s27, 0
    s_and_b32 s85, s85, 0xffff
    s_mov_b32 s86, 1048576
    s_mov_b32 s87, 0x20000
    s_waitcnt vmcnt(11)
    s_waitcnt lgkmcnt(0)
    s_barrier
    s_add_u32 m0, s69, 131072
    s_nop 0
    buffer_load_dwordx4 v13, s[12:15], s49 offen offset:0 lds
    v_and_b32 v56, 31, v1
    s_lshl_b32 s16, s34, 5
    v_add_u32 v56, s16, v56
    v_lshlrev_b32 v57, 3, v56
    v_add_u32 v57, 159744, v57
    ds_read_b64 v[68:69], v57
    buffer_load_dwordx4 v14, s[12:15], s49 offen offset:1024 lds
    v_lshlrev_b32 v57, 4, v56
    v_add_u32 v57, 155648, v57
    v_lshlrev_b32 v56, 2, v56
    v_add_u32 v56, 155648, v56
    s_waitcnt lgkmcnt(0)
    v_mul_f32 v68, 0xbacccccd, v68
    buffer_load_dwordx4 v15, s[12:15], s49 offen offset:2048 lds
    v_mul_f32 v70, 0x3acccccd, v69
    v_fma_f32 v70, -v68, v68, v70
    v_max_f32 v70, 0, v70
    v_cvt_pk_bf16_f32 v68, v68, v68
    v_and_b32 v68, 0xffff0000, v68
    v_cvt_pk_bf16_f32 v70, v70, v70
    s_add_u32 m0, s69, 134144
    s_nop 0
    buffer_load_dwordx4 v16, s[12:15], s49 offen offset:0 lds
    v_and_b32 v70, 0xffff0000, v70
    v_add_f32 v70, 0x3727c5ac, v70
    v_cvt_pk_bf16_f32 v70, v70, v70
    v_and_b32 v70, 0xffff0000, v70
    v_sqrt_f32 v70, v70
    ds_write_b32 v56, v68 offset:2048
    buffer_load_dwordx4 v17, s[12:15], s49 offen offset:1024 lds
    v_cvt_pk_bf16_f32 v70, v70, v70
    v_and_b32 v70, 0xffff0000, v70
    v_rcp_f32 v69, v70
    s_cmp_lt_u32 s30, 8
    s_cselect_b32 s16, 0, 0x80000000
    v_fma_f32 v71, -v70, v69, 1.0
    buffer_load_dwordx4 v18, s[12:15], s49 offen offset:2048 lds
    v_fma_f32 v69, v71, v69, v69
    v_xor_b32 v72, s16, v69
    ds_write_b32 v56, v72 offset:2560
    v_mul_f32 v67, v70, v70
    v_mul_f32 v70, v69, v69
    v_mul_f32 v70, v70, v69
    s_add_u32 s49, s49, 196608
    s_cmp_eq_u32 s49, 1966080
    s_cselect_b32 s49, 0, s49
    s_add_u32 m0, s68, 0
    s_nop 0
    buffer_load_dwordx4 v5, s[80:83], s43 offen offset:0 lds
    v_mul_f32 v66, 0xbdd2d3e8, v70
    v_mul_f32 v65, 0xc0135761, v69
    v_mov_b32 v64, v68
    buffer_load_dwordx4 v6, s[80:83], s43 offen offset:1024 lds
    buffer_load_dwordx4 v7, s[80:83], s43 offen offset:2048 lds
    s_waitcnt vmcnt(9)
    s_waitcnt lgkmcnt(0)
    s_barrier
    s_add_u32 m0, s69, 106496
    s_nop 0
    buffer_load_dwordx4 v13, s[12:15], s49 offen offset:0 lds
    v_lshlrev_b32 v68, 16, v96
    v_and_b32 v69, 0xffff0000, v96
    v_lshlrev_b32 v70, 16, v97
    v_and_b32 v71, 0xffff0000, v97
    v_lshlrev_b32 v72, 16, v98
    buffer_load_dwordx4 v14, s[12:15], s49 offen offset:1024 lds
    v_and_b32 v73, 0xffff0000, v98
    v_lshlrev_b32 v76, 16, v100
    v_and_b32 v77, 0xffff0000, v100
    v_lshlrev_b32 v78, 16, v101
    v_and_b32 v79, 0xffff0000, v101
    v_lshlrev_b32 v80, 16, v102
    buffer_load_dwordx4 v15, s[12:15], s49 offen offset:2048 lds
    v_and_b32 v81, 0xffff0000, v102
    v_add_f32 v68, v68, v76
    v_add_f32 v69, v69, v77
    v_add_f32 v70, v70, v78
    v_add_f32 v71, v71, v79
    v_add_f32 v72, v72, v80
    s_add_u32 m0, s69, 109568
    s_nop 0
    buffer_load_dwordx4 v16, s[12:15], s49 offen offset:0 lds
    v_add_f32 v73, v73, v81
    v_lshlrev_b32 v76, 16, v104
    v_and_b32 v77, 0xffff0000, v104
    v_lshlrev_b32 v78, 16, v105
    v_and_b32 v79, 0xffff0000, v105
    v_lshlrev_b32 v80, 16, v106
    buffer_load_dwordx4 v17, s[12:15], s49 offen offset:1024 lds
    v_and_b32 v81, 0xffff0000, v106
    v_add_f32 v68, v68, v76
    v_add_f32 v69, v69, v77
    v_add_f32 v70, v70, v78
    v_add_f32 v71, v71, v79
    v_add_f32 v72, v72, v80
    buffer_load_dwordx4 v18, s[12:15], s49 offen offset:2048 lds
    v_add_f32 v73, v73, v81
    v_lshlrev_b32 v76, 16, v108
    v_and_b32 v77, 0xffff0000, v108
    v_lshlrev_b32 v78, 16, v109
    v_and_b32 v79, 0xffff0000, v109
    v_lshlrev_b32 v80, 16, v110
    s_add_u32 s49, s49, 196608
    s_cmp_eq_u32 s49, 1966080
    s_cselect_b32 s49, 0, s49
    s_add_u32 m0, s68, 0
    s_nop 0
    buffer_load_dwordx4 v8, s[80:83], s43 offen offset:3072 lds
    v_and_b32 v81, 0xffff0000, v110
    v_add_f32 v68, v68, v76
    v_add_f32 v69, v69, v77
    v_add_f32 v70, v70, v78
    v_add_f32 v71, v71, v79
    v_add_f32 v72, v72, v80
    s_add_u32 s43, s43, 128
    s_cmp_eq_u32 s43, 1280
    s_cselect_b32 s43, 0, s43
    s_add_u32 m0, s68, 16384
    s_nop 0
    buffer_load_dwordx4 v5, s[80:83], s43 offen offset:0 lds
    v_add_f32 v73, v73, v81
    v_lshlrev_b32 v76, 16, v112
    v_and_b32 v77, 0xffff0000, v112
    v_lshlrev_b32 v78, 16, v113
    v_and_b32 v79, 0xffff0000, v113
    v_lshlrev_b32 v80, 16, v114
    buffer_load_dwordx4 v6, s[80:83], s43 offen offset:1024 lds
    v_and_b32 v81, 0xffff0000, v114
    v_add_f32 v68, v68, v76
    v_add_f32 v69, v69, v77
    v_add_f32 v70, v70, v78
    v_add_f32 v71, v71, v79
    v_add_f32 v72, v72, v80
    v_add_f32 v73, v73, v81
    ds_write_b128 v57, v[64:67]
    s_waitcnt vmcnt(12)
    s_waitcnt lgkmcnt(0)
    s_barrier
    s_add_u32 m0, s69, 81920
    s_nop 0
    buffer_load_dwordx4 v13, s[12:15], s49 offen offset:0 lds
    s_nop 1
    v_permlane32_swap_b32 v68, v71
    v_permlane32_swap_b32 v69, v72
    v_permlane32_swap_b32 v70, v73
    s_nop 1
    v_add_f32 v68, v68, v71
    buffer_load_dwordx4 v14, s[12:15], s49 offen offset:1024 lds
    v_add_f32 v69, v69, v72
    v_add_f32 v70, v70, v73
    v_mov_b32 v71, v68
    v_mov_b32 v72, v69
    v_mov_b32 v73, v70
    s_nop 1
    buffer_load_dwordx4 v15, s[12:15], s49 offen offset:2048 lds
    v_permlane16_swap_b32 v68, v71
    v_permlane16_swap_b32 v69, v72
    v_permlane16_swap_b32 v70, v73
    s_nop 1
    v_add_f32 v68, v68, v71
    v_add_f32 v69, v69, v72
    s_add_u32 m0, s69, 84992
    s_nop 0
    buffer_load_dwordx4 v16, s[12:15], s49 offen offset:0 lds
    v_add_f32 v70, v70, v73
    s_and_b32 s16, s34, 1
    s_lshl_b32 s16, s16, 1
    s_lshr_b32 s17, s34, 1
    s_add_u32 s40, s16, s17
    v_add_f32_dpp v68, v68, v68 row_ror:8 row_mask:0xf bank_mask:0xf
    buffer_load_dwordx4 v17, s[12:15], s49 offen offset:1024 lds
    v_add_f32_dpp v69, v69, v69 row_ror:8 row_mask:0xf bank_mask:0xf
    v_add_f32_dpp v70, v70, v70 row_ror:8 row_mask:0xf bank_mask:0xf
    v_mov_b32 v71, v55
    v_lshrrev_b32 v56, 5, v1
    v_lshl_add_u32 v56, v2, 1, v56
    v_lshlrev_b32 v56, 4, v56
    buffer_load_dwordx4 v18, s[12:15], s49 offen offset:2048 lds
    s_lshl_b32 s16, s30, 4
    s_add_u32 s16, s16, s29
    s_lshl_b32 s16, s16, 2
    s_add_u32 s16, s16, s40
    s_lshl_b32 s16, s16, 8
    s_add_u32 s16, s16, 65536
    s_add_u32 s49, s49, 196608
    s_cmp_eq_u32 s49, 1966080
    s_cselect_b32 s49, 0, s49
    s_add_u32 m0, s68, 16384
    s_nop 0
    buffer_load_dwordx4 v7, s[80:83], s43 offen offset:2048 lds
    buffer_store_dwordx4 v[68:71], v56, s[84:87], s16 offen sc1
    v_lshrrev_b32 v56, 4, v1
    v_and_b32 v19, 15, v1
    v_lshlrev_b32 v57, 10, v56
    v_lshl_add_u32 v57, v19, 4, v57
    s_lshl_b32 s16, s40, 8
    buffer_load_dwordx4 v8, s[80:83], s43 offen offset:3072 lds
    v_add_u32 v57, s16, v57
    v_cmp_eq_u32 vcc, 3, v56
    v_cndmask_b32 v56, v56, 1, vcc
    v_mul_u32_u24 v19, 3, v19
    v_add_u32 v56, v56, v19
    s_mul_i32 s16, s40, 192
    s_add_u32 s43, s43, 128
    s_cmp_eq_u32 s43, 1280
    s_cselect_b32 s43, 0, s43
    s_add_u32 m0, s68, 32768
    s_nop 0
    buffer_load_dwordx4 v5, s[80:83], s43 offen offset:0 lds
    s_add_u32 s16, s16, 158720
    v_lshl_add_u32 v56, v56, 2, s16
    s_waitcnt vmcnt(12)
    s_waitcnt lgkmcnt(0)
    s_barrier
    s_add_u32 m0, s69, 131072
    s_nop 0
    buffer_load_dwordx4 v13, s[12:15], s49 offen offset:0 lds
    buffer_load_dwordx4 v14, s[12:15], s49 offen offset:1024 lds
    buffer_load_dwordx4 v15, s[12:15], s49 offen offset:2048 lds
    s_add_u32 m0, s69, 134144
    s_nop 0
    buffer_load_dwordx4 v16, s[12:15], s49 offen offset:0 lds
    buffer_load_dwordx4 v17, s[12:15], s49 offen offset:1024 lds
    buffer_load_dwordx4 v18, s[12:15], s49 offen offset:2048 lds
    s_add_u32 s49, s49, 196608
    s_cmp_eq_u32 s49, 1966080
    s_cselect_b32 s49, 0, s49
    s_add_u32 m0, s68, 32768
    s_nop 0
    buffer_load_dwordx4 v6, s[80:83], s43 offen offset:1024 lds
    buffer_load_dwordx4 v7, s[80:83], s43 offen offset:2048 lds
    buffer_load_dwordx4 v8, s[80:83], s43 offen offset:3072 lds
    s_add_u32 s43, s43, 128
    s_cmp_eq_u32 s43, 1280
    s_cselect_b32 s43, 0, s43
    s_waitcnt vmcnt(12)
    s_waitcnt lgkmcnt(0)
    s_barrier
    s_add_u32 m0, s69, 106496
    s_nop 0
    buffer_load_dwordx4 v13, s[12:15], s49 offen offset:0 lds
    buffer_load_dwordx4 v14, s[12:15], s49 offen offset:1024 lds
    buffer_load_dwordx4 v15, s[12:15], s49 offen offset:2048 lds
    s_add_u32 m0, s69, 109568
    s_nop 0
    buffer_load_dwordx4 v16, s[12:15], s49 offen offset:0 lds
    buffer_load_dwordx4 v17, s[12:15], s49 offen offset:1024 lds
    buffer_load_dwordx4 v18, s[12:15], s49 offen offset:2048 lds
    s_add_u32 s49, s49, 196608
    s_cmp_eq_u32 s49, 1966080
    s_cselect_b32 s49, 0, s49
    s_add_u32 m0, s68, 49152
    s_nop 0
    buffer_load_dwordx4 v5, s[80:83], s43 offen offset:0 lds
    buffer_load_dwordx4 v6, s[80:83], s43 offen offset:1024 lds
    buffer_load_dwordx4 v7, s[80:83], s43 offen offset:2048 lds
    s_waitcnt vmcnt(12)
    s_waitcnt lgkmcnt(0)
    s_barrier
    s_add_u32 m0, s69, 81920
    s_nop 0
    buffer_load_dwordx4 v13, s[12:15], s49 offen offset:0 lds
    buffer_load_dwordx4 v14, s[12:15], s49 offen offset:1024 lds
    buffer_load_dwordx4 v15, s[12:15], s49 offen offset:2048 lds
    s_add_u32 m0, s69, 84992
    s_nop 0
    buffer_load_dwordx4 v16, s[12:15], s49 offen offset:0 lds
    buffer_load_dwordx4 v17, s[12:15], s49 offen offset:1024 lds
    buffer_load_dwordx4 v18, s[12:15], s49 offen offset:2048 lds
    s_add_u32 s49, s49, 196608
    s_cmp_eq_u32 s49, 1966080
    s_cselect_b32 s49, 0, s49
    s_add_u32 m0, s68, 49152
    s_nop 0
    buffer_load_dwordx4 v8, s[80:83], s43 offen offset:3072 lds
    s_add_u32 s43, s43, 128
    s_cmp_eq_u32 s43, 1280
    s_cselect_b32 s43, 0, s43
    s_add_u32 m0, s68, 65536
    s_nop 0
    buffer_load_dwordx4 v5, s[80:83], s43 offen offset:0 lds
    buffer_load_dwordx4 v6, s[80:83], s43 offen offset:1024 lds
    s_lshl_b32 s70, s30, 14
    s_add_u32 s70, s70, 65536
    buffer_load_dwordx4 v[96:99], v57, s[84:87], s70 offen
    s_add_u32 s70, s70, 4096
    buffer_load_dwordx4 v[100:103], v57, s[84:87], s70 offen
    s_add_u32 s70, s70, 4096
    buffer_load_dwordx4 v[104:107], v57, s[84:87], s70 offen
    s_add_u32 s70, s70, 4096
    buffer_load_dwordx4 v[108:111], v57, s[84:87], s70 offen
    s_add_u32 s70, s70, 4096
    s_waitcnt vmcnt(16)
    s_waitcnt lgkmcnt(0)
    s_barrier
    s_add_u32 m0, s68, 65536
    s_nop 0
    buffer_load_dwordx4 v7, s[80:83], s43 offen offset:2048 lds
    buffer_load_dwordx4 v8, s[80:83], s43 offen offset:3072 lds
    s_add_u32 s43, s43, 128
    s_cmp_eq_u32 s43, 1280
    s_cselect_b32 s43, 0, s43
    s_add_u32 m0, s69, 131072
    s_nop 0
    buffer_load_dwordx4 v13, s[12:15], s49 offen offset:0 lds
    buffer_load_dwordx4 v14, s[12:15], s49 offen offset:1024 lds
    buffer_load_dwordx4 v15, s[12:15], s49 offen offset:2048 lds
    s_add_u32 m0, s69, 134144
    s_nop 0
    buffer_load_dwordx4 v16, s[12:15], s49 offen offset:0 lds
    buffer_load_dwordx4 v17, s[12:15], s49 offen offset:1024 lds
    buffer_load_dwordx4 v18, s[12:15], s49 offen offset:2048 lds
    s_add_u32 s49, s49, 196608
    s_cmp_eq_u32 s49, 1966080
    s_cselect_b32 s49, 0, s49
    v_readlane_b32 s70, v52, s76
    s_cmp_lt_u32 s70, 32
    s_cselect_b32 s64, s44, s46
    s_cselect_b32 s65, s45, s47
    s_and_b32 s71, s70, 31
    s_mov_b32 m0, s36
    s_lshl_b32 s71, s71, 7
    buffer_load_dwordx4 v20, s[64:67], s71 offen offset:0 lds
    buffer_load_dwordx4 v21, s[64:67], s71 offen offset:1024 lds
    s_add_u32 m0, s36, 2048
    s_nop 0
    buffer_load_dwordx4 v22, s[64:67], s71 offen offset:0 lds
    buffer_load_dwordx4 v23, s[64:67], s71 offen offset:1024 lds
    s_add_u32 s76, s76, 1
    s_add_u32 s36, s36, 16384
    s_cmp_ge_u32 s36, s38
    s_cselect_b32 s70, 81920, 0
    s_sub_u32 s36, s36, s70
    s_waitcnt vmcnt(18)
    s_waitcnt lgkmcnt(0)
    s_barrier
    v_readlane_b32 s70, v52, s76
    s_cmp_lt_u32 s70, 32
    s_cselect_b32 s64, s44, s46
    s_cselect_b32 s65, s45, s47
    s_and_b32 s71, s70, 31
    s_mov_b32 m0, s36
    s_lshl_b32 s71, s71, 7
    buffer_load_dwordx4 v20, s[64:67], s71 offen offset:0 lds
    buffer_load_dwordx4 v21, s[64:67], s71 offen offset:1024 lds
    s_add_u32 m0, s36, 2048
    s_nop 0
    buffer_load_dwordx4 v22, s[64:67], s71 offen offset:0 lds
    buffer_load_dwordx4 v23, s[64:67], s71 offen offset:1024 lds
    s_add_u32 s76, s76, 1
    s_add_u32 s36, s36, 16384
    s_cmp_ge_u32 s36, s38
    s_cselect_b32 s70, 81920, 0
    s_sub_u32 s36, s36, s70
    v_readlane_b32 s70, v52, s76
    s_cmp_lt_u32 s70, 32
    s_cselect_b32 s64, s44, s46
    s_cselect_b32 s65, s45, s47
    s_and_b32 s71, s70, 31
    s_mov_b32 m0, s36
    s_lshl_b32 s71, s71, 7
    buffer_load_dwordx4 v20, s[64:67], s71 offen offset:0 lds
    buffer_load_dwordx4 v21, s[64:67], s71 offen offset:1024 lds
    s_add_u32 m0, s36, 2048
    s_nop 0
    buffer_load_dwordx4 v22, s[64:67], s71 offen offset:0 lds
    buffer_load_dwordx4 v23, s[64:67], s71 offen offset:1024 lds
    s_add_u32 s76, s76, 1
    s_add_u32 s36, s36, 16384
    s_cmp_ge_u32 s36, s38
    s_cselect_b32 s70, 81920, 0
    s_sub_u32 s36, s36, s70
    s_waitcnt vmcnt(20)
    s_mov_b32 s88, 20000
.h_gchk:
    v_cmp_eq_u32 s[70:71], v55, v99
    v_cmp_eq_u32 vcc, v55, v103
    s_and_b64 s[70:71], s[70:71], vcc
    v_cmp_eq_u32 vcc, v55, v107
    s_and_b64 s[70:71], s[70:71], vcc
    v_cmp_eq_u32 vcc, v55, v111
    s_and_b64 s[70:71], s[70:71], vcc
    s_sub_u32 s88, s88, 1
    s_cmp_eq_u32 s88, 0
    s_cbranch_scc1 .h_gok
    s_cmp_eq_u64 s[70:71], -1
    s_cbranch_scc1 .h_gok
    s_lshl_b32 s70, s30, 14
    s_add_u32 s70, s70, 65536
    buffer_load_dwordx4 v[96:99], v57, s[84:87], s70 offen sc1
    s_add_u32 s70, s70, 4096
    buffer_load_dwordx4 v[100:103], v57, s[84:87], s70 offen sc1
    s_add_u32 s70, s70, 4096
    buffer_load_dwordx4 v[104:107], v57, s[84:87], s70 offen sc1
    s_add_u32 s70, s70, 4096
    buffer_load_dwordx4 v[108:111], v57, s[84:87], s70 offen sc1
    s_add_u32 s70, s70, 4096
    s_waitcnt vmcnt(0)
    s_branch .h_gchk
.h_gok:
    v_add_f32 v96, v96, v100
    v_add_f32 v97, v97, v101
    v_add_f32 v98, v98, v102
    v_add_f32 v96, v96, v104
    v_add_f32 v97, v97, v105
    v_add_f32 v98, v98, v106
    v_add_f32 v96, v96, v108
    v_add_f32 v97, v97, v109
    v_add_f32 v98, v98, v110
    v_mov_b32 v99, v97
    s_nop 1
    v_permlane32_swap_b32 v96, v98
    v_permlane32_swap_b32 v97, v99
    s_nop 1
    v_add_f32 v96, v96, v98
    v_add_f32 v97, v97, v99
    s_nop 1
    v_permlane16_swap_b32 v96, v97
    s_nop 1
    v_add_f32 v96, v96, v97
    ds_write_b32 v56, v96
    s_waitcnt vmcnt(12)
    s_waitcnt lgkmcnt(0)
    s_barrier
    s_sleep 0
    buffer_load_dword v58, v53, s[84:87], 0 offen sc1
    s_waitcnt lgkmcnt(0)
    s_barrier
    s_waitcnt vmcnt(0)
    v_cmp_eq_u32 vcc, v55, v58
    s_cmp_eq_u64 vcc, -1
    s_cbranch_scc1 .h_join
    s_mov_b32 s88, 20000
.h_fp:
    buffer_load_dword v58, v53, s[84:87], 0 offen sc1
    s_waitcnt vmcnt(0)
.h_fp_c:
    v_cmp_eq_u32 vcc, v55, v58
    s_sub_u32 s88, s88, 1
    s_cmp_eq_u32 s88, 0
    s_cbranch_scc1 .h_fp_ok
    s_cmp_eq_u64 vcc, -1
    s_cbranch_scc1 .h_fp_ok
    s_sleep 4
    s_branch .h_fp
.h_fp_ok:
.h_join:
    v_readlane_b32 s70, v52, s77
    s_lshr_b32 s71, s70, 5
    s_mul_i32 s71, s71, 2621440
    s_and_b32 s72, s70, 31
    s_mul_i32 s72, s72, 20480
    s_mov_b32 m0, s37
    s_add_u32 s71, s71, s72
    buffer_load_dwordx4 v25, s[56:59], s71 offen offset:0 lds
    buffer_load_dwordx4 v25, s[56:59], s71 offen offset:1024 lds
    buffer_load_dwordx4 v25, s[56:59], s71 offen offset:2048 lds
    buffer_load_dwordx4 v25, s[56:59], s71 offen offset:3072 lds
    s_add_u32 m0, s37, 4096
    s_nop 0
    buffer_load_dwordx4 v26, s[56:59], s71 offen lds
    s_add_u32 s77, s77, 1
    s_add_u32 s37, s37, 20480
    s_cmp_ge_u32 s37, s39
    s_cselect_b32 s70, 81920, 0
    s_sub_u32 s37, s37, s70
    v_readlane_b32 s70, v52, s77
    s_lshr_b32 s71, s70, 5
    s_mul_i32 s71, s71, 2621440
    s_and_b32 s72, s70, 31
    s_mul_i32 s72, s72, 20480
    s_mov_b32 m0, s37
    s_add_u32 s71, s71, s72
    buffer_load_dwordx4 v25, s[56:59], s71 offen offset:0 lds
    buffer_load_dwordx4 v25, s[56:59], s71 offen offset:1024 lds
    buffer_load_dwordx4 v25, s[56:59], s71 offen offset:2048 lds
    buffer_load_dwordx4 v25, s[56:59], s71 offen offset:3072 lds
    s_add_u32 m0, s37, 4096
    s_nop 0
    buffer_load_dwordx4 v26, s[56:59], s71 offen lds
    s_add_u32 s77, s77, 1
    s_add_u32 s37, s37, 20480
    s_cmp_ge_u32 s37, s39
    s_cselect_b32 s70, 81920, 0
    s_sub_u32 s37, s37, s70
    v_readlane_b32 s70, v52, s76
    s_cmp_lt_u32 s70, 32
    s_cselect_b32 s64, s44, s46
    s_cselect_b32 s65, s45, s47
    s_and_b32 s71, s70, 31
    s_mov_b32 m0, s36
    s_lshl_b32 s71, s71, 7
    buffer_load_dwordx4 v20, s[64:67], s71 offen offset:0 lds
    buffer_load_dwordx4 v21, s[64:67], s71 offen offset:1024 lds
    s_add_u32 m0, s36, 2048
    s_nop 0
    buffer_load_dwordx4 v22, s[64:67], s71 offen offset:0 lds
    buffer_load_dwordx4 v23, s[64:67], s71 offen offset:1024 lds
    s_add_u32 s76, s76, 1
    s_add_u32 s36, s36, 16384
    s_cmp_ge_u32 s36, s38
    s_cselect_b32 s70, 81920, 0
    s_sub_u32 s36, s36, s70
    v_readlane_b32 s70, v52, s77
    s_lshr_b32 s71, s70, 5
    s_mul_i32 s71, s71, 2621440
    s_and_b32 s72, s70, 31
    s_mul_i32 s72, s72, 20480
    s_mov_b32 m0, s37
    s_add_u32 s71, s71, s72
    buffer_load_dwordx4 v25, s[56:59], s71 offen offset:0 lds
    buffer_load_dwordx4 v25, s[56:59], s71 offen offset:1024 lds
    buffer_load_dwordx4 v25, s[56:59], s71 offen offset:2048 lds
    buffer_load_dwordx4 v25, s[56:59], s71 offen offset:3072 lds
    s_add_u32 m0, s37, 4096
    s_nop 0
    buffer_load_dwordx4 v26, s[56:59], s71 offen lds
    s_add_u32 s77, s77, 1
    s_add_u32 s37, s37, 20480
    s_cmp_ge_u32 s37, s39
    s_cselect_b32 s70, 81920, 0
    s_sub_u32 s37, s37, s70
    v_readlane_b32 s70, v52, s76
    s_cmp_lt_u32 s70, 32
    s_cselect_b32 s64, s44, s46
    s_cselect_b32 s65, s45, s47
    s_and_b32 s71, s70, 31
    s_mov_b32 m0, s36
    s_lshl_b32 s71, s71, 7
    buffer_load_dwordx4 v20, s[64:67], s71 offen offset:0 lds
    buffer_load_dwordx4 v21, s[64:67], s71 offen offset:1024 lds
    s_add_u32 m0, s36, 2048
    s_nop 0
    buffer_load_dwordx4 v22, s[64:67], s71 offen offset:0 lds
    buffer_load_dwordx4 v23, s[64:67], s71 offen offset:1024 lds
    s_add_u32 s76, s76, 1
    s_add_u32 s36, s36, 16384
    s_cmp_ge_u32 s36, s38
    s_cselect_b32 s70, 81920, 0
    s_sub_u32 s36, s36, s70
    s_mov_b32 s79, 20
    s_cmp_eq_u32 s31, 2
    s_cselect_b32 s79, 18, s79
    s_cmp_eq_u32 s31, 3
    s_cselect_b32 s79, 18, s79
    s_mov_b32 s42, 99
    s_cmp_eq_u32 s31, 2
    s_cselect_b32 s42, 9, s42
    s_cmp_eq_u32 s31, 3
    s_cselect_b32 s42, 9, s42
    s_sub_u32 s41, s42, 1
    s_mov_b32 s78, 0
.h_loop:
    s_waitcnt vmcnt(18)
    s_barrier
    s_add_u32 s78, s78, 1
    s_cmp_eq_u32 s78, s79
    s_cbranch_scc1 .h_bd
    s_cmp_eq_u32 s78, 1
    s_cbranch_scc1 .h_bd
    v_readlane_b32 s70, v52, s76
    s_cmp_lt_u32 s70, 64
    s_cbranch_scc0 .h_bo
    s_cmp_lt_u32 s70, 32
    s_cselect_b32 s64, s44, s46
    s_cselect_b32 s65, s45, s47
    s_and_b32 s71, s70, 31
    s_mov_b32 m0, s36
    s_lshl_b32 s71, s71, 7
    buffer_load_dwordx4 v20, s[64:67], s71 offen offset:0 lds
    buffer_load_dwordx4 v21, s[64:67], s71 offen offset:1024 lds
    s_add_u32 m0, s36, 2048
    s_nop 0
    buffer_load_dwordx4 v22, s[64:67], s71 offen offset:0 lds
    buffer_load_dwordx4 v23, s[64:67], s71 offen offset:1024 lds
    s_branch .h_bx
.h_bo:
    s_cmp_lg_u32 s76, s42
    s_cbranch_scc1 .h_bo1
    s_cmp_eq_u32 s41, 0
    s_cbranch_scc1 .h_bo2
    s_mov_b32 s41, 0
    buffer_load_dword v58, v54, s[84:87], 0 offen sc1
    buffer_load_dword v58, v54, s[84:87], 0 offen sc1
    buffer_load_dword v58, v54, s[84:87], 0 offen sc1
    buffer_load_dword v58, v54, s[84:87], 0 offen sc1
    s_branch .h_bd
.h_bo2:
    s_waitcnt vmcnt(5)
    s_mov_b32 s88, 20000
    s_branch .h_hp_c
.h_hp:
    buffer_load_dword v58, v54, s[84:87], 0 offen sc1
    s_waitcnt vmcnt(0)
.h_hp_c:
    v_cmp_eq_u32 vcc, v55, v58
    s_sub_u32 s88, s88, 1
    s_cmp_eq_u32 s88, 0
    s_cbranch_scc1 .h_hp_ok
    s_cmp_eq_u64 vcc, -1
    s_cbranch_scc1 .h_hp_ok
    s_sleep 4
    s_branch .h_hp
.h_hp_ok:
    v_readlane_b32 s70, v52, s76
    s_sub_u32 s71, s70, 64
    s_mov_b32 m0, s36
    s_lshl_b32 s71, s71, 14
    buffer_load_dwordx4 v32, s[52:55], s71 offen offset:0 lds
    buffer_load_dwordx4 v33, s[52:55], s71 offen offset:1024 lds
    buffer_load_dwordx4 v34, s[52:55], s71 offen offset:2048 lds
    buffer_load_dwordx4 v35, s[52:55], s71 offen offset:3072 lds
    s_add_u32 s76, s76, 1
    s_add_u32 s36, s36, 16384
    s_cmp_ge_u32 s36, s38
    s_cselect_b32 s70, 81920, 0
    s_sub_u32 s36, s36, s70
    v_readlane_b32 s70, v52, s76
.h_bo1:
    s_sub_u32 s71, s70, 64
    s_mov_b32 m0, s36
    s_lshl_b32 s71, s71, 14
    buffer_load_dwordx4 v32, s[52:55], s71 offen offset:0 lds
    buffer_load_dwordx4 v33, s[52:55], s71 offen offset:1024 lds
    buffer_load_dwordx4 v34, s[52:55], s71 offen offset:2048 lds
    buffer_load_dwordx4 v35, s[52:55], s71 offen offset:3072 lds
.h_bx:
    s_add_u32 s76, s76, 1
    s_add_u32 s36, s36, 16384
    s_cmp_ge_u32 s36, s38
    s_cselect_b32 s70, 81920, 0
    s_sub_u32 s36, s36, s70
.h_bd:
    v_readlane_b32 s70, v52, s77
    s_cmp_lt_u32 s70, 64
    s_cbranch_scc0 .h_ao
    s_lshr_b32 s71, s70, 5
    s_mul_i32 s71, s71, 2621440
    s_and_b32 s72, s70, 31
    s_mul_i32 s72, s72, 20480
    s_mov_b32 m0, s37
    s_add_u32 s71, s71, s72
    buffer_load_dwordx4 v25, s[56:59], s71 offen offset:0 lds
    buffer_load_dwordx4 v25, s[56:59], s71 offen offset:1024 lds
    buffer_load_dwordx4 v25, s[56:59], s71 offen offset:2048 lds
    buffer_load_dwordx4 v25, s[56:59], s71 offen offset:3072 lds
    s_add_u32 m0, s37, 4096
    s_nop 0
    buffer_load_dwordx4 v26, s[56:59], s71 offen lds
    s_branch .h_ax
.h_ao:
    s_sub_u32 s71, s70, 64
    s_mov_b32 m0, s37
    s_mul_i32 s71, s71, 81920
    buffer_load_dwordx4 v27, s[60:63], s71 offen offset:0 lds
    buffer_load_dwordx4 v28, s[60:63], s71 offen offset:1024 lds
    buffer_load_dwordx4 v29, s[60:63], s71 offen offset:2048 lds
    buffer_load_dwordx4 v30, s[60:63], s71 offen offset:3072 lds
    s_add_u32 m0, s37, 4096
    s_nop 0
    buffer_load_dwordx4 v31, s[60:63], s71 offen lds
.h_ax:
    s_add_u32 s77, s77, 1
    s_add_u32 s37, s37, 20480
    s_cmp_ge_u32 s37, s39
    s_cselect_b32 s70, 81920, 0
    s_sub_u32 s37, s37, s70
    s_cmp_lg_u32 s78, s79
    s_cbranch_scc1 .h_loop
    s_and_b32 s35, s34, 1
    s_lshr_b32 s36, s34, 1
    s_lshl_b32 s70, s29, 2
    s_add_u32 s70, s70, s32
    s_lshl_b32 s70, s70, 2
    s_add_u32 s70, s70, s31
    s_lshl_b32 s70, s70, 2
    s_add_u32 s70, s70, s34
    s_mul_i32 s70, s70, 20480
    s_add_u32 s70, s70, 41943040
    s_add_u32 s40, s26, s70
    s_addc_u32 s41, s27, 0
    s_and_b32 s41, s41, 0xffff
    s_mov_b32 s42, 20480
    s_mov_b32 s43, 0x20000
    s_lshl_b32 s70, s29, 3
    s_lshl_b32 s71, s35, 2
    s_add_u32 s70, s70, s71
    s_add_u32 s70, s70, s31
    s_mul_i32 s70, s70, 20480
    s_mul_i32 s71, s32, 320
    s_add_u32 s70, s70, s71
    s_mul_i32 s71, s36, 160
    s_add_u32 s70, s70, s71
    s_add_u32 s44, s4, s70
    s_addc_u32 s45, s5, 0
    s_and_b32 s45, s45, 0xffff
    s_mov_b32 s46, 19360
    s_mov_b32 s47, 0x20000
    s_add_u32 s48, s22, s70
    s_addc_u32 s49, s23, 0
    s_and_b32 s49, s49, 0xffff
    s_mov_b32 s50, 19360
    s_mov_b32 s51, 0x20000
    v_and_b32 v2, 15, v1
    v_lshrrev_b32 v3, 4, v1
    v_mul_u32_u24 v2, 1280, v2
    v_lshl_add_u32 v2, v3, 3, v2
    v_lshlrev_b32 v3, 4, v1
    v_lshlrev_b32 v4, 3, v1
    s_mov_b32 s52, 4096
    s_mov_b32 s53, 8192
    s_mov_b32 s54, 12288
    s_mov_b32 s55, 16384
    s_cmp_eq_u32 s31, 2
    s_cselect_b32 s56, 4096, 0
    s_cmp_eq_u32 s31, 3
    s_cselect_b32 s57, 0, 4096
    s_waitcnt vmcnt(14)
    s_barrier
    s_add_u32 s78, s78, 1
    buffer_load_dwordx2 v[64:65], v2, s[44:47], 0 offen offset:0
    buffer_load_dwordx2 v[66:67], v2, s[44:47], 0 offen offset:32
    buffer_load_dwordx2 v[68:69], v2, s[44:47], 0 offen offset:64
    buffer_load_dwordx2 v[70:71], v2, s[44:47], 0 offen offset:96
    buffer_load_dwordx2 v[72:73], v2, s[44:47], 0 offen offset:128
    buffer_load_dwordx4 v[80:83], v3, s[40:43], s56 offen offset:0 sc1
    buffer_load_dwordx4 v[84:87], v3, s[40:43], s56 offen offset:1024 sc1
    buffer_load_dwordx4 v[88:91], v3, s[40:43], s56 offen offset:2048 sc1
    s_waitcnt vmcnt(13)
    s_barrier
    s_add_u32 s78, s78, 1
    buffer_load_dwordx4 v[96:99], v3, s[40:43], s57 offen offset:0 sc1
    buffer_load_dwordx4 v[100:103], v3, s[40:43], s57 offen offset:1024 sc1
    buffer_load_dwordx4 v[104:107], v3, s[40:43], s57 offen offset:2048 sc1
    v_mov_b32 v6, 0xbfb8aa3b
    v_mov_b32 v7, 1.0
    s_mul_i32 s70, s34, 5120
    s_mov_b32 s71, 143360
    s_cmp_eq_u32 s31, 2
    s_cselect_b32 s71, 102400, s71
    s_cmp_eq_u32 s31, 3
    s_cselect_b32 s71, 102400, s71
    s_add_u32 s71, s71, s70
    v_add_u32 v30, s71, v3
    s_mov_b32 s71, 81920
    s_cmp_eq_u32 s31, 2
    s_cselect_b32 s71, 122880, s71
    s_cmp_eq_u32 s31, 3
    s_cselect_b32 s71, 122880, s71
    s_add_u32 s71, s71, s70
    v_add_u32 v31, s71, v3
    s_mov_b32 s71, 102400
    s_cmp_eq_u32 s31, 2
    s_cselect_b32 s71, 143360, s71
    s_cmp_eq_u32 s31, 3
    s_cselect_b32 s71, 143360, s71
    s_lshl_b32 s70, s34, 8
    s_add_u32 s71, s71, s70
    v_lshl_add_u32 v29, v1, 2, s71
    v_min_u32 v5, 2, v1
    v_lshlrev_b32 v5, 12, v5
    v_add_u32 v5, 11264, v5
    v_mov_b32 v24, 0
    v_mov_b32 v25, 0
    buffer_load_dword v26, v5, s[40:43], 0 offen sc1
    s_waitcnt vmcnt(12)
    s_barrier
    s_add_u32 s78, s78, 1
    buffer_load_dword v27, v5, s[40:43], 0 offen sc1
    s_mov_b32 s88, 20000
    s_waitcnt vmcnt(1)
    v_cmp_eq_u32 vcc, v55, v26
    s_and_b32 s73, vcc_lo, 7
    s_bitcmp1_b32 s73, 0
    s_cbranch_scc0 .f_g0
    buffer_load_dwordx4 v[112:115], v3, s[40:43], s53 offen offset:0 sc1
    buffer_load_dwordx4 v[116:119], v3, s[40:43], s53 offen offset:1024 sc1
    buffer_load_dwordx4 v[120:123], v3, s[40:43], s53 offen offset:2048 sc1
.f_g0:
    s_bitcmp1_b32 s73, 1
    s_cbranch_scc0 .f_g1
    buffer_load_dwordx4 v[128:131], v3, s[40:43], s54 offen offset:0 sc1
    buffer_load_dwordx4 v[132:135], v3, s[40:43], s54 offen offset:1024 sc1
    buffer_load_dwordx4 v[136:139], v3, s[40:43], s54 offen offset:2048 sc1
.f_g1:
    s_bitcmp1_b32 s73, 2
    s_cbranch_scc0 .f_g2
    buffer_load_dwordx4 v[144:147], v3, s[40:43], s55 offen offset:0 sc1
    buffer_load_dwordx4 v[148:151], v3, s[40:43], s55 offen offset:1024 sc1
    buffer_load_dwordx4 v[152:155], v3, s[40:43], s55 offen offset:2048 sc1
.f_g2:
    s_branch .f_me_c
.f_me:
    s_waitcnt vmcnt(0)
.f_me_c:
    v_cmp_eq_u32_sdwa s[70:71], v55, v83 src0_sel:WORD_1 src1_sel:WORD_1
    v_cmp_eq_u32_sdwa vcc, v55, v87 src0_sel:WORD_0 src1_sel:WORD_1
    s_and_b64 s[70:71], s[70:71], vcc
    v_cmp_eq_u32 vcc, v55, v91
    s_and_b64 s[70:71], s[70:71], vcc
    v_cmp_eq_u32_sdwa vcc, v55, v99 src0_sel:WORD_1 src1_sel:WORD_1
    s_and_b64 s[70:71], s[70:71], vcc
    v_cmp_eq_u32_sdwa vcc, v55, v103 src0_sel:WORD_0 src1_sel:WORD_1
    s_and_b64 s[70:71], s[70:71], vcc
    v_cmp_eq_u32 vcc, v55, v107
    s_and_b64 s[70:71], s[70:71], vcc
    s_cmp_eq_u64 s[70:71], -1
    s_cbranch_scc1 .f_me_ok
    s_sub_u32 s88, s88, 1
    s_cmp_eq_u32 s88, 0
    s_cbranch_scc1 .f_me_ok
    s_sleep 2
    buffer_load_dwordx4 v[80:83], v3, s[40:43], s56 offen offset:0 sc1
    buffer_load_dwordx4 v[84:87], v3, s[40:43], s56 offen offset:1024 sc1
    buffer_load_dwordx4 v[88:91], v3, s[40:43], s56 offen offset:2048 sc1
    buffer_load_dwordx4 v[96:99], v3, s[40:43], s57 offen offset:0 sc1
    buffer_load_dwordx4 v[100:103], v3, s[40:43], s57 offen offset:1024 sc1
    buffer_load_dwordx4 v[104:107], v3, s[40:43], s57 offen offset:2048 sc1
    s_branch .f_me
.f_me_ok:
    s_cmp_ge_u32 s31, 2
    s_cbranch_scc1 .f_e1
    v_lshlrev_b32 v180, 16, v80
    v_lshlrev_b32 v8, 16, v96
    v_mov_b32 v160, 0
    v_add_f32 v180, v180, v8
    v_and_b32 v181, 0xffff0000, v80
    v_and_b32 v9, 0xffff0000, v96
    v_mov_b32 v161, 0
    v_add_f32 v181, v181, v9
    v_lshlrev_b32 v182, 16, v81
    v_lshlrev_b32 v10, 16, v97
    v_mov_b32 v162, 0
    v_add_f32 v182, v182, v10
    v_and_b32 v183, 0xffff0000, v81
    v_and_b32 v11, 0xffff0000, v97
    v_mov_b32 v163, 0
    v_add_f32 v183, v183, v11
    v_lshlrev_b32 v184, 16, v82
    v_lshlrev_b32 v8, 16, v98
    v_mov_b32 v164, 0
    v_add_f32 v184, v184, v8
    v_and_b32 v185, 0xffff0000, v82
    v_and_b32 v9, 0xffff0000, v98
    v_mov_b32 v165, 0
    v_add_f32 v185, v185, v9
    v_lshlrev_b32 v186, 16, v83
    v_lshlrev_b32 v10, 16, v99
    v_mov_b32 v166, 0
    v_add_f32 v186, v186, v10
    v_lshlrev_b32 v187, 16, v84
    v_lshlrev_b32 v11, 16, v100
    v_mov_b32 v167, 0
    v_add_f32 v187, v187, v11
    v_and_b32 v188, 0xffff0000, v84
    v_and_b32 v8, 0xffff0000, v100
    v_mov_b32 v168, 0
    v_add_f32 v188, v188, v8
    v_lshlrev_b32 v189, 16, v85
    v_lshlrev_b32 v9, 16, v101
    v_mov_b32 v169, 0
    v_add_f32 v189, v189, v9
    v_and_b32 v190, 0xffff0000, v85
    v_and_b32 v10, 0xffff0000, v101
    v_mov_b32 v170, 0
    v_add_f32 v190, v190, v10
    v_lshlrev_b32 v191, 16, v86
    v_lshlrev_b32 v11, 16, v102
    v_mov_b32 v171, 0
    v_add_f32 v191, v191, v11
    v_and_b32 v192, 0xffff0000, v86
    v_and_b32 v8, 0xffff0000, v102
    v_mov_b32 v172, 0
    v_add_f32 v192, v192, v8
    v_lshlrev_b32 v193, 16, v87
    v_lshlrev_b32 v9, 16, v103
    v_mov_b32 v173, 0
    v_add_f32 v193, v193, v9
    v_lshlrev_b32 v194, 16, v88
    v_lshlrev_b32 v10, 16, v104
    v_mov_b32 v174, 0
    v_add_f32 v194, v194, v10
    v_and_b32 v195, 0xffff0000, v88
    v_and_b32 v11, 0xffff0000, v104
    v_mov_b32 v175, 0
    v_add_f32 v195, v195, v11
    v_lshlrev_b32 v196, 16, v89
    v_lshlrev_b32 v8, 16, v105
    v_mov_b32 v176, 0
    v_add_f32 v196, v196, v8
    v_and_b32 v197, 0xffff0000, v89
    v_and_b32 v9, 0xffff0000, v105
    v_mov_b32 v177, 0
    v_add_f32 v197, v197, v9
    v_lshlrev_b32 v198, 16, v90
    v_lshlrev_b32 v10, 16, v106
    v_mov_b32 v178, 0
    v_add_f32 v198, v198, v10
    v_and_b32 v199, 0xffff0000, v90
    v_and_b32 v11, 0xffff0000, v106
    v_mov_b32 v179, 0
    v_add_f32 v199, v199, v11
    s_branch .f_e2
.f_e1:
    v_lshlrev_b32 v160, 16, v80
    v_mov_b32 v180, 0
    v_and_b32 v161, 0xffff0000, v80
    v_mov_b32 v181, 0
    v_lshlrev_b32 v162, 16, v81
    v_mov_b32 v182, 0
    v_and_b32 v163, 0xffff0000, v81
    v_mov_b32 v183, 0
    v_lshlrev_b32 v164, 16, v82
    v_mov_b32 v184, 0
    v_and_b32 v165, 0xffff0000, v82
    v_mov_b32 v185, 0
    v_lshlrev_b32 v166, 16, v83
    v_mov_b32 v186, 0
    v_lshlrev_b32 v167, 16, v84
    v_mov_b32 v187, 0
    v_and_b32 v168, 0xffff0000, v84
    v_mov_b32 v188, 0
    v_lshlrev_b32 v169, 16, v85
    v_mov_b32 v189, 0
    v_and_b32 v170, 0xffff0000, v85
    v_mov_b32 v190, 0
    v_lshlrev_b32 v171, 16, v86
    v_mov_b32 v191, 0
    v_and_b32 v172, 0xffff0000, v86
    v_mov_b32 v192, 0
    v_lshlrev_b32 v173, 16, v87
    v_mov_b32 v193, 0
    v_lshlrev_b32 v174, 16, v88
    v_mov_b32 v194, 0
    v_and_b32 v175, 0xffff0000, v88
    v_mov_b32 v195, 0
    v_lshlrev_b32 v176, 16, v89
    v_mov_b32 v196, 0
    v_and_b32 v177, 0xffff0000, v89
    v_mov_b32 v197, 0
    v_lshlrev_b32 v178, 16, v90
    v_mov_b32 v198, 0
    v_and_b32 v179, 0xffff0000, v90
    v_mov_b32 v199, 0
.f_e2:
    v_lshlrev_b32 v200, 16, v64
    v_and_b32 v201, 0xffff0000, v64
    v_lshlrev_b32 v202, 16, v65
    v_and_b32 v203, 0xffff0000, v65
    v_lshlrev_b32 v204, 16, v66
    v_and_b32 v205, 0xffff0000, v66
    v_lshlrev_b32 v206, 16, v67
    v_and_b32 v207, 0xffff0000, v67
    v_lshlrev_b32 v208, 16, v68
    v_and_b32 v209, 0xffff0000, v68
    v_lshlrev_b32 v210, 16, v69
    v_and_b32 v211, 0xffff0000, v69
    v_lshlrev_b32 v212, 16, v70
    v_and_b32 v213, 0xffff0000, v70
    v_lshlrev_b32 v214, 16, v71
    v_and_b32 v215, 0xffff0000, v71
    v_lshlrev_b32 v216, 16, v72
    v_and_b32 v217, 0xffff0000, v72
    v_lshlrev_b32 v218, 16, v73
    v_and_b32 v219, 0xffff0000, v73
    s_mov_b32 s72, 15
    s_mov_b32 s88, 20000
    v_mov_b32 v25, v27
    s_branch .f_h3
.f_pl:
    buffer_load_dword v24, v5, s[40:43], 0 offen sc1
    ds_read_b32 v28, v29
    s_waitcnt vmcnt(3) lgkmcnt(0)
    v_cmp_eq_u32 vcc, v55, v25
    v_cmp_eq_u32 s[74:75], v55, v28
    s_and_b32 s73, vcc_lo, 7
    s_and_b32 s74, s74, 8
    s_or_b32 s73, s73, s74
    s_and_b32 s73, s73, s72
    s_cbranch_scc1 .f_hd
    s_sleep 3
    buffer_load_dword v25, v5, s[40:43], 0 offen sc1
    ds_read_b32 v28, v29
    s_waitcnt vmcnt(3) lgkmcnt(0)
    v_cmp_eq_u32 vcc, v55, v26
    v_cmp_eq_u32 s[74:75], v55, v28
    s_and_b32 s73, vcc_lo, 7
    s_and_b32 s74, s74, 8
    s_or_b32 s73, s73, s74
    s_and_b32 s73, s73, s72
    s_cbranch_scc1 .f_hd
    s_sleep 3
    buffer_load_dword v26, v5, s[40:43], 0 offen sc1
    ds_read_b32 v28, v29
    s_waitcnt vmcnt(3) lgkmcnt(0)
    v_cmp_eq_u32 vcc, v55, v27
    v_cmp_eq_u32 s[74:75], v55, v28
    s_and_b32 s73, vcc_lo, 7
    s_and_b32 s74, s74, 8
    s_or_b32 s73, s73, s74
    s_and_b32 s73, s73, s72
    s_cbranch_scc1 .f_hd
    s_sleep 3
    buffer_load_dword v27, v5, s[40:43], 0 offen sc1
    ds_read_b32 v28, v29
    s_waitcnt vmcnt(3) lgkmcnt(0)
    v_cmp_eq_u32 vcc, v55, v24
    v_cmp_eq_u32 s[74:75], v55, v28
    s_and_b32 s73, vcc_lo, 7
    s_and_b32 s74, s74, 8
    s_or_b32 s73, s73, s74
    s_and_b32 s73, s73, s72
    s_cbranch_scc1 .f_hd
    s_sleep 3
    s_sub_u32 s88, s88, 1
    s_cmp_lg_u32 s88, 0
    s_cbranch_scc1 .f_pl
    s_branch .f_fin
.f_hd:
    s_bitcmp1_b32 s73, 0
    s_cbranch_scc0 .f_h0
    buffer_load_dwordx4 v[112:115], v3, s[40:43], s53 offen offset:0 sc1
    buffer_load_dwordx4 v[116:119], v3, s[40:43], s53 offen offset:1024 sc1
    buffer_load_dwordx4 v[120:123], v3, s[40:43], s53 offen offset:2048 sc1
.f_h0:
    s_bitcmp1_b32 s73, 1
    s_cbranch_scc0 .f_h1
    buffer_load_dwordx4 v[128:131], v3, s[40:43], s54 offen offset:0 sc1
    buffer_load_dwordx4 v[132:135], v3, s[40:43], s54 offen offset:1024 sc1
    buffer_load_dwordx4 v[136:139], v3, s[40:43], s54 offen offset:2048 sc1
.f_h1:
    s_bitcmp1_b32 s73, 2
    s_cbranch_scc0 .f_h2
    buffer_load_dwordx4 v[144:147], v3, s[40:43], s55 offen offset:0 sc1
    buffer_load_dwordx4 v[148:151], v3, s[40:43], s55 offen offset:1024 sc1
    buffer_load_dwordx4 v[152:155], v3, s[40:43], s55 offen offset:2048 sc1
.f_h2:
    s_bitcmp1_b32 s73, 3
    s_cbranch_scc0 .f_h3
    ds_read_b128 v[220:223], v30 offset:0
    ds_read_b128 v[224:227], v30 offset:1024
    ds_read_b128 v[228:231], v30 offset:2048
    ds_read_b128 v[232:235], v30 offset:3072
    ds_read_b128 v[236:239], v30 offset:4096
    s_andn2_b32 s72, s72, 8
    s_cmp_lt_u32 s31, 2
    s_cbranch_scc1 .f_h4
    ds_read_b128 v[80:83], v31 offset:0
    ds_read_b128 v[84:87], v31 offset:1024
    ds_read_b128 v[88:91], v31 offset:2048
    ds_read_b128 v[92:95], v31 offset:3072
    ds_read_b128 v[96:99], v31 offset:4096
    s_waitcnt lgkmcnt(0)
    v_pk_add_f32 v[160:161], v[160:161], v[80:81]
    v_pk_add_f32 v[162:163], v[162:163], v[82:83]
    v_pk_add_f32 v[164:165], v[164:165], v[84:85]
    v_pk_add_f32 v[166:167], v[166:167], v[86:87]
    v_pk_add_f32 v[168:169], v[168:169], v[88:89]
    v_pk_add_f32 v[170:171], v[170:171], v[90:91]
    v_pk_add_f32 v[172:173], v[172:173], v[92:93]
    v_pk_add_f32 v[174:175], v[174:175], v[94:95]
    v_pk_add_f32 v[176:177], v[176:177], v[96:97]
    v_pk_add_f32 v[178:179], v[178:179], v[98:99]
.f_h4:
    s_waitcnt lgkmcnt(0)
    v_pk_add_f32 v[180:181], v[180:181], v[220:221]
    v_pk_add_f32 v[182:183], v[182:183], v[222:223]
    v_pk_add_f32 v[184:185], v[184:185], v[224:225]
    v_pk_add_f32 v[186:187], v[186:187], v[226:227]
    v_pk_add_f32 v[188:189], v[188:189], v[228:229]
    v_pk_add_f32 v[190:191], v[190:191], v[230:231]
    v_pk_add_f32 v[192:193], v[192:193], v[232:233]
    v_pk_add_f32 v[194:195], v[194:195], v[234:235]
    v_pk_add_f32 v[196:197], v[196:197], v[236:237]
    v_pk_add_f32 v[198:199], v[198:199], v[238:239]
.f_h3:
    s_and_b32 s74, s73, 7
    s_cbranch_scc0 .f_h8
    s_waitcnt vmcnt(0)
    s_bitcmp1_b32 s73, 0
    s_cbranch_scc0 .f_h5
    v_cmp_eq_u32_sdwa s[70:71], v55, v115 src0_sel:WORD_1 src1_sel:WORD_1
    v_cmp_eq_u32_sdwa vcc, v55, v119 src0_sel:WORD_0 src1_sel:WORD_1
    s_and_b64 s[70:71], s[70:71], vcc
    v_cmp_eq_u32 vcc, v55, v123
    s_and_b64 s[70:71], s[70:71], vcc
    s_cmp_eq_u64 s[70:71], -1
    s_cbranch_scc0 .f_h5
    v_lshlrev_b32 v8, 16, v112
    v_and_b32 v9, 0xffff0000, v112
    v_pk_add_f32 v[180:181], v[180:181], v[8:9]
    v_lshlrev_b32 v10, 16, v113
    v_and_b32 v11, 0xffff0000, v113
    v_pk_add_f32 v[182:183], v[182:183], v[10:11]
    v_lshlrev_b32 v12, 16, v114
    v_and_b32 v13, 0xffff0000, v114
    v_pk_add_f32 v[184:185], v[184:185], v[12:13]
    v_lshlrev_b32 v14, 16, v115
    v_lshlrev_b32 v15, 16, v116
    v_pk_add_f32 v[186:187], v[186:187], v[14:15]
    v_and_b32 v8, 0xffff0000, v116
    v_lshlrev_b32 v9, 16, v117
    v_pk_add_f32 v[188:189], v[188:189], v[8:9]
    v_and_b32 v10, 0xffff0000, v117
    v_lshlrev_b32 v11, 16, v118
    v_pk_add_f32 v[190:191], v[190:191], v[10:11]
    v_and_b32 v12, 0xffff0000, v118
    v_lshlrev_b32 v13, 16, v119
    v_pk_add_f32 v[192:193], v[192:193], v[12:13]
    v_lshlrev_b32 v14, 16, v120
    v_and_b32 v15, 0xffff0000, v120
    v_pk_add_f32 v[194:195], v[194:195], v[14:15]
    v_lshlrev_b32 v8, 16, v121
    v_and_b32 v9, 0xffff0000, v121
    v_pk_add_f32 v[196:197], v[196:197], v[8:9]
    v_lshlrev_b32 v10, 16, v122
    v_and_b32 v11, 0xffff0000, v122
    v_pk_add_f32 v[198:199], v[198:199], v[10:11]
    s_andn2_b32 s72, s72, 1
.f_h5:
    s_bitcmp1_b32 s73, 1
    s_cbranch_scc0 .f_h6
    v_cmp_eq_u32_sdwa s[70:71], v55, v131 src0_sel:WORD_1 src1_sel:WORD_1
    v_cmp_eq_u32_sdwa vcc, v55, v135 src0_sel:WORD_0 src1_sel:WORD_1
    s_and_b64 s[70:71], s[70:71], vcc
    v_cmp_eq_u32 vcc, v55, v139
    s_and_b64 s[70:71], s[70:71], vcc
    s_cmp_eq_u64 s[70:71], -1
    s_cbranch_scc0 .f_h6
    v_lshlrev_b32 v8, 16, v128
    v_and_b32 v9, 0xffff0000, v128
    v_pk_add_f32 v[160:161], v[160:161], v[8:9]
    v_lshlrev_b32 v10, 16, v129
    v_and_b32 v11, 0xffff0000, v129
    v_pk_add_f32 v[162:163], v[162:163], v[10:11]
    v_lshlrev_b32 v12, 16, v130
    v_and_b32 v13, 0xffff0000, v130
    v_pk_add_f32 v[164:165], v[164:165], v[12:13]
    v_lshlrev_b32 v14, 16, v131
    v_lshlrev_b32 v15, 16, v132
    v_pk_add_f32 v[166:167], v[166:167], v[14:15]
    v_and_b32 v8, 0xffff0000, v132
    v_lshlrev_b32 v9, 16, v133
    v_pk_add_f32 v[168:169], v[168:169], v[8:9]
    v_and_b32 v10, 0xffff0000, v133
    v_lshlrev_b32 v11, 16, v134
    v_pk_add_f32 v[170:171], v[170:171], v[10:11]
    v_and_b32 v12, 0xffff0000, v134
    v_lshlrev_b32 v13, 16, v135
    v_pk_add_f32 v[172:173], v[172:173], v[12:13]
    v_lshlrev_b32 v14, 16, v136
    v_and_b32 v15, 0xffff0000, v136
    v_pk_add_f32 v[174:175], v[174:175], v[14:15]
    v_lshlrev_b32 v8, 16, v137
    v_and_b32 v9, 0xffff0000, v137
    v_pk_add_f32 v[176:177], v[176:177], v[8:9]
    v_lshlrev_b32 v10, 16, v138
    v_and_b32 v11, 0xffff0000, v138
    v_pk_add_f32 v[178:179], v[178:179], v[10:11]
    s_andn2_b32 s72, s72, 2
.f_h6:
    s_bitcmp1_b32 s73, 2
    s_cbranch_scc0 .f_h7
    v_cmp_eq_u32_sdwa s[70:71], v55, v147 src0_sel:WORD_1 src1_sel:WORD_1
    v_cmp_eq_u32_sdwa vcc, v55, v151 src0_sel:WORD_0 src1_sel:WORD_1
    s_and_b64 s[70:71], s[70:71], vcc
    v_cmp_eq_u32 vcc, v55, v155
    s_and_b64 s[70:71], s[70:71], vcc
    s_cmp_eq_u64 s[70:71], -1
    s_cbranch_scc0 .f_h7
    v_lshlrev_b32 v8, 16, v144
    v_and_b32 v9, 0xffff0000, v144
    v_pk_add_f32 v[160:161], v[160:161], v[8:9]
    v_lshlrev_b32 v10, 16, v145
    v_and_b32 v11, 0xffff0000, v145
    v_pk_add_f32 v[162:163], v[162:163], v[10:11]
    v_lshlrev_b32 v12, 16, v146
    v_and_b32 v13, 0xffff0000, v146
    v_pk_add_f32 v[164:165], v[164:165], v[12:13]
    v_lshlrev_b32 v14, 16, v147
    v_lshlrev_b32 v15, 16, v148
    v_pk_add_f32 v[166:167], v[166:167], v[14:15]
    v_and_b32 v8, 0xffff0000, v148
    v_lshlrev_b32 v9, 16, v149
    v_pk_add_f32 v[168:169], v[168:169], v[8:9]
    v_and_b32 v10, 0xffff0000, v149
    v_lshlrev_b32 v11, 16, v150
    v_pk_add_f32 v[170:171], v[170:171], v[10:11]
    v_and_b32 v12, 0xffff0000, v150
    v_lshlrev_b32 v13, 16, v151
    v_pk_add_f32 v[172:173], v[172:173], v[12:13]
    v_lshlrev_b32 v14, 16, v152
    v_and_b32 v15, 0xffff0000, v152
    v_pk_add_f32 v[174:175], v[174:175], v[14:15]
    v_lshlrev_b32 v8, 16, v153
    v_and_b32 v9, 0xffff0000, v153
    v_pk_add_f32 v[176:177], v[176:177], v[8:9]
    v_lshlrev_b32 v10, 16, v154
    v_and_b32 v11, 0xffff0000, v154
    v_pk_add_f32 v[178:179], v[178:179], v[10:11]
    s_andn2_b32 s72, s72, 4
.f_h7:
    s_sub_u32 s88, s88, 1
    s_cmp_eq_u32 s88, 0
    s_cbranch_scc1 .f_fin
.f_h8:
    s_cmp_lg_u32 s72, 0
    s_cbranch_scc1 .f_pl
.f_fin:
    s_cmp_ge_u32 s31, 2
    s_cbranch_scc1 .f_hi
    v_cvt_pk_bf16_f32 v12, v160, v161
    v_cvt_pk_bf16_f32 v14, v180, v181
    v_lshlrev_b32 v8, 16, v12
    v_and_b32 v9, 0xffff0000, v12
    v_pk_mul_f32 v[10:11], v[8:9], v[6:7] op_sel_hi:[1,0]
    v_exp_f32 v10, v10
    v_exp_f32 v11, v11
    v_lshlrev_b32 v12, 16, v14
    v_pk_add_f32 v[10:11], v[10:11], v[6:7] op_sel:[0,1]
    v_rcp_f32 v10, v10
    v_rcp_f32 v11, v11
    v_and_b32 v13, 0xffff0000, v14
    v_pk_mul_f32 v[8:9], v[8:9], v[10:11]
    v_cvt_pk_bf16_f32 v10, v8, v9
    v_lshlrev_b32 v8, 16, v10
    v_and_b32 v9, 0xffff0000, v10
    v_pk_mul_f32 v[8:9], v[8:9], v[12:13]
    v_cvt_pk_bf16_f32 v10, v8, v9
    v_lshlrev_b32 v8, 16, v10
    v_and_b32 v9, 0xffff0000, v10
    v_pk_add_f32 v[8:9], v[8:9], v[200:201]
    v_cvt_pk_bf16_f32 v64, v8, v9
    v_cvt_pk_bf16_f32 v20, v162, v163
    v_cvt_pk_bf16_f32 v22, v182, v183
    v_lshlrev_b32 v16, 16, v20
    v_and_b32 v17, 0xffff0000, v20
    v_pk_mul_f32 v[18:19], v[16:17], v[6:7] op_sel_hi:[1,0]
    v_exp_f32 v18, v18
    v_exp_f32 v19, v19
    v_lshlrev_b32 v20, 16, v22
    v_pk_add_f32 v[18:19], v[18:19], v[6:7] op_sel:[0,1]
    v_rcp_f32 v18, v18
    v_rcp_f32 v19, v19
    v_and_b32 v21, 0xffff0000, v22
    v_pk_mul_f32 v[16:17], v[16:17], v[18:19]
    v_cvt_pk_bf16_f32 v18, v16, v17
    v_lshlrev_b32 v16, 16, v18
    v_and_b32 v17, 0xffff0000, v18
    v_pk_mul_f32 v[16:17], v[16:17], v[20:21]
    v_cvt_pk_bf16_f32 v18, v16, v17
    v_lshlrev_b32 v16, 16, v18
    v_and_b32 v17, 0xffff0000, v18
    v_pk_add_f32 v[16:17], v[16:17], v[202:203]
    v_cvt_pk_bf16_f32 v65, v16, v17
    buffer_store_dwordx2 v[64:65], v2, s[48:51], 0 offen offset:0
    v_cvt_pk_bf16_f32 v12, v164, v165
    v_cvt_pk_bf16_f32 v14, v184, v185
    v_lshlrev_b32 v8, 16, v12
    v_and_b32 v9, 0xffff0000, v12
    v_pk_mul_f32 v[10:11], v[8:9], v[6:7] op_sel_hi:[1,0]
    v_exp_f32 v10, v10
    v_exp_f32 v11, v11
    v_lshlrev_b32 v12, 16, v14
    v_pk_add_f32 v[10:11], v[10:11], v[6:7] op_sel:[0,1]
    v_rcp_f32 v10, v10
    v_rcp_f32 v11, v11
    v_and_b32 v13, 0xffff0000, v14
    v_pk_mul_f32 v[8:9], v[8:9], v[10:11]
    v_cvt_pk_bf16_f32 v10, v8, v9
    v_lshlrev_b32 v8, 16, v10
    v_and_b32 v9, 0xffff0000, v10
    v_pk_mul_f32 v[8:9], v[8:9], v[12:13]
    v_cvt_pk_bf16_f32 v10, v8, v9
    v_lshlrev_b32 v8, 16, v10
    v_and_b32 v9, 0xffff0000, v10
    v_pk_add_f32 v[8:9], v[8:9], v[204:205]
    v_cvt_pk_bf16_f32 v66, v8, v9
    v_cvt_pk_bf16_f32 v20, v166, v167
    v_cvt_pk_bf16_f32 v22, v186, v187
    v_lshlrev_b32 v16, 16, v20
    v_and_b32 v17, 0xffff0000, v20
    v_pk_mul_f32 v[18:19], v[16:17], v[6:7] op_sel_hi:[1,0]
    v_exp_f32 v18, v18
    v_exp_f32 v19, v19
    v_lshlrev_b32 v20, 16, v22
    v_pk_add_f32 v[18:19], v[18:19], v[6:7] op_sel:[0,1]
    v_rcp_f32 v18, v18
    v_rcp_f32 v19, v19
    v_and_b32 v21, 0xffff0000, v22
    v_pk_mul_f32 v[16:17], v[16:17], v[18:19]
    v_cvt_pk_bf16_f32 v18, v16, v17
    v_lshlrev_b32 v16, 16, v18
    v_and_b32 v17, 0xffff0000, v18
    v_pk_mul_f32 v[16:17], v[16:17], v[20:21]
    v_cvt_pk_bf16_f32 v18, v16, v17
    v_lshlrev_b32 v16, 16, v18
    v_and_b32 v17, 0xffff0000, v18
    v_pk_add_f32 v[16:17], v[16:17], v[206:207]
    v_cvt_pk_bf16_f32 v67, v16, v17
    buffer_store_dwordx2 v[66:67], v2, s[48:51], 0 offen offset:32
    v_cvt_pk_bf16_f32 v12, v168, v169
    v_cvt_pk_bf16_f32 v14, v188, v189
    v_lshlrev_b32 v8, 16, v12
    v_and_b32 v9, 0xffff0000, v12
    v_pk_mul_f32 v[10:11], v[8:9], v[6:7] op_sel_hi:[1,0]
    v_exp_f32 v10, v10
    v_exp_f32 v11, v11
    v_lshlrev_b32 v12, 16, v14
    v_pk_add_f32 v[10:11], v[10:11], v[6:7] op_sel:[0,1]
    v_rcp_f32 v10, v10
    v_rcp_f32 v11, v11
    v_and_b32 v13, 0xffff0000, v14
    v_pk_mul_f32 v[8:9], v[8:9], v[10:11]
    v_cvt_pk_bf16_f32 v10, v8, v9
    v_lshlrev_b32 v8, 16, v10
    v_and_b32 v9, 0xffff0000, v10
    v_pk_mul_f32 v[8:9], v[8:9], v[12:13]
    v_cvt_pk_bf16_f32 v10, v8, v9
    v_lshlrev_b32 v8, 16, v10
    v_and_b32 v9, 0xffff0000, v10
    v_pk_add_f32 v[8:9], v[8:9], v[208:209]
    v_cvt_pk_bf16_f32 v68, v8, v9
    v_cvt_pk_bf16_f32 v20, v170, v171
    v_cvt_pk_bf16_f32 v22, v190, v191
    v_lshlrev_b32 v16, 16, v20
    v_and_b32 v17, 0xffff0000, v20
    v_pk_mul_f32 v[18:19], v[16:17], v[6:7] op_sel_hi:[1,0]
    v_exp_f32 v18, v18
    v_exp_f32 v19, v19
    v_lshlrev_b32 v20, 16, v22
    v_pk_add_f32 v[18:19], v[18:19], v[6:7] op_sel:[0,1]
    v_rcp_f32 v18, v18
    v_rcp_f32 v19, v19
    v_and_b32 v21, 0xffff0000, v22
    v_pk_mul_f32 v[16:17], v[16:17], v[18:19]
    v_cvt_pk_bf16_f32 v18, v16, v17
    v_lshlrev_b32 v16, 16, v18
    v_and_b32 v17, 0xffff0000, v18
    v_pk_mul_f32 v[16:17], v[16:17], v[20:21]
    v_cvt_pk_bf16_f32 v18, v16, v17
    v_lshlrev_b32 v16, 16, v18
    v_and_b32 v17, 0xffff0000, v18
    v_pk_add_f32 v[16:17], v[16:17], v[210:211]
    v_cvt_pk_bf16_f32 v69, v16, v17
    buffer_store_dwordx2 v[68:69], v2, s[48:51], 0 offen offset:64
    v_cvt_pk_bf16_f32 v12, v172, v173
    v_cvt_pk_bf16_f32 v14, v192, v193
    v_lshlrev_b32 v8, 16, v12
    v_and_b32 v9, 0xffff0000, v12
    v_pk_mul_f32 v[10:11], v[8:9], v[6:7] op_sel_hi:[1,0]
    v_exp_f32 v10, v10
    v_exp_f32 v11, v11
    v_lshlrev_b32 v12, 16, v14
    v_pk_add_f32 v[10:11], v[10:11], v[6:7] op_sel:[0,1]
    v_rcp_f32 v10, v10
    v_rcp_f32 v11, v11
    v_and_b32 v13, 0xffff0000, v14
    v_pk_mul_f32 v[8:9], v[8:9], v[10:11]
    v_cvt_pk_bf16_f32 v10, v8, v9
    v_lshlrev_b32 v8, 16, v10
    v_and_b32 v9, 0xffff0000, v10
    v_pk_mul_f32 v[8:9], v[8:9], v[12:13]
    v_cvt_pk_bf16_f32 v10, v8, v9
    v_lshlrev_b32 v8, 16, v10
    v_and_b32 v9, 0xffff0000, v10
    v_pk_add_f32 v[8:9], v[8:9], v[212:213]
    v_cvt_pk_bf16_f32 v70, v8, v9
    v_cvt_pk_bf16_f32 v20, v174, v175
    v_cvt_pk_bf16_f32 v22, v194, v195
    v_lshlrev_b32 v16, 16, v20
    v_and_b32 v17, 0xffff0000, v20
    v_pk_mul_f32 v[18:19], v[16:17], v[6:7] op_sel_hi:[1,0]
    v_exp_f32 v18, v18
    v_exp_f32 v19, v19
    v_lshlrev_b32 v20, 16, v22
    v_pk_add_f32 v[18:19], v[18:19], v[6:7] op_sel:[0,1]
    v_rcp_f32 v18, v18
    v_rcp_f32 v19, v19
    v_and_b32 v21, 0xffff0000, v22
    v_pk_mul_f32 v[16:17], v[16:17], v[18:19]
    v_cvt_pk_bf16_f32 v18, v16, v17
    v_lshlrev_b32 v16, 16, v18
    v_and_b32 v17, 0xffff0000, v18
    v_pk_mul_f32 v[16:17], v[16:17], v[20:21]
    v_cvt_pk_bf16_f32 v18, v16, v17
    v_lshlrev_b32 v16, 16, v18
    v_and_b32 v17, 0xffff0000, v18
    v_pk_add_f32 v[16:17], v[16:17], v[214:215]
    v_cvt_pk_bf16_f32 v71, v16, v17
    buffer_store_dwordx2 v[70:71], v2, s[48:51], 0 offen offset:96
    v_cvt_pk_bf16_f32 v12, v176, v177
    v_cvt_pk_bf16_f32 v14, v196, v197
    v_lshlrev_b32 v8, 16, v12
    v_and_b32 v9, 0xffff0000, v12
    v_pk_mul_f32 v[10:11], v[8:9], v[6:7] op_sel_hi:[1,0]
    v_exp_f32 v10, v10
    v_exp_f32 v11, v11
    v_lshlrev_b32 v12, 16, v14
    v_pk_add_f32 v[10:11], v[10:11], v[6:7] op_sel:[0,1]
    v_rcp_f32 v10, v10
    v_rcp_f32 v11, v11
    v_and_b32 v13, 0xffff0000, v14
    v_pk_mul_f32 v[8:9], v[8:9], v[10:11]
    v_cvt_pk_bf16_f32 v10, v8, v9
    v_lshlrev_b32 v8, 16, v10
    v_and_b32 v9, 0xffff0000, v10
    v_pk_mul_f32 v[8:9], v[8:9], v[12:13]
    v_cvt_pk_bf16_f32 v10, v8, v9
    v_lshlrev_b32 v8, 16, v10
    v_and_b32 v9, 0xffff0000, v10
    v_pk_add_f32 v[8:9], v[8:9], v[216:217]
    v_cvt_pk_bf16_f32 v72, v8, v9
    v_cvt_pk_bf16_f32 v20, v178, v179
    v_cvt_pk_bf16_f32 v22, v198, v199
    v_lshlrev_b32 v16, 16, v20
    v_and_b32 v17, 0xffff0000, v20
    v_pk_mul_f32 v[18:19], v[16:17], v[6:7] op_sel_hi:[1,0]
    v_exp_f32 v18, v18
    v_exp_f32 v19, v19
    v_lshlrev_b32 v20, 16, v22
    v_pk_add_f32 v[18:19], v[18:19], v[6:7] op_sel:[0,1]
    v_rcp_f32 v18, v18
    v_rcp_f32 v19, v19
    v_and_b32 v21, 0xffff0000, v22
    v_pk_mul_f32 v[16:17], v[16:17], v[18:19]
    v_cvt_pk_bf16_f32 v18, v16, v17
    v_lshlrev_b32 v16, 16, v18
    v_and_b32 v17, 0xffff0000, v18
    v_pk_mul_f32 v[16:17], v[16:17], v[20:21]
    v_cvt_pk_bf16_f32 v18, v16, v17
    v_lshlrev_b32 v16, 16, v18
    v_and_b32 v17, 0xffff0000, v18
    v_pk_add_f32 v[16:17], v[16:17], v[218:219]
    v_cvt_pk_bf16_f32 v73, v16, v17
    buffer_store_dwordx2 v[72:73], v2, s[48:51], 0 offen offset:128
    s_branch .f_end
.f_hi:
    v_cvt_pk_bf16_f32 v12, v180, v181
    v_cvt_pk_bf16_f32 v14, v160, v161
    v_lshlrev_b32 v8, 16, v12
    v_and_b32 v9, 0xffff0000, v12
    v_pk_mul_f32 v[10:11], v[8:9], v[6:7] op_sel_hi:[1,0]
    v_exp_f32 v10, v10
    v_exp_f32 v11, v11
    v_lshlrev_b32 v12, 16, v14
    v_pk_add_f32 v[10:11], v[10:11], v[6:7] op_sel:[0,1]
    v_rcp_f32 v10, v10
    v_rcp_f32 v11, v11
    v_and_b32 v13, 0xffff0000, v14
    v_pk_mul_f32 v[8:9], v[8:9], v[10:11]
    v_cvt_pk_bf16_f32 v10, v8, v9
    v_lshlrev_b32 v8, 16, v10
    v_and_b32 v9, 0xffff0000, v10
    v_pk_mul_f32 v[8:9], v[8:9], v[12:13]
    v_cvt_pk_bf16_f32 v10, v8, v9
    v_lshlrev_b32 v8, 16, v10
    v_and_b32 v9, 0xffff0000, v10
    v_pk_add_f32 v[8:9], v[8:9], v[200:201]
    v_cvt_pk_bf16_f32 v64, v8, v9
    v_cvt_pk_bf16_f32 v20, v182, v183
    v_cvt_pk_bf16_f32 v22, v162, v163
    v_lshlrev_b32 v16, 16, v20
    v_and_b32 v17, 0xffff0000, v20
    v_pk_mul_f32 v[18:19], v[16:17], v[6:7] op_sel_hi:[1,0]
    v_exp_f32 v18, v18
    v_exp_f32 v19, v19
    v_lshlrev_b32 v20, 16, v22
    v_pk_add_f32 v[18:19], v[18:19], v[6:7] op_sel:[0,1]
    v_rcp_f32 v18, v18
    v_rcp_f32 v19, v19
    v_and_b32 v21, 0xffff0000, v22
    v_pk_mul_f32 v[16:17], v[16:17], v[18:19]
    v_cvt_pk_bf16_f32 v18, v16, v17
    v_lshlrev_b32 v16, 16, v18
    v_and_b32 v17, 0xffff0000, v18
    v_pk_mul_f32 v[16:17], v[16:17], v[20:21]
    v_cvt_pk_bf16_f32 v18, v16, v17
    v_lshlrev_b32 v16, 16, v18
    v_and_b32 v17, 0xffff0000, v18
    v_pk_add_f32 v[16:17], v[16:17], v[202:203]
    v_cvt_pk_bf16_f32 v65, v16, v17
    buffer_store_dwordx2 v[64:65], v2, s[48:51], 0 offen offset:0
    v_cvt_pk_bf16_f32 v12, v184, v185
    v_cvt_pk_bf16_f32 v14, v164, v165
    v_lshlrev_b32 v8, 16, v12
    v_and_b32 v9, 0xffff0000, v12
    v_pk_mul_f32 v[10:11], v[8:9], v[6:7] op_sel_hi:[1,0]
    v_exp_f32 v10, v10
    v_exp_f32 v11, v11
    v_lshlrev_b32 v12, 16, v14
    v_pk_add_f32 v[10:11], v[10:11], v[6:7] op_sel:[0,1]
    v_rcp_f32 v10, v10
    v_rcp_f32 v11, v11
    v_and_b32 v13, 0xffff0000, v14
    v_pk_mul_f32 v[8:9], v[8:9], v[10:11]
    v_cvt_pk_bf16_f32 v10, v8, v9
    v_lshlrev_b32 v8, 16, v10
    v_and_b32 v9, 0xffff0000, v10
    v_pk_mul_f32 v[8:9], v[8:9], v[12:13]
    v_cvt_pk_bf16_f32 v10, v8, v9
    v_lshlrev_b32 v8, 16, v10
    v_and_b32 v9, 0xffff0000, v10
    v_pk_add_f32 v[8:9], v[8:9], v[204:205]
    v_cvt_pk_bf16_f32 v66, v8, v9
    v_cvt_pk_bf16_f32 v20, v186, v187
    v_cvt_pk_bf16_f32 v22, v166, v167
    v_lshlrev_b32 v16, 16, v20
    v_and_b32 v17, 0xffff0000, v20
    v_pk_mul_f32 v[18:19], v[16:17], v[6:7] op_sel_hi:[1,0]
    v_exp_f32 v18, v18
    v_exp_f32 v19, v19
    v_lshlrev_b32 v20, 16, v22
    v_pk_add_f32 v[18:19], v[18:19], v[6:7] op_sel:[0,1]
    v_rcp_f32 v18, v18
    v_rcp_f32 v19, v19
    v_and_b32 v21, 0xffff0000, v22
    v_pk_mul_f32 v[16:17], v[16:17], v[18:19]
    v_cvt_pk_bf16_f32 v18, v16, v17
    v_lshlrev_b32 v16, 16, v18
    v_and_b32 v17, 0xffff0000, v18
    v_pk_mul_f32 v[16:17], v[16:17], v[20:21]
    v_cvt_pk_bf16_f32 v18, v16, v17
    v_lshlrev_b32 v16, 16, v18
    v_and_b32 v17, 0xffff0000, v18
    v_pk_add_f32 v[16:17], v[16:17], v[206:207]
    v_cvt_pk_bf16_f32 v67, v16, v17
    buffer_store_dwordx2 v[66:67], v2, s[48:51], 0 offen offset:32
    v_cvt_pk_bf16_f32 v12, v188, v189
    v_cvt_pk_bf16_f32 v14, v168, v169
    v_lshlrev_b32 v8, 16, v12
    v_and_b32 v9, 0xffff0000, v12
    v_pk_mul_f32 v[10:11], v[8:9], v[6:7] op_sel_hi:[1,0]
    v_exp_f32 v10, v10
    v_exp_f32 v11, v11
    v_lshlrev_b32 v12, 16, v14
    v_pk_add_f32 v[10:11], v[10:11], v[6:7] op_sel:[0,1]
    v_rcp_f32 v10, v10
    v_rcp_f32 v11, v11
    v_and_b32 v13, 0xffff0000, v14
    v_pk_mul_f32 v[8:9], v[8:9], v[10:11]
    v_cvt_pk_bf16_f32 v10, v8, v9
    v_lshlrev_b32 v8, 16, v10
    v_and_b32 v9, 0xffff0000, v10
    v_pk_mul_f32 v[8:9], v[8:9], v[12:13]
    v_cvt_pk_bf16_f32 v10, v8, v9
    v_lshlrev_b32 v8, 16, v10
    v_and_b32 v9, 0xffff0000, v10
    v_pk_add_f32 v[8:9], v[8:9], v[208:209]
    v_cvt_pk_bf16_f32 v68, v8, v9
    v_cvt_pk_bf16_f32 v20, v190, v191
    v_cvt_pk_bf16_f32 v22, v170, v171
    v_lshlrev_b32 v16, 16, v20
    v_and_b32 v17, 0xffff0000, v20
    v_pk_mul_f32 v[18:19], v[16:17], v[6:7] op_sel_hi:[1,0]
    v_exp_f32 v18, v18
    v_exp_f32 v19, v19
    v_lshlrev_b32 v20, 16, v22
    v_pk_add_f32 v[18:19], v[18:19], v[6:7] op_sel:[0,1]
    v_rcp_f32 v18, v18
    v_rcp_f32 v19, v19
    v_and_b32 v21, 0xffff0000, v22
    v_pk_mul_f32 v[16:17], v[16:17], v[18:19]
    v_cvt_pk_bf16_f32 v18, v16, v17
    v_lshlrev_b32 v16, 16, v18
    v_and_b32 v17, 0xffff0000, v18
    v_pk_mul_f32 v[16:17], v[16:17], v[20:21]
    v_cvt_pk_bf16_f32 v18, v16, v17
    v_lshlrev_b32 v16, 16, v18
    v_and_b32 v17, 0xffff0000, v18
    v_pk_add_f32 v[16:17], v[16:17], v[210:211]
    v_cvt_pk_bf16_f32 v69, v16, v17
    buffer_store_dwordx2 v[68:69], v2, s[48:51], 0 offen offset:64
    v_cvt_pk_bf16_f32 v12, v192, v193
    v_cvt_pk_bf16_f32 v14, v172, v173
    v_lshlrev_b32 v8, 16, v12
    v_and_b32 v9, 0xffff0000, v12
    v_pk_mul_f32 v[10:11], v[8:9], v[6:7] op_sel_hi:[1,0]
    v_exp_f32 v10, v10
    v_exp_f32 v11, v11
    v_lshlrev_b32 v12, 16, v14
    v_pk_add_f32 v[10:11], v[10:11], v[6:7] op_sel:[0,1]
    v_rcp_f32 v10, v10
    v_rcp_f32 v11, v11
    v_and_b32 v13, 0xffff0000, v14
    v_pk_mul_f32 v[8:9], v[8:9], v[10:11]
    v_cvt_pk_bf16_f32 v10, v8, v9
    v_lshlrev_b32 v8, 16, v10
    v_and_b32 v9, 0xffff0000, v10
    v_pk_mul_f32 v[8:9], v[8:9], v[12:13]
    v_cvt_pk_bf16_f32 v10, v8, v9
    v_lshlrev_b32 v8, 16, v10
    v_and_b32 v9, 0xffff0000, v10
    v_pk_add_f32 v[8:9], v[8:9], v[212:213]
    v_cvt_pk_bf16_f32 v70, v8, v9
    v_cvt_pk_bf16_f32 v20, v194, v195
    v_cvt_pk_bf16_f32 v22, v174, v175
    v_lshlrev_b32 v16, 16, v20
    v_and_b32 v17, 0xffff0000, v20
    v_pk_mul_f32 v[18:19], v[16:17], v[6:7] op_sel_hi:[1,0]
    v_exp_f32 v18, v18
    v_exp_f32 v19, v19
    v_lshlrev_b32 v20, 16, v22
    v_pk_add_f32 v[18:19], v[18:19], v[6:7] op_sel:[0,1]
    v_rcp_f32 v18, v18
    v_rcp_f32 v19, v19
    v_and_b32 v21, 0xffff0000, v22
    v_pk_mul_f32 v[16:17], v[16:17], v[18:19]
    v_cvt_pk_bf16_f32 v18, v16, v17
    v_lshlrev_b32 v16, 16, v18
    v_and_b32 v17, 0xffff0000, v18
    v_pk_mul_f32 v[16:17], v[16:17], v[20:21]
    v_cvt_pk_bf16_f32 v18, v16, v17
    v_lshlrev_b32 v16, 16, v18
    v_and_b32 v17, 0xffff0000, v18
    v_pk_add_f32 v[16:17], v[16:17], v[214:215]
    v_cvt_pk_bf16_f32 v71, v16, v17
    buffer_store_dwordx2 v[70:71], v2, s[48:51], 0 offen offset:96
    v_cvt_pk_bf16_f32 v12, v196, v197
    v_cvt_pk_bf16_f32 v14, v176, v177
    v_lshlrev_b32 v8, 16, v12
    v_and_b32 v9, 0xffff0000, v12
    v_pk_mul_f32 v[10:11], v[8:9], v[6:7] op_sel_hi:[1,0]
    v_exp_f32 v10, v10
    v_exp_f32 v11, v11
    v_lshlrev_b32 v12, 16, v14
    v_pk_add_f32 v[10:11], v[10:11], v[6:7] op_sel:[0,1]
    v_rcp_f32 v10, v10
    v_rcp_f32 v11, v11
    v_and_b32 v13, 0xffff0000, v14
    v_pk_mul_f32 v[8:9], v[8:9], v[10:11]
    v_cvt_pk_bf16_f32 v10, v8, v9
    v_lshlrev_b32 v8, 16, v10
    v_and_b32 v9, 0xffff0000, v10
    v_pk_mul_f32 v[8:9], v[8:9], v[12:13]
    v_cvt_pk_bf16_f32 v10, v8, v9
    v_lshlrev_b32 v8, 16, v10
    v_and_b32 v9, 0xffff0000, v10
    v_pk_add_f32 v[8:9], v[8:9], v[216:217]
    v_cvt_pk_bf16_f32 v72, v8, v9
    v_cvt_pk_bf16_f32 v20, v198, v199
    v_cvt_pk_bf16_f32 v22, v178, v179
    v_lshlrev_b32 v16, 16, v20
    v_and_b32 v17, 0xffff0000, v20
    v_pk_mul_f32 v[18:19], v[16:17], v[6:7] op_sel_hi:[1,0]
    v_exp_f32 v18, v18
    v_exp_f32 v19, v19
    v_lshlrev_b32 v20, 16, v22
    v_pk_add_f32 v[18:19], v[18:19], v[6:7] op_sel:[0,1]
    v_rcp_f32 v18, v18
    v_rcp_f32 v19, v19
    v_and_b32 v21, 0xffff0000, v22
    v_pk_mul_f32 v[16:17], v[16:17], v[18:19]
    v_cvt_pk_bf16_f32 v18, v16, v17
    v_lshlrev_b32 v16, 16, v18
    v_and_b32 v17, 0xffff0000, v18
    v_pk_mul_f32 v[16:17], v[16:17], v[20:21]
    v_cvt_pk_bf16_f32 v18, v16, v17
    v_lshlrev_b32 v16, 16, v18
    v_and_b32 v17, 0xffff0000, v18
    v_pk_add_f32 v[16:17], v[16:17], v[218:219]
    v_cvt_pk_bf16_f32 v73, v16, v17
    buffer_store_dwordx2 v[72:73], v2, s[48:51], 0 offen offset:128
.f_end:
    s_waitcnt vmcnt(0)
    s_endpgm
.f_cons:
    s_getpc_b64 s[72:73]
.f_pc2:
    s_sub_u32 s72, s72, .f_pc2-recurrent_scan__spectral_fnet__glu_gated_geglu__prompt_kernel
    s_subb_u32 s73, s73, 0
    s_lshr_b32 s70, s2, 3
    s_lshl_b32 s70, s70, 2
    s_add_u32 s70, s70, s28
    s_mul_i32 s71, s70, 6554
    s_lshr_b32 s71, s71, 16
    s_mul_i32 s71, s71, 10
    s_sub_u32 s70, s70, s71
    s_lshl_b32 s70, s70, 12
    v_lshl_add_u32 v54, v1, 6, s70
    v_min_u32 v54, .f_done-recurrent_scan__spectral_fnet__glu_gated_geglu__prompt_kernel, v54
    global_load_dword v255, v54, s[72:73]
    s_and_b32 s34, s28, 1
    s_lshr_b32 s35, s28, 1
    v_and_b32 v12, 15, v1
    v_lshlrev_b32 v12, 7, v12
    v_lshrrev_b32 v14, 4, v1
    v_and_b32 v13, 7, v1
    v_xor_b32 v13, v13, v14
    v_lshl_add_u32 v12, v13, 4, v12
    v_xor_b32 v13, 64, v12
    s_lshl_b32 s40, s34, 13
    s_lshl_b32 s41, s35, 12
    s_add_u32 s42, s40, s41
    s_xor_b32 s43, s42, 4096
    s_add_u32 s41, s41, 81920
    v_add_u32 v2, s42, v12
    v_add_u32 v3, s43, v12
    v_add_u32 v6, s41, v12
    v_add_u32 v8, 90112, v12
    v_add_u32 v4, s42, v13
    v_add_u32 v5, s43, v13
    v_add_u32 v7, s41, v13
    v_add_u32 v9, 90112, v13
    v_bfe_u32 v15, v1, 2, 2
    v_lshl_add_u32 v15, v14, 3, v15
    v_mul_u32_u24 v15, 192, v15
    v_and_b32 v16, 3, v1
    v_lshl_add_u32 v15, v16, 3, v15
    v_and_b32 v16, 1, v14
    s_mul_i32 s40, s35, 3
    v_xor_b32 v17, s40, v16
    v_lshl_add_u32 v88, v17, 5, v15
    v_add_u32 v88, 81920, v88
    s_add_u32 s40, s40, 1
    v_xor_b32 v17, s40, v16
    v_lshl_add_u32 v89, v17, 5, v15
    v_add_u32 v89, 81888, v89
    s_add_u32 s40, s40, 1
    s_lshl_b32 s40, s34, 8
    s_lshl_b32 s41, s35, 7
    s_add_u32 s42, s40, s41
    s_add_u32 s42, s42, 155648
    v_lshl_add_u32 v10, v14, 4, s42
    v_and_b32 v11, 15, v1
    v_lshlrev_b32 v11, 4, v11
    v_lshrrev_b32 v15, 1, v14
    v_lshl_add_u32 v11, v15, 8, v11
    v_and_b32 v15, 1, v14
    v_lshl_add_u32 v11, v15, 9, v11
    v_mov_b32 v248, 0x3f803f80
    v_mov_b32 v249, 0x3f803f80
    v_mov_b32 v250, 0x3f803f80
    v_mov_b32 v251, 0x3f803f80
    s_waitcnt lgkmcnt(0)
    s_mul_i32 s40, s29, 393216
    s_lshl_b32 s41, s34, 12
    s_add_u32 s40, s40, s41
    s_add_u32 s40, s40, 6291456
    s_add_u32 s44, s26, s40
    s_addc_u32 s45, s27, 0
    s_and_b32 s45, s45, 0xffff
    s_mov_b32 s46, 393216
    s_mov_b32 s47, 0x20000
    s_mul_i32 s40, s30, 6
    s_mul_i32 s41, s35, 3
    s_add_u32 s40, s40, s41
    s_lshr_b32 s56, s40, 1
    s_lshl_b32 s56, s56, 13
    s_and_b32 s41, s40, 1
    s_lshl_b32 s41, s41, 9
    s_add_u32 s56, s56, s41
    s_add_u32 s40, s40, 1
    s_lshr_b32 s57, s40, 1
    s_lshl_b32 s57, s57, 13
    s_and_b32 s41, s40, 1
    s_lshl_b32 s41, s41, 9
    s_add_u32 s57, s57, s41
    s_add_u32 s40, s40, 1
    s_lshr_b32 s58, s40, 1
    s_lshl_b32 s58, s58, 13
    s_and_b32 s41, s40, 1
    s_lshl_b32 s41, s41, 9
    s_add_u32 s58, s58, s41
    s_add_u32 s40, s40, 1
    s_lshr_b32 s40, s30, 1
    s_mul_i32 s40, s40, 655360
    s_lshl_b32 s41, s29, 1
    s_add_u32 s41, s41, s34
    s_mul_i32 s41, s41, 20480
    s_add_u32 s40, s40, s41
    s_and_b32 s41, s30, 1
    s_mul_i32 s41, s41, 5120
    s_add_u32 s40, s40, s41
    s_add_u32 s40, s40, 0
    s_add_u32 s48, s26, s40
    s_addc_u32 s49, s27, 0
    s_and_b32 s49, s49, 0xffff
    s_mov_b32 s50, 15360
    s_mov_b32 s51, 0x20000
    s_mul_i32 s63, s35, 10240
    s_lshl_b32 s41, s35, 11
    s_add_u32 s59, s63, s41
    s_sub_u32 s60, 10240, s63
    s_add_u32 s60, s60, s41
    s_add_u32 s63, s63, 4096
    s_add_u32 s52, s26, 5242880
    s_addc_u32 s53, s27, 0
    s_and_b32 s53, s53, 0xffff
    s_mov_b32 s54, 1048576
    s_mov_b32 s55, 0x20000
    s_bfe_u32 s61, s30, 0x20001
    s_lshl_b32 s61, s61, 1
    s_lshr_b32 s41, s30, 3
    s_add_u32 s61, s61, s41
    s_lshl_b32 s61, s61, 4
    s_add_u32 s61, s61, s29
    s_lshl_b32 s61, s61, 1
    s_and_b32 s41, s30, 1
    s_add_u32 s61, s61, s41
    s_lshl_b32 s61, s61, 5
    s_add_u32 s61, s61, 393216
    s_lshl_b32 s62, s29, 4
    s_add_u32 s62, s62, s30
    s_lshl_b32 s62, s62, 5
    s_add_u32 s62, s62, 458752
    s_lshl_b32 s40, s29, 2
    s_add_u32 s40, s40, s32
    s_lshl_b32 s40, s40, 4
    s_add_u32 s40, s40, s28
    s_mul_i32 s40, s40, 20480
    s_add_u32 s40, s40, 41943040
    s_add_u32 s64, s26, s40
    s_addc_u32 s65, s27, 0
    s_and_b32 s65, s65, 0xffff
    s_mov_b32 s66, 266240
    s_mov_b32 s67, 0x20000
    s_mov_b32 s68, 0x00f0000f
    s_mov_b32 s69, 0xf0000f00
    s_mov_b32 s70, 0x22222222
    s_mov_b32 s71, 0x22222222
    s_mov_b32 s72, 0x44444444
    s_mov_b32 s73, 0x44444444
    s_mov_b32 s74, 0x88888888
    s_mov_b32 s75, 0x88888888
    s_lshl_b32 s76, s34, 9
    s_lshl_b32 s41, s35, 8
    s_add_u32 s76, s76, s41
    s_add_u32 s76, s76, 159744
    s_barrier
    ds_read_b128 v[28:31], v6 offset:24576
    ds_read_b128 v[12:15], v2 offset:0
    ds_read_b128 v[16:19], v2 offset:2048
    ds_read_b128 v[20:23], v3 offset:0
    ds_read_b128 v[24:27], v3 offset:2048
    ds_read_b128 v[32:35], v6 offset:26624
    ds_read_b128 v[36:39], v8 offset:24576
    s_waitcnt lgkmcnt(5)
    v_mfma_f32_16x16x32_bf16 v[188:191], v[12:15], v[28:31], 0
    ds_read_b128 v[68:71], v7 offset:24576
    s_waitcnt lgkmcnt(5)
    v_mfma_f32_16x16x32_bf16 v[192:195], v[16:19], v[28:31], 0
    ds_read_b128 v[52:55], v4 offset:0
    s_waitcnt lgkmcnt(5)
    v_mfma_f32_16x16x32_bf16 v[196:199], v[20:23], v[28:31], 0
    ds_read_b128 v[56:59], v4 offset:2048
    s_waitcnt lgkmcnt(5)
    v_mfma_f32_16x16x32_bf16 v[200:203], v[24:27], v[28:31], 0
    ds_read_b128 v[60:63], v5 offset:0
    v_mfma_f32_16x16x32_bf16 v[240:243], v[248:251], v[12:15], 0
    ds_read_b128 v[64:67], v5 offset:2048
    v_mfma_f32_16x16x32_bf16 v[180:183], v[12:15], v[12:15], 0
    ds_read_b128 v[72:75], v7 offset:26624
    v_mfma_f32_16x16x32_bf16 v[244:247], v[248:251], v[16:19], 0
    ds_read_b128 v[76:79], v9 offset:24576
    v_mfma_f32_16x16x32_bf16 v[184:187], v[16:19], v[16:19], 0
    v_mfma_f32_16x16x32_bf16 v[228:231], v[248:251], v[28:31], 0
    s_waitcnt lgkmcnt(8)
    v_mfma_f32_16x16x32_bf16 v[204:207], v[12:15], v[32:35], 0
    v_mfma_f32_16x16x32_bf16 v[208:211], v[16:19], v[32:35], 0
    v_mfma_f32_16x16x32_bf16 v[212:215], v[20:23], v[32:35], 0
    v_mfma_f32_16x16x32_bf16 v[216:219], v[24:27], v[32:35], 0
    v_mfma_f32_16x16x32_bf16 v[232:235], v[248:251], v[32:35], 0
    s_waitcnt lgkmcnt(7)
    v_mfma_f32_16x16x32_bf16 v[220:223], v[12:15], v[36:39], 0
    v_mfma_f32_16x16x32_bf16 v[224:227], v[16:19], v[36:39], 0
    v_mfma_f32_16x16x32_bf16 v[236:239], v[248:251], v[36:39], 0
    s_waitcnt lgkmcnt(5)
    v_mfma_f32_16x16x32_bf16 v[188:191], v[52:55], v[68:71], v[188:191]
    s_waitcnt lgkmcnt(0)
    s_barrier
    ds_read_b128 v[28:31], v6 offset:34816
    v_mfma_f32_16x16x32_bf16 v[192:195], v[56:59], v[68:71], v[192:195]
    ds_read_b128 v[12:15], v2 offset:16384
    v_mfma_f32_16x16x32_bf16 v[196:199], v[60:63], v[68:71], v[196:199]
    ds_read_b128 v[16:19], v2 offset:18432
    v_mfma_f32_16x16x32_bf16 v[200:203], v[64:67], v[68:71], v[200:203]
    ds_read_b128 v[20:23], v3 offset:16384
    v_mfma_f32_16x16x32_bf16 v[240:243], v[248:251], v[52:55], v[240:243]
    ds_read_b128 v[24:27], v3 offset:18432
    v_mfma_f32_16x16x32_bf16 v[180:183], v[52:55], v[52:55], v[180:183]
    ds_read_b128 v[32:35], v6 offset:36864
    v_mfma_f32_16x16x32_bf16 v[244:247], v[248:251], v[56:59], v[244:247]
    ds_read_b128 v[36:39], v8 offset:34816
    v_mfma_f32_16x16x32_bf16 v[184:187], v[56:59], v[56:59], v[184:187]
    v_mfma_f32_16x16x32_bf16 v[228:231], v[248:251], v[68:71], v[228:231]
    v_mfma_f32_16x16x32_bf16 v[204:207], v[52:55], v[72:75], v[204:207]
    v_mfma_f32_16x16x32_bf16 v[208:211], v[56:59], v[72:75], v[208:211]
    v_mfma_f32_16x16x32_bf16 v[212:215], v[60:63], v[72:75], v[212:215]
    v_mfma_f32_16x16x32_bf16 v[216:219], v[64:67], v[72:75], v[216:219]
    v_mfma_f32_16x16x32_bf16 v[232:235], v[248:251], v[72:75], v[232:235]
    v_mfma_f32_16x16x32_bf16 v[220:223], v[52:55], v[76:79], v[220:223]
    v_mfma_f32_16x16x32_bf16 v[224:227], v[56:59], v[76:79], v[224:227]
    v_mfma_f32_16x16x32_bf16 v[236:239], v[248:251], v[76:79], v[236:239]
    s_waitcnt lgkmcnt(5)
    v_mfma_f32_16x16x32_bf16 v[188:191], v[12:15], v[28:31], v[188:191]
    ds_read_b128 v[68:71], v7 offset:34816
    s_waitcnt lgkmcnt(5)
    v_mfma_f32_16x16x32_bf16 v[192:195], v[16:19], v[28:31], v[192:195]
    ds_read_b128 v[52:55], v4 offset:16384
    s_waitcnt lgkmcnt(5)
    v_mfma_f32_16x16x32_bf16 v[196:199], v[20:23], v[28:31], v[196:199]
    ds_read_b128 v[56:59], v4 offset:18432
    s_waitcnt lgkmcnt(5)
    v_mfma_f32_16x16x32_bf16 v[200:203], v[24:27], v[28:31], v[200:203]
    ds_read_b128 v[60:63], v5 offset:16384
    v_mfma_f32_16x16x32_bf16 v[240:243], v[248:251], v[12:15], v[240:243]
    ds_read_b128 v[64:67], v5 offset:18432
    v_mfma_f32_16x16x32_bf16 v[180:183], v[12:15], v[12:15], v[180:183]
    ds_read_b128 v[72:75], v7 offset:36864
    v_mfma_f32_16x16x32_bf16 v[244:247], v[248:251], v[16:19], v[244:247]
    ds_read_b128 v[76:79], v9 offset:34816
    v_mfma_f32_16x16x32_bf16 v[184:187], v[16:19], v[16:19], v[184:187]
    v_mfma_f32_16x16x32_bf16 v[228:231], v[248:251], v[28:31], v[228:231]
    s_waitcnt lgkmcnt(8)
    v_mfma_f32_16x16x32_bf16 v[204:207], v[12:15], v[32:35], v[204:207]
    v_mfma_f32_16x16x32_bf16 v[208:211], v[16:19], v[32:35], v[208:211]
    v_mfma_f32_16x16x32_bf16 v[212:215], v[20:23], v[32:35], v[212:215]
    v_mfma_f32_16x16x32_bf16 v[216:219], v[24:27], v[32:35], v[216:219]
    v_mfma_f32_16x16x32_bf16 v[232:235], v[248:251], v[32:35], v[232:235]
    s_waitcnt lgkmcnt(7)
    v_mfma_f32_16x16x32_bf16 v[220:223], v[12:15], v[36:39], v[220:223]
    v_mfma_f32_16x16x32_bf16 v[224:227], v[16:19], v[36:39], v[224:227]
    v_mfma_f32_16x16x32_bf16 v[236:239], v[248:251], v[36:39], v[236:239]
    s_waitcnt lgkmcnt(5)
    v_mfma_f32_16x16x32_bf16 v[188:191], v[52:55], v[68:71], v[188:191]
    s_waitcnt lgkmcnt(0)
    s_barrier
    ds_read_b128 v[28:31], v6 offset:0
    v_mfma_f32_16x16x32_bf16 v[192:195], v[56:59], v[68:71], v[192:195]
    ds_read_b128 v[12:15], v2 offset:32768
    v_mfma_f32_16x16x32_bf16 v[196:199], v[60:63], v[68:71], v[196:199]
    ds_read_b128 v[16:19], v2 offset:34816
    v_mfma_f32_16x16x32_bf16 v[200:203], v[64:67], v[68:71], v[200:203]
    ds_read_b128 v[20:23], v3 offset:32768
    v_mfma_f32_16x16x32_bf16 v[240:243], v[248:251], v[52:55], v[240:243]
    ds_read_b128 v[24:27], v3 offset:34816
    v_mfma_f32_16x16x32_bf16 v[180:183], v[52:55], v[52:55], v[180:183]
    ds_read_b128 v[32:35], v6 offset:2048
    v_mfma_f32_16x16x32_bf16 v[244:247], v[248:251], v[56:59], v[244:247]
    ds_read_b128 v[36:39], v8 offset:0
    v_mfma_f32_16x16x32_bf16 v[184:187], v[56:59], v[56:59], v[184:187]
    v_mfma_f32_16x16x32_bf16 v[228:231], v[248:251], v[68:71], v[228:231]
    v_mfma_f32_16x16x32_bf16 v[204:207], v[52:55], v[72:75], v[204:207]
    v_mfma_f32_16x16x32_bf16 v[208:211], v[56:59], v[72:75], v[208:211]
    v_mfma_f32_16x16x32_bf16 v[212:215], v[60:63], v[72:75], v[212:215]
    v_mfma_f32_16x16x32_bf16 v[216:219], v[64:67], v[72:75], v[216:219]
    v_mfma_f32_16x16x32_bf16 v[232:235], v[248:251], v[72:75], v[232:235]
    v_mfma_f32_16x16x32_bf16 v[220:223], v[52:55], v[76:79], v[220:223]
    v_mfma_f32_16x16x32_bf16 v[224:227], v[56:59], v[76:79], v[224:227]
    v_mfma_f32_16x16x32_bf16 v[236:239], v[248:251], v[76:79], v[236:239]
    s_waitcnt lgkmcnt(5)
    v_mfma_f32_16x16x32_bf16 v[188:191], v[12:15], v[28:31], v[188:191]
    ds_read_b128 v[68:71], v7 offset:0
    s_waitcnt lgkmcnt(5)
    v_mfma_f32_16x16x32_bf16 v[192:195], v[16:19], v[28:31], v[192:195]
    ds_read_b128 v[52:55], v4 offset:32768
    s_waitcnt lgkmcnt(5)
    v_mfma_f32_16x16x32_bf16 v[196:199], v[20:23], v[28:31], v[196:199]
    ds_read_b128 v[56:59], v4 offset:34816
    s_waitcnt lgkmcnt(5)
    v_mfma_f32_16x16x32_bf16 v[200:203], v[24:27], v[28:31], v[200:203]
    ds_read_b128 v[60:63], v5 offset:32768
    v_mfma_f32_16x16x32_bf16 v[240:243], v[248:251], v[12:15], v[240:243]
    ds_read_b128 v[64:67], v5 offset:34816
    v_mfma_f32_16x16x32_bf16 v[180:183], v[12:15], v[12:15], v[180:183]
    ds_read_b128 v[72:75], v7 offset:2048
    v_mfma_f32_16x16x32_bf16 v[244:247], v[248:251], v[16:19], v[244:247]
    ds_read_b128 v[76:79], v9 offset:0
    v_add_u32 v2, 49152, v2
    v_mfma_f32_16x16x32_bf16 v[184:187], v[16:19], v[16:19], v[184:187]
    v_add_u32 v3, 49152, v3
    v_add_u32 v4, 49152, v4
    v_mfma_f32_16x16x32_bf16 v[228:231], v[248:251], v[28:31], v[228:231]
    v_add_u32 v5, 49152, v5
    s_waitcnt lgkmcnt(8)
    v_mfma_f32_16x16x32_bf16 v[204:207], v[12:15], v[32:35], v[204:207]
    v_mfma_f32_16x16x32_bf16 v[208:211], v[16:19], v[32:35], v[208:211]
    v_mfma_f32_16x16x32_bf16 v[212:215], v[20:23], v[32:35], v[212:215]
    v_mfma_f32_16x16x32_bf16 v[216:219], v[24:27], v[32:35], v[216:219]
    v_mfma_f32_16x16x32_bf16 v[232:235], v[248:251], v[32:35], v[232:235]
    s_waitcnt lgkmcnt(7)
    v_mfma_f32_16x16x32_bf16 v[220:223], v[12:15], v[36:39], v[220:223]
    v_mfma_f32_16x16x32_bf16 v[224:227], v[16:19], v[36:39], v[224:227]
    v_mfma_f32_16x16x32_bf16 v[236:239], v[248:251], v[36:39], v[236:239]
    s_waitcnt lgkmcnt(5)
    v_mfma_f32_16x16x32_bf16 v[188:191], v[52:55], v[68:71], v[188:191]
    s_waitcnt lgkmcnt(0)
    s_barrier
    ds_read_b128 v[28:31], v6 offset:10240
    v_mfma_f32_16x16x32_bf16 v[192:195], v[56:59], v[68:71], v[192:195]
    ds_read_b128 v[12:15], v2 offset:0
    v_mfma_f32_16x16x32_bf16 v[196:199], v[60:63], v[68:71], v[196:199]
    ds_read_b128 v[16:19], v2 offset:2048
    v_mfma_f32_16x16x32_bf16 v[200:203], v[64:67], v[68:71], v[200:203]
    ds_read_b128 v[20:23], v3 offset:0
    v_mfma_f32_16x16x32_bf16 v[240:243], v[248:251], v[52:55], v[240:243]
    ds_read_b128 v[24:27], v3 offset:2048
    v_mfma_f32_16x16x32_bf16 v[180:183], v[52:55], v[52:55], v[180:183]
    ds_read_b128 v[32:35], v6 offset:12288
    v_mfma_f32_16x16x32_bf16 v[244:247], v[248:251], v[56:59], v[244:247]
    ds_read_b128 v[36:39], v8 offset:10240
    v_mfma_f32_16x16x32_bf16 v[184:187], v[56:59], v[56:59], v[184:187]
    v_mfma_f32_16x16x32_bf16 v[228:231], v[248:251], v[68:71], v[228:231]
    v_mfma_f32_16x16x32_bf16 v[204:207], v[52:55], v[72:75], v[204:207]
    v_mfma_f32_16x16x32_bf16 v[208:211], v[56:59], v[72:75], v[208:211]
    v_mfma_f32_16x16x32_bf16 v[212:215], v[60:63], v[72:75], v[212:215]
    v_mfma_f32_16x16x32_bf16 v[216:219], v[64:67], v[72:75], v[216:219]
    v_mfma_f32_16x16x32_bf16 v[232:235], v[248:251], v[72:75], v[232:235]
    v_mfma_f32_16x16x32_bf16 v[220:223], v[52:55], v[76:79], v[220:223]
    v_mfma_f32_16x16x32_bf16 v[224:227], v[56:59], v[76:79], v[224:227]
    v_mfma_f32_16x16x32_bf16 v[236:239], v[248:251], v[76:79], v[236:239]
    s_waitcnt lgkmcnt(5)
    v_mfma_f32_16x16x32_bf16 v[188:191], v[12:15], v[28:31], v[188:191]
    ds_read_b128 v[68:71], v7 offset:10240
    s_waitcnt lgkmcnt(5)
    v_mfma_f32_16x16x32_bf16 v[192:195], v[16:19], v[28:31], v[192:195]
    ds_read_b128 v[52:55], v4 offset:0
    s_waitcnt lgkmcnt(5)
    v_mfma_f32_16x16x32_bf16 v[196:199], v[20:23], v[28:31], v[196:199]
    ds_read_b128 v[56:59], v4 offset:2048
    s_waitcnt lgkmcnt(5)
    v_mfma_f32_16x16x32_bf16 v[200:203], v[24:27], v[28:31], v[200:203]
    ds_read_b128 v[60:63], v5 offset:0
    v_mfma_f32_16x16x32_bf16 v[240:243], v[248:251], v[12:15], v[240:243]
    ds_read_b128 v[64:67], v5 offset:2048
    v_mfma_f32_16x16x32_bf16 v[180:183], v[12:15], v[12:15], v[180:183]
    ds_read_b128 v[72:75], v7 offset:12288
    v_mfma_f32_16x16x32_bf16 v[244:247], v[248:251], v[16:19], v[244:247]
    ds_read_b128 v[76:79], v9 offset:10240
    v_mfma_f32_16x16x32_bf16 v[184:187], v[16:19], v[16:19], v[184:187]
    v_mfma_f32_16x16x32_bf16 v[228:231], v[248:251], v[28:31], v[228:231]
    s_waitcnt lgkmcnt(8)
    v_mfma_f32_16x16x32_bf16 v[204:207], v[12:15], v[32:35], v[204:207]
    v_mfma_f32_16x16x32_bf16 v[208:211], v[16:19], v[32:35], v[208:211]
    v_mfma_f32_16x16x32_bf16 v[212:215], v[20:23], v[32:35], v[212:215]
    v_mfma_f32_16x16x32_bf16 v[216:219], v[24:27], v[32:35], v[216:219]
    v_mfma_f32_16x16x32_bf16 v[232:235], v[248:251], v[32:35], v[232:235]
    s_waitcnt lgkmcnt(7)
    v_mfma_f32_16x16x32_bf16 v[220:223], v[12:15], v[36:39], v[220:223]
    v_mfma_f32_16x16x32_bf16 v[224:227], v[16:19], v[36:39], v[224:227]
    v_mfma_f32_16x16x32_bf16 v[236:239], v[248:251], v[36:39], v[236:239]
    s_waitcnt lgkmcnt(5)
    v_mfma_f32_16x16x32_bf16 v[188:191], v[52:55], v[68:71], v[188:191]
    s_waitcnt lgkmcnt(0)
    s_barrier
    ds_read_b128 v[28:31], v6 offset:49152
    v_mfma_f32_16x16x32_bf16 v[192:195], v[56:59], v[68:71], v[192:195]
    ds_read_b128 v[12:15], v2 offset:16384
    v_mfma_f32_16x16x32_bf16 v[196:199], v[60:63], v[68:71], v[196:199]
    ds_read_b128 v[16:19], v2 offset:18432
    v_mfma_f32_16x16x32_bf16 v[200:203], v[64:67], v[68:71], v[200:203]
    ds_read_b128 v[20:23], v3 offset:16384
    v_mfma_f32_16x16x32_bf16 v[240:243], v[248:251], v[52:55], v[240:243]
    ds_read_b128 v[24:27], v3 offset:18432
    v_mfma_f32_16x16x32_bf16 v[180:183], v[52:55], v[52:55], v[180:183]
    ds_read_b128 v[32:35], v6 offset:51200
    v_mfma_f32_16x16x32_bf16 v[244:247], v[248:251], v[56:59], v[244:247]
    ds_read_b128 v[36:39], v8 offset:49152
    v_mfma_f32_16x16x32_bf16 v[184:187], v[56:59], v[56:59], v[184:187]
    v_mfma_f32_16x16x32_bf16 v[228:231], v[248:251], v[68:71], v[228:231]
    v_mfma_f32_16x16x32_bf16 v[204:207], v[52:55], v[72:75], v[204:207]
    v_mfma_f32_16x16x32_bf16 v[208:211], v[56:59], v[72:75], v[208:211]
    v_mfma_f32_16x16x32_bf16 v[212:215], v[60:63], v[72:75], v[212:215]
    v_mfma_f32_16x16x32_bf16 v[216:219], v[64:67], v[72:75], v[216:219]
    v_mfma_f32_16x16x32_bf16 v[232:235], v[248:251], v[72:75], v[232:235]
    v_mfma_f32_16x16x32_bf16 v[220:223], v[52:55], v[76:79], v[220:223]
    v_mfma_f32_16x16x32_bf16 v[224:227], v[56:59], v[76:79], v[224:227]
    v_mfma_f32_16x16x32_bf16 v[236:239], v[248:251], v[76:79], v[236:239]
    s_waitcnt lgkmcnt(5)
    v_mfma_f32_16x16x32_bf16 v[188:191], v[12:15], v[28:31], v[188:191]
    ds_read_b128 v[68:71], v7 offset:49152
    s_waitcnt lgkmcnt(5)
    v_mfma_f32_16x16x32_bf16 v[192:195], v[16:19], v[28:31], v[192:195]
    ds_read_b128 v[52:55], v4 offset:16384
    s_waitcnt lgkmcnt(5)
    v_mfma_f32_16x16x32_bf16 v[196:199], v[20:23], v[28:31], v[196:199]
    ds_read_b128 v[56:59], v4 offset:18432
    s_waitcnt lgkmcnt(5)
    v_mfma_f32_16x16x32_bf16 v[200:203], v[24:27], v[28:31], v[200:203]
    ds_read_b128 v[60:63], v5 offset:16384
    v_mfma_f32_16x16x32_bf16 v[240:243], v[248:251], v[12:15], v[240:243]
    ds_read_b128 v[64:67], v5 offset:18432
    v_mfma_f32_16x16x32_bf16 v[180:183], v[12:15], v[12:15], v[180:183]
    ds_read_b128 v[72:75], v7 offset:51200
    v_mfma_f32_16x16x32_bf16 v[244:247], v[248:251], v[16:19], v[244:247]
    ds_read_b128 v[76:79], v9 offset:49152
    v_subrev_u32 v2, 49152, v2
    v_mfma_f32_16x16x32_bf16 v[184:187], v[16:19], v[16:19], v[184:187]
    v_subrev_u32 v3, 49152, v3
    v_subrev_u32 v4, 49152, v4
    v_mfma_f32_16x16x32_bf16 v[228:231], v[248:251], v[28:31], v[228:231]
    v_subrev_u32 v5, 49152, v5
    s_waitcnt lgkmcnt(8)
    v_mfma_f32_16x16x32_bf16 v[204:207], v[12:15], v[32:35], v[204:207]
    v_mfma_f32_16x16x32_bf16 v[208:211], v[16:19], v[32:35], v[208:211]
    v_mfma_f32_16x16x32_bf16 v[212:215], v[20:23], v[32:35], v[212:215]
    v_mfma_f32_16x16x32_bf16 v[216:219], v[24:27], v[32:35], v[216:219]
    v_mfma_f32_16x16x32_bf16 v[232:235], v[248:251], v[32:35], v[232:235]
    s_waitcnt lgkmcnt(7)
    v_mfma_f32_16x16x32_bf16 v[220:223], v[12:15], v[36:39], v[220:223]
    v_mfma_f32_16x16x32_bf16 v[224:227], v[16:19], v[36:39], v[224:227]
    v_mfma_f32_16x16x32_bf16 v[236:239], v[248:251], v[36:39], v[236:239]
    s_waitcnt lgkmcnt(5)
    v_mfma_f32_16x16x32_bf16 v[188:191], v[52:55], v[68:71], v[188:191]
    s_waitcnt lgkmcnt(0)
    s_barrier
    ds_read_b128 v[28:31], v6 offset:59392
    v_mfma_f32_16x16x32_bf16 v[192:195], v[56:59], v[68:71], v[192:195]
    ds_read_b128 v[12:15], v2 offset:0
    v_mfma_f32_16x16x32_bf16 v[196:199], v[60:63], v[68:71], v[196:199]
    ds_read_b128 v[16:19], v2 offset:2048
    v_mfma_f32_16x16x32_bf16 v[200:203], v[64:67], v[68:71], v[200:203]
    ds_read_b128 v[20:23], v3 offset:0
    v_mfma_f32_16x16x32_bf16 v[240:243], v[248:251], v[52:55], v[240:243]
    ds_read_b128 v[24:27], v3 offset:2048
    v_mfma_f32_16x16x32_bf16 v[180:183], v[52:55], v[52:55], v[180:183]
    ds_read_b128 v[32:35], v6 offset:61440
    v_mfma_f32_16x16x32_bf16 v[244:247], v[248:251], v[56:59], v[244:247]
    ds_read_b128 v[36:39], v8 offset:59392
    v_mfma_f32_16x16x32_bf16 v[184:187], v[56:59], v[56:59], v[184:187]
    v_mfma_f32_16x16x32_bf16 v[228:231], v[248:251], v[68:71], v[228:231]
    v_mfma_f32_16x16x32_bf16 v[204:207], v[52:55], v[72:75], v[204:207]
    v_mfma_f32_16x16x32_bf16 v[208:211], v[56:59], v[72:75], v[208:211]
    v_mfma_f32_16x16x32_bf16 v[212:215], v[60:63], v[72:75], v[212:215]
    v_mfma_f32_16x16x32_bf16 v[216:219], v[64:67], v[72:75], v[216:219]
    v_mfma_f32_16x16x32_bf16 v[232:235], v[248:251], v[72:75], v[232:235]
    v_mfma_f32_16x16x32_bf16 v[220:223], v[52:55], v[76:79], v[220:223]
    v_mfma_f32_16x16x32_bf16 v[224:227], v[56:59], v[76:79], v[224:227]
    v_mfma_f32_16x16x32_bf16 v[236:239], v[248:251], v[76:79], v[236:239]
    s_waitcnt lgkmcnt(5)
    v_mfma_f32_16x16x32_bf16 v[188:191], v[12:15], v[28:31], v[188:191]
    ds_read_b128 v[68:71], v7 offset:59392
    s_waitcnt lgkmcnt(5)
    v_mfma_f32_16x16x32_bf16 v[192:195], v[16:19], v[28:31], v[192:195]
    ds_read_b128 v[52:55], v4 offset:0
    s_waitcnt lgkmcnt(5)
    v_mfma_f32_16x16x32_bf16 v[196:199], v[20:23], v[28:31], v[196:199]
    ds_read_b128 v[56:59], v4 offset:2048
    s_waitcnt lgkmcnt(5)
    v_mfma_f32_16x16x32_bf16 v[200:203], v[24:27], v[28:31], v[200:203]
    ds_read_b128 v[60:63], v5 offset:0
    v_mfma_f32_16x16x32_bf16 v[240:243], v[248:251], v[12:15], v[240:243]
    ds_read_b128 v[64:67], v5 offset:2048
    v_mfma_f32_16x16x32_bf16 v[180:183], v[12:15], v[12:15], v[180:183]
    ds_read_b128 v[72:75], v7 offset:61440
    v_mfma_f32_16x16x32_bf16 v[244:247], v[248:251], v[16:19], v[244:247]
    ds_read_b128 v[76:79], v9 offset:59392
    v_mfma_f32_16x16x32_bf16 v[184:187], v[16:19], v[16:19], v[184:187]
    v_mfma_f32_16x16x32_bf16 v[228:231], v[248:251], v[28:31], v[228:231]
    s_waitcnt lgkmcnt(8)
    v_mfma_f32_16x16x32_bf16 v[204:207], v[12:15], v[32:35], v[204:207]
    v_mfma_f32_16x16x32_bf16 v[208:211], v[16:19], v[32:35], v[208:211]
    v_mfma_f32_16x16x32_bf16 v[212:215], v[20:23], v[32:35], v[212:215]
    v_mfma_f32_16x16x32_bf16 v[216:219], v[24:27], v[32:35], v[216:219]
    v_mfma_f32_16x16x32_bf16 v[232:235], v[248:251], v[32:35], v[232:235]
    s_waitcnt lgkmcnt(7)
    v_mfma_f32_16x16x32_bf16 v[220:223], v[12:15], v[36:39], v[220:223]
    v_mfma_f32_16x16x32_bf16 v[224:227], v[16:19], v[36:39], v[224:227]
    v_mfma_f32_16x16x32_bf16 v[236:239], v[248:251], v[36:39], v[236:239]
    s_waitcnt lgkmcnt(5)
    v_mfma_f32_16x16x32_bf16 v[188:191], v[52:55], v[68:71], v[188:191]
    s_waitcnt lgkmcnt(0)
    s_barrier
    ds_read_b128 v[28:31], v6 offset:24576
    v_mfma_f32_16x16x32_bf16 v[192:195], v[56:59], v[68:71], v[192:195]
    ds_read_b128 v[12:15], v2 offset:16384
    v_mfma_f32_16x16x32_bf16 v[196:199], v[60:63], v[68:71], v[196:199]
    ds_read_b128 v[16:19], v2 offset:18432
    v_mfma_f32_16x16x32_bf16 v[200:203], v[64:67], v[68:71], v[200:203]
    ds_read_b128 v[20:23], v3 offset:16384
    v_mfma_f32_16x16x32_bf16 v[240:243], v[248:251], v[52:55], v[240:243]
    ds_read_b128 v[24:27], v3 offset:18432
    v_mfma_f32_16x16x32_bf16 v[180:183], v[52:55], v[52:55], v[180:183]
    ds_read_b128 v[32:35], v6 offset:26624
    v_mfma_f32_16x16x32_bf16 v[244:247], v[248:251], v[56:59], v[244:247]
    ds_read_b128 v[36:39], v8 offset:24576
    v_mfma_f32_16x16x32_bf16 v[184:187], v[56:59], v[56:59], v[184:187]
    v_mfma_f32_16x16x32_bf16 v[228:231], v[248:251], v[68:71], v[228:231]
    v_mfma_f32_16x16x32_bf16 v[204:207], v[52:55], v[72:75], v[204:207]
    v_mfma_f32_16x16x32_bf16 v[208:211], v[56:59], v[72:75], v[208:211]
    v_mfma_f32_16x16x32_bf16 v[212:215], v[60:63], v[72:75], v[212:215]
    v_mfma_f32_16x16x32_bf16 v[216:219], v[64:67], v[72:75], v[216:219]
    v_mfma_f32_16x16x32_bf16 v[232:235], v[248:251], v[72:75], v[232:235]
    v_mfma_f32_16x16x32_bf16 v[220:223], v[52:55], v[76:79], v[220:223]
    v_mfma_f32_16x16x32_bf16 v[224:227], v[56:59], v[76:79], v[224:227]
    v_mfma_f32_16x16x32_bf16 v[236:239], v[248:251], v[76:79], v[236:239]
    s_waitcnt lgkmcnt(5)
    v_mfma_f32_16x16x32_bf16 v[188:191], v[12:15], v[28:31], v[188:191]
    ds_read_b128 v[68:71], v7 offset:24576
    s_waitcnt lgkmcnt(5)
    v_mfma_f32_16x16x32_bf16 v[192:195], v[16:19], v[28:31], v[192:195]
    ds_read_b128 v[52:55], v4 offset:16384
    s_waitcnt lgkmcnt(5)
    v_mfma_f32_16x16x32_bf16 v[196:199], v[20:23], v[28:31], v[196:199]
    ds_read_b128 v[56:59], v4 offset:18432
    s_waitcnt lgkmcnt(5)
    v_mfma_f32_16x16x32_bf16 v[200:203], v[24:27], v[28:31], v[200:203]
    ds_read_b128 v[60:63], v5 offset:16384
    v_mfma_f32_16x16x32_bf16 v[240:243], v[248:251], v[12:15], v[240:243]
    ds_read_b128 v[64:67], v5 offset:18432
    v_mfma_f32_16x16x32_bf16 v[180:183], v[12:15], v[12:15], v[180:183]
    ds_read_b128 v[72:75], v7 offset:26624
    v_mfma_f32_16x16x32_bf16 v[244:247], v[248:251], v[16:19], v[244:247]
    ds_read_b128 v[76:79], v9 offset:24576
    v_mfma_f32_16x16x32_bf16 v[184:187], v[16:19], v[16:19], v[184:187]
    v_mfma_f32_16x16x32_bf16 v[228:231], v[248:251], v[28:31], v[228:231]
    s_waitcnt lgkmcnt(8)
    v_mfma_f32_16x16x32_bf16 v[204:207], v[12:15], v[32:35], v[204:207]
    v_mfma_f32_16x16x32_bf16 v[208:211], v[16:19], v[32:35], v[208:211]
    v_mfma_f32_16x16x32_bf16 v[212:215], v[20:23], v[32:35], v[212:215]
    v_mfma_f32_16x16x32_bf16 v[216:219], v[24:27], v[32:35], v[216:219]
    v_mfma_f32_16x16x32_bf16 v[232:235], v[248:251], v[32:35], v[232:235]
    s_waitcnt lgkmcnt(7)
    v_mfma_f32_16x16x32_bf16 v[220:223], v[12:15], v[36:39], v[220:223]
    v_mfma_f32_16x16x32_bf16 v[224:227], v[16:19], v[36:39], v[224:227]
    v_mfma_f32_16x16x32_bf16 v[236:239], v[248:251], v[36:39], v[236:239]
    s_waitcnt lgkmcnt(5)
    v_mfma_f32_16x16x32_bf16 v[188:191], v[52:55], v[68:71], v[188:191]
    s_waitcnt lgkmcnt(0)
    s_barrier
    ds_read_b128 v[28:31], v6 offset:34816
    v_mfma_f32_16x16x32_bf16 v[192:195], v[56:59], v[68:71], v[192:195]
    ds_read_b128 v[12:15], v2 offset:32768
    v_mfma_f32_16x16x32_bf16 v[196:199], v[60:63], v[68:71], v[196:199]
    ds_read_b128 v[16:19], v2 offset:34816
    v_mfma_f32_16x16x32_bf16 v[200:203], v[64:67], v[68:71], v[200:203]
    ds_read_b128 v[20:23], v3 offset:32768
    v_mfma_f32_16x16x32_bf16 v[240:243], v[248:251], v[52:55], v[240:243]
    ds_read_b128 v[24:27], v3 offset:34816
    v_mfma_f32_16x16x32_bf16 v[180:183], v[52:55], v[52:55], v[180:183]
    ds_read_b128 v[32:35], v6 offset:36864
    v_mfma_f32_16x16x32_bf16 v[244:247], v[248:251], v[56:59], v[244:247]
    ds_read_b128 v[36:39], v8 offset:34816
    v_mfma_f32_16x16x32_bf16 v[184:187], v[56:59], v[56:59], v[184:187]
    v_mfma_f32_16x16x32_bf16 v[228:231], v[248:251], v[68:71], v[228:231]
    v_mfma_f32_16x16x32_bf16 v[204:207], v[52:55], v[72:75], v[204:207]
    v_mfma_f32_16x16x32_bf16 v[208:211], v[56:59], v[72:75], v[208:211]
    v_mfma_f32_16x16x32_bf16 v[212:215], v[60:63], v[72:75], v[212:215]
    v_mfma_f32_16x16x32_bf16 v[216:219], v[64:67], v[72:75], v[216:219]
    v_mfma_f32_16x16x32_bf16 v[232:235], v[248:251], v[72:75], v[232:235]
    v_mfma_f32_16x16x32_bf16 v[220:223], v[52:55], v[76:79], v[220:223]
    v_mfma_f32_16x16x32_bf16 v[224:227], v[56:59], v[76:79], v[224:227]
    v_mfma_f32_16x16x32_bf16 v[236:239], v[248:251], v[76:79], v[236:239]
    s_waitcnt lgkmcnt(5)
    v_mfma_f32_16x16x32_bf16 v[188:191], v[12:15], v[28:31], v[188:191]
    ds_read_b128 v[68:71], v7 offset:34816
    s_waitcnt lgkmcnt(5)
    v_mfma_f32_16x16x32_bf16 v[192:195], v[16:19], v[28:31], v[192:195]
    ds_read_b128 v[52:55], v4 offset:32768
    s_waitcnt lgkmcnt(5)
    v_mfma_f32_16x16x32_bf16 v[196:199], v[20:23], v[28:31], v[196:199]
    ds_read_b128 v[56:59], v4 offset:34816
    s_waitcnt lgkmcnt(5)
    v_mfma_f32_16x16x32_bf16 v[200:203], v[24:27], v[28:31], v[200:203]
    ds_read_b128 v[60:63], v5 offset:32768
    v_mfma_f32_16x16x32_bf16 v[240:243], v[248:251], v[12:15], v[240:243]
    ds_read_b128 v[64:67], v5 offset:34816
    v_mfma_f32_16x16x32_bf16 v[180:183], v[12:15], v[12:15], v[180:183]
    ds_read_b128 v[72:75], v7 offset:36864
    v_mfma_f32_16x16x32_bf16 v[244:247], v[248:251], v[16:19], v[244:247]
    ds_read_b128 v[76:79], v9 offset:34816
    v_add_u32 v2, 49152, v2
    v_mfma_f32_16x16x32_bf16 v[184:187], v[16:19], v[16:19], v[184:187]
    v_add_u32 v3, 49152, v3
    v_add_u32 v4, 49152, v4
    v_mfma_f32_16x16x32_bf16 v[228:231], v[248:251], v[28:31], v[228:231]
    v_add_u32 v5, 49152, v5
    s_waitcnt lgkmcnt(8)
    v_mfma_f32_16x16x32_bf16 v[204:207], v[12:15], v[32:35], v[204:207]
    v_mfma_f32_16x16x32_bf16 v[208:211], v[16:19], v[32:35], v[208:211]
    v_mfma_f32_16x16x32_bf16 v[212:215], v[20:23], v[32:35], v[212:215]
    v_mfma_f32_16x16x32_bf16 v[216:219], v[24:27], v[32:35], v[216:219]
    v_mfma_f32_16x16x32_bf16 v[232:235], v[248:251], v[32:35], v[232:235]
    s_waitcnt lgkmcnt(7)
    v_mfma_f32_16x16x32_bf16 v[220:223], v[12:15], v[36:39], v[220:223]
    v_mfma_f32_16x16x32_bf16 v[224:227], v[16:19], v[36:39], v[224:227]
    v_mfma_f32_16x16x32_bf16 v[236:239], v[248:251], v[36:39], v[236:239]
    s_waitcnt lgkmcnt(5)
    v_mfma_f32_16x16x32_bf16 v[188:191], v[52:55], v[68:71], v[188:191]
    s_waitcnt lgkmcnt(0)
    s_barrier
    ds_read_b128 v[28:31], v6 offset:0
    v_mfma_f32_16x16x32_bf16 v[192:195], v[56:59], v[68:71], v[192:195]
    ds_read_b128 v[12:15], v2 offset:0
    v_mfma_f32_16x16x32_bf16 v[196:199], v[60:63], v[68:71], v[196:199]
    ds_read_b128 v[16:19], v2 offset:2048
    v_mfma_f32_16x16x32_bf16 v[200:203], v[64:67], v[68:71], v[200:203]
    ds_read_b128 v[20:23], v3 offset:0
    v_mfma_f32_16x16x32_bf16 v[240:243], v[248:251], v[52:55], v[240:243]
    ds_read_b128 v[24:27], v3 offset:2048
    v_mfma_f32_16x16x32_bf16 v[180:183], v[52:55], v[52:55], v[180:183]
    ds_read_b128 v[32:35], v6 offset:2048
    v_mfma_f32_16x16x32_bf16 v[244:247], v[248:251], v[56:59], v[244:247]
    ds_read_b128 v[36:39], v8 offset:0
    v_mfma_f32_16x16x32_bf16 v[184:187], v[56:59], v[56:59], v[184:187]
    v_mfma_f32_16x16x32_bf16 v[228:231], v[248:251], v[68:71], v[228:231]
    v_mfma_f32_16x16x32_bf16 v[204:207], v[52:55], v[72:75], v[204:207]
    v_mfma_f32_16x16x32_bf16 v[208:211], v[56:59], v[72:75], v[208:211]
    v_mfma_f32_16x16x32_bf16 v[212:215], v[60:63], v[72:75], v[212:215]
    v_mfma_f32_16x16x32_bf16 v[216:219], v[64:67], v[72:75], v[216:219]
    v_mfma_f32_16x16x32_bf16 v[232:235], v[248:251], v[72:75], v[232:235]
    v_mfma_f32_16x16x32_bf16 v[220:223], v[52:55], v[76:79], v[220:223]
    v_mfma_f32_16x16x32_bf16 v[224:227], v[56:59], v[76:79], v[224:227]
    v_mfma_f32_16x16x32_bf16 v[236:239], v[248:251], v[76:79], v[236:239]
    s_waitcnt lgkmcnt(5)
    v_mfma_f32_16x16x32_bf16 v[188:191], v[12:15], v[28:31], v[188:191]
    ds_read_b128 v[68:71], v7 offset:0
    s_waitcnt lgkmcnt(5)
    v_mfma_f32_16x16x32_bf16 v[192:195], v[16:19], v[28:31], v[192:195]
    ds_read_b128 v[52:55], v4 offset:0
    s_waitcnt lgkmcnt(5)
    v_mfma_f32_16x16x32_bf16 v[196:199], v[20:23], v[28:31], v[196:199]
    ds_read_b128 v[56:59], v4 offset:2048
    s_waitcnt lgkmcnt(5)
    v_mfma_f32_16x16x32_bf16 v[200:203], v[24:27], v[28:31], v[200:203]
    ds_read_b128 v[60:63], v5 offset:0
    v_mfma_f32_16x16x32_bf16 v[240:243], v[248:251], v[12:15], v[240:243]
    ds_read_b128 v[64:67], v5 offset:2048
    v_mfma_f32_16x16x32_bf16 v[180:183], v[12:15], v[12:15], v[180:183]
    ds_read_b128 v[72:75], v7 offset:2048
    v_mfma_f32_16x16x32_bf16 v[244:247], v[248:251], v[16:19], v[244:247]
    ds_read_b128 v[76:79], v9 offset:0
    v_mfma_f32_16x16x32_bf16 v[184:187], v[16:19], v[16:19], v[184:187]
    v_mfma_f32_16x16x32_bf16 v[228:231], v[248:251], v[28:31], v[228:231]
    s_waitcnt lgkmcnt(8)
    v_mfma_f32_16x16x32_bf16 v[204:207], v[12:15], v[32:35], v[204:207]
    v_mfma_f32_16x16x32_bf16 v[208:211], v[16:19], v[32:35], v[208:211]
    v_mfma_f32_16x16x32_bf16 v[212:215], v[20:23], v[32:35], v[212:215]
    v_mfma_f32_16x16x32_bf16 v[216:219], v[24:27], v[32:35], v[216:219]
    v_mfma_f32_16x16x32_bf16 v[232:235], v[248:251], v[32:35], v[232:235]
    s_waitcnt lgkmcnt(7)
    v_mfma_f32_16x16x32_bf16 v[220:223], v[12:15], v[36:39], v[220:223]
    v_mfma_f32_16x16x32_bf16 v[224:227], v[16:19], v[36:39], v[224:227]
    v_mfma_f32_16x16x32_bf16 v[236:239], v[248:251], v[36:39], v[236:239]
    s_waitcnt lgkmcnt(5)
    v_mfma_f32_16x16x32_bf16 v[188:191], v[52:55], v[68:71], v[188:191]
    s_waitcnt lgkmcnt(0)
    s_barrier
    ds_read_b128 v[28:31], v6 offset:10240
    v_mfma_f32_16x16x32_bf16 v[192:195], v[56:59], v[68:71], v[192:195]
    ds_read_b128 v[12:15], v2 offset:16384
    v_mfma_f32_16x16x32_bf16 v[196:199], v[60:63], v[68:71], v[196:199]
    ds_read_b128 v[16:19], v2 offset:18432
    v_mfma_f32_16x16x32_bf16 v[200:203], v[64:67], v[68:71], v[200:203]
    ds_read_b128 v[20:23], v3 offset:16384
    v_mfma_f32_16x16x32_bf16 v[240:243], v[248:251], v[52:55], v[240:243]
    ds_read_b128 v[24:27], v3 offset:18432
    v_mfma_f32_16x16x32_bf16 v[180:183], v[52:55], v[52:55], v[180:183]
    ds_read_b128 v[32:35], v6 offset:12288
    v_mfma_f32_16x16x32_bf16 v[244:247], v[248:251], v[56:59], v[244:247]
    ds_read_b128 v[36:39], v8 offset:10240
    v_mfma_f32_16x16x32_bf16 v[184:187], v[56:59], v[56:59], v[184:187]
    v_mfma_f32_16x16x32_bf16 v[228:231], v[248:251], v[68:71], v[228:231]
    v_mfma_f32_16x16x32_bf16 v[204:207], v[52:55], v[72:75], v[204:207]
    v_mfma_f32_16x16x32_bf16 v[208:211], v[56:59], v[72:75], v[208:211]
    v_mfma_f32_16x16x32_bf16 v[212:215], v[60:63], v[72:75], v[212:215]
    v_mfma_f32_16x16x32_bf16 v[216:219], v[64:67], v[72:75], v[216:219]
    v_mfma_f32_16x16x32_bf16 v[232:235], v[248:251], v[72:75], v[232:235]
    v_mfma_f32_16x16x32_bf16 v[220:223], v[52:55], v[76:79], v[220:223]
    v_mfma_f32_16x16x32_bf16 v[224:227], v[56:59], v[76:79], v[224:227]
    v_mfma_f32_16x16x32_bf16 v[236:239], v[248:251], v[76:79], v[236:239]
    s_waitcnt lgkmcnt(5)
    v_mfma_f32_16x16x32_bf16 v[188:191], v[12:15], v[28:31], v[188:191]
    ds_read_b128 v[68:71], v7 offset:10240
    s_waitcnt lgkmcnt(5)
    v_mfma_f32_16x16x32_bf16 v[192:195], v[16:19], v[28:31], v[192:195]
    ds_read_b128 v[52:55], v4 offset:16384
    s_waitcnt lgkmcnt(5)
    v_mfma_f32_16x16x32_bf16 v[196:199], v[20:23], v[28:31], v[196:199]
    ds_read_b128 v[56:59], v4 offset:18432
    s_waitcnt lgkmcnt(5)
    v_mfma_f32_16x16x32_bf16 v[200:203], v[24:27], v[28:31], v[200:203]
    ds_read_b128 v[60:63], v5 offset:16384
    v_mfma_f32_16x16x32_bf16 v[240:243], v[248:251], v[12:15], v[240:243]
    ds_read_b128 v[64:67], v5 offset:18432
    v_mfma_f32_16x16x32_bf16 v[180:183], v[12:15], v[12:15], v[180:183]
    ds_read_b128 v[72:75], v7 offset:12288
    v_mfma_f32_16x16x32_bf16 v[244:247], v[248:251], v[16:19], v[244:247]
    ds_read_b128 v[76:79], v9 offset:10240
    v_subrev_u32 v2, 49152, v2
    v_mfma_f32_16x16x32_bf16 v[184:187], v[16:19], v[16:19], v[184:187]
    v_subrev_u32 v3, 49152, v3
    v_subrev_u32 v4, 49152, v4
    v_mfma_f32_16x16x32_bf16 v[228:231], v[248:251], v[28:31], v[228:231]
    v_subrev_u32 v5, 49152, v5
    v_mov_b32 v6, v88
    s_waitcnt lgkmcnt(8)
    v_mfma_f32_16x16x32_bf16 v[204:207], v[12:15], v[32:35], v[204:207]
    v_mov_b32 v7, v89
    v_add_u32 v8, 12288, v88
    v_mfma_f32_16x16x32_bf16 v[208:211], v[16:19], v[32:35], v[208:211]
    v_add_u32 v9, 12288, v89
    v_mfma_f32_16x16x32_bf16 v[212:215], v[20:23], v[32:35], v[212:215]
    v_mfma_f32_16x16x32_bf16 v[216:219], v[24:27], v[32:35], v[216:219]
    v_mfma_f32_16x16x32_bf16 v[232:235], v[248:251], v[32:35], v[232:235]
    s_waitcnt lgkmcnt(7)
    v_mfma_f32_16x16x32_bf16 v[220:223], v[12:15], v[36:39], v[220:223]
    v_mfma_f32_16x16x32_bf16 v[224:227], v[16:19], v[36:39], v[224:227]
    v_mfma_f32_16x16x32_bf16 v[236:239], v[248:251], v[36:39], v[236:239]
    s_waitcnt lgkmcnt(5)
    v_mfma_f32_16x16x32_bf16 v[188:191], v[52:55], v[68:71], v[188:191]
    s_waitcnt lgkmcnt(0)
    s_barrier
    ds_read_b64_tr_b16 v[28:29], v6 offset:49152
    v_mfma_f32_16x16x32_bf16 v[192:195], v[56:59], v[68:71], v[192:195]
    ds_read_b64_tr_b16 v[30:31], v6 offset:49920
    v_mfma_f32_16x16x32_bf16 v[196:199], v[60:63], v[68:71], v[196:199]
    ds_read_b128 v[12:15], v2 offset:0
    v_mfma_f32_16x16x32_bf16 v[200:203], v[64:67], v[68:71], v[200:203]
    ds_read_b128 v[16:19], v2 offset:2048
    v_mfma_f32_16x16x32_bf16 v[240:243], v[248:251], v[52:55], v[240:243]
    ds_read_b128 v[20:23], v3 offset:0
    v_mfma_f32_16x16x32_bf16 v[180:183], v[52:55], v[52:55], v[180:183]
    ds_read_b128 v[24:27], v3 offset:2048
    v_mfma_f32_16x16x32_bf16 v[244:247], v[248:251], v[56:59], v[244:247]
    ds_read_b64_tr_b16 v[32:33], v8 offset:49152
    v_mfma_f32_16x16x32_bf16 v[184:187], v[56:59], v[56:59], v[184:187]
    ds_read_b64_tr_b16 v[34:35], v8 offset:49920
    v_mfma_f32_16x16x32_bf16 v[228:231], v[248:251], v[68:71], v[228:231]
    ds_read_b64_tr_b16 v[36:37], v7 offset:49184
    v_mfma_f32_16x16x32_bf16 v[204:207], v[52:55], v[72:75], v[204:207]
    ds_read_b64_tr_b16 v[38:39], v7 offset:49952
    v_mfma_f32_16x16x32_bf16 v[208:211], v[56:59], v[72:75], v[208:211]
    ds_read_b64_tr_b16 v[40:41], v9 offset:49184
    v_mfma_f32_16x16x32_bf16 v[212:215], v[60:63], v[72:75], v[212:215]
    ds_read_b64_tr_b16 v[42:43], v9 offset:49952
    v_mfma_f32_16x16x32_bf16 v[216:219], v[64:67], v[72:75], v[216:219]
    ds_read_b64_tr_b16 v[44:45], v6 offset:49216
    v_mfma_f32_16x16x32_bf16 v[232:235], v[248:251], v[72:75], v[232:235]
    ds_read_b64_tr_b16 v[46:47], v6 offset:49984
    v_mfma_f32_16x16x32_bf16 v[220:223], v[52:55], v[76:79], v[220:223]
    ds_read_b64_tr_b16 v[48:49], v8 offset:49216
    v_mfma_f32_16x16x32_bf16 v[224:227], v[56:59], v[76:79], v[224:227]
    ds_read_b64_tr_b16 v[50:51], v8 offset:49984
    v_mfma_f32_16x16x32_bf16 v[236:239], v[248:251], v[76:79], v[236:239]
    s_waitcnt lgkmcnt(13)
    v_mfma_f32_16x16x32_bf16 v[92:95], v[28:31], v[12:15], 0
    ds_read_b64_tr_b16 v[68:69], v6 offset:55296
    s_nop 0
    s_waitcnt lgkmcnt(13)
    v_mfma_f32_16x16x32_bf16 v[96:99], v[28:31], v[16:19], 0
    ds_read_b64_tr_b16 v[70:71], v6 offset:56064
    s_nop 0
    s_waitcnt lgkmcnt(13)
    v_mfma_f32_16x16x32_bf16 v[100:103], v[28:31], v[20:23], 0
    ds_read_b128 v[52:55], v4 offset:0
    v_and_b32 v242, 15, v1
    s_waitcnt lgkmcnt(13)
    v_mfma_f32_16x16x32_bf16 v[104:107], v[28:31], v[24:27], 0
    ds_read_b128 v[56:59], v4 offset:2048
    v_lshl_add_u32 v242, v242, 3, s76
    s_waitcnt lgkmcnt(12)
    v_mfma_f32_16x16x32_bf16 v[108:111], v[32:35], v[12:15], 0
    ds_read_b128 v[60:63], v5 offset:0
    v_cndmask_b32 v241, v180, v181, s[70:71]
    v_mfma_f32_16x16x32_bf16 v[112:115], v[32:35], v[16:19], 0
    ds_read_b128 v[64:67], v5 offset:2048
    v_cndmask_b32 v241, v241, v182, s[72:73]
    v_mfma_f32_16x16x32_bf16 v[116:119], v[32:35], v[20:23], 0
    ds_read_b64_tr_b16 v[72:73], v8 offset:55296
    v_cndmask_b32 v241, v241, v183, s[74:75]
    v_mfma_f32_16x16x32_bf16 v[120:123], v[32:35], v[24:27], 0
    ds_read_b64_tr_b16 v[74:75], v8 offset:56064
    v_cndmask_b32 v245, v184, v185, s[70:71]
    s_waitcnt lgkmcnt(14)
    v_mfma_f32_16x16x32_bf16 v[124:127], v[36:39], v[12:15], 0
    ds_read_b64_tr_b16 v[76:77], v7 offset:55328
    v_cndmask_b32 v245, v245, v186, s[72:73]
    v_mfma_f32_16x16x32_bf16 v[128:131], v[36:39], v[16:19], 0
    ds_read_b64_tr_b16 v[78:79], v7 offset:56096
    v_cndmask_b32 v245, v245, v187, s[74:75]
    v_mfma_f32_16x16x32_bf16 v[132:135], v[36:39], v[20:23], 0
    ds_read_b64_tr_b16 v[80:81], v9 offset:55328
    s_mov_b64 exec, s[68:69]
    ds_write_b64 v242, v[240:241]
    ds_write_b64 v242, v[244:245] offset:128
    s_mov_b64 exec, -1
    v_mfma_f32_16x16x32_bf16 v[136:139], v[36:39], v[24:27], 0
    ds_read_b64_tr_b16 v[82:83], v9 offset:56096
    v_mov_b32 v229, v232
    s_waitcnt lgkmcnt(15)
    v_mfma_f32_16x16x32_bf16 v[140:143], v[40:43], v[12:15], 0
    ds_read_b64_tr_b16 v[84:85], v6 offset:55360
    v_mov_b32 v230, v236
    v_mfma_f32_16x16x32_bf16 v[144:147], v[40:43], v[16:19], 0
    ds_read_b64_tr_b16 v[86:87], v6 offset:56128
    v_mfma_f32_16x16x32_bf16 v[148:151], v[40:43], v[20:23], 0
    ds_read_b64_tr_b16 v[88:89], v8 offset:55360
    v_mfma_f32_16x16x32_bf16 v[152:155], v[40:43], v[24:27], 0
    ds_read_b64_tr_b16 v[90:91], v8 offset:56128
    v_mfma_f32_16x16x32_bf16 v[156:159], v[44:47], v[12:15], 0
    v_mfma_f32_16x16x32_bf16 v[160:163], v[44:47], v[16:19], 0
    v_mfma_f32_16x16x32_bf16 v[164:167], v[44:47], v[20:23], 0
    v_mfma_f32_16x16x32_bf16 v[168:171], v[44:47], v[24:27], 0
    s_waitcnt lgkmcnt(15)
    v_mfma_f32_16x16x32_bf16 v[172:175], v[48:51], v[12:15], 0
    v_mfma_f32_16x16x32_bf16 v[176:179], v[48:51], v[16:19], 0
    v_mfma_f32_16x16x32_bf16 v[180:183], v[48:51], v[20:23], 0
    v_mfma_f32_16x16x32_bf16 v[184:187], v[48:51], v[24:27], 0
    v_mfma_f32_16x16x32_bf16 v[92:95], v[68:71], v[52:55], v[92:95]
    s_waitcnt lgkmcnt(0)
    s_barrier
    ds_read_b64_tr_b16 v[28:29], v6 offset:24576
    v_mfma_f32_16x16x32_bf16 v[96:99], v[68:71], v[56:59], v[96:99]
    ds_read_b64_tr_b16 v[30:31], v6 offset:25344
    v_mfma_f32_16x16x32_bf16 v[100:103], v[68:71], v[60:63], v[100:103]
    ds_read_b128 v[12:15], v2 offset:16384
    v_mfma_f32_16x16x32_bf16 v[104:107], v[68:71], v[64:67], v[104:107]
    ds_read_b128 v[16:19], v2 offset:18432
    v_mfma_f32_16x16x32_bf16 v[108:111], v[72:75], v[52:55], v[108:111]
    ds_read_b128 v[20:23], v3 offset:16384
    v_mfma_f32_16x16x32_bf16 v[112:115], v[72:75], v[56:59], v[112:115]
    ds_read_b128 v[24:27], v3 offset:18432
    v_mfma_f32_16x16x32_bf16 v[116:119], v[72:75], v[60:63], v[116:119]
    ds_read_b64_tr_b16 v[32:33], v8 offset:24576
    v_mfma_f32_16x16x32_bf16 v[120:123], v[72:75], v[64:67], v[120:123]
    ds_read_b64_tr_b16 v[34:35], v8 offset:25344
    v_mfma_f32_16x16x32_bf16 v[124:127], v[76:79], v[52:55], v[124:127]
    ds_read_b64_tr_b16 v[36:37], v7 offset:24608
    v_mfma_f32_16x16x32_bf16 v[128:131], v[76:79], v[56:59], v[128:131]
    ds_read_b64_tr_b16 v[38:39], v7 offset:25376
    v_mfma_f32_16x16x32_bf16 v[132:135], v[76:79], v[60:63], v[132:135]
    ds_read_b64_tr_b16 v[40:41], v9 offset:24608
    v_mfma_f32_16x16x32_bf16 v[136:139], v[76:79], v[64:67], v[136:139]
    ds_read_b64_tr_b16 v[42:43], v9 offset:25376
    v_mfma_f32_16x16x32_bf16 v[140:143], v[80:83], v[52:55], v[140:143]
    ds_read_b64_tr_b16 v[44:45], v6 offset:24640
    v_mfma_f32_16x16x32_bf16 v[144:147], v[80:83], v[56:59], v[144:147]
    ds_read_b64_tr_b16 v[46:47], v6 offset:25408
    v_mfma_f32_16x16x32_bf16 v[148:151], v[80:83], v[60:63], v[148:151]
    ds_read_b64_tr_b16 v[48:49], v8 offset:24640
    v_mfma_f32_16x16x32_bf16 v[152:155], v[80:83], v[64:67], v[152:155]
    ds_read_b64_tr_b16 v[50:51], v8 offset:25408
    v_mfma_f32_16x16x32_bf16 v[156:159], v[84:87], v[52:55], v[156:159]
    v_mfma_f32_16x16x32_bf16 v[160:163], v[84:87], v[56:59], v[160:163]
    v_mfma_f32_16x16x32_bf16 v[164:167], v[84:87], v[60:63], v[164:167]
    v_mfma_f32_16x16x32_bf16 v[168:171], v[84:87], v[64:67], v[168:171]
    v_mfma_f32_16x16x32_bf16 v[172:175], v[88:91], v[52:55], v[172:175]
    v_mfma_f32_16x16x32_bf16 v[176:179], v[88:91], v[56:59], v[176:179]
    v_mfma_f32_16x16x32_bf16 v[180:183], v[88:91], v[60:63], v[180:183]
    v_mfma_f32_16x16x32_bf16 v[184:187], v[88:91], v[64:67], v[184:187]
    s_waitcnt lgkmcnt(13)
    v_mfma_f32_16x16x32_bf16 v[92:95], v[28:31], v[12:15], v[92:95]
    ds_read_b64_tr_b16 v[68:69], v6 offset:30720
    s_waitcnt lgkmcnt(13)
    v_mfma_f32_16x16x32_bf16 v[96:99], v[28:31], v[16:19], v[96:99]
    ds_read_b64_tr_b16 v[70:71], v6 offset:31488
    s_waitcnt lgkmcnt(13)
    v_mfma_f32_16x16x32_bf16 v[100:103], v[28:31], v[20:23], v[100:103]
    ds_read_b128 v[52:55], v4 offset:16384
    s_waitcnt lgkmcnt(13)
    v_mfma_f32_16x16x32_bf16 v[104:107], v[28:31], v[24:27], v[104:107]
    ds_read_b128 v[56:59], v4 offset:18432
    s_waitcnt lgkmcnt(12)
    v_mfma_f32_16x16x32_bf16 v[108:111], v[32:35], v[12:15], v[108:111]
    ds_read_b128 v[60:63], v5 offset:16384
    v_mfma_f32_16x16x32_bf16 v[112:115], v[32:35], v[16:19], v[112:115]
    ds_read_b128 v[64:67], v5 offset:18432
    v_mfma_f32_16x16x32_bf16 v[116:119], v[32:35], v[20:23], v[116:119]
    ds_read_b64_tr_b16 v[72:73], v8 offset:30720
    v_mfma_f32_16x16x32_bf16 v[120:123], v[32:35], v[24:27], v[120:123]
    ds_read_b64_tr_b16 v[74:75], v8 offset:31488
    s_waitcnt lgkmcnt(14)
    v_mfma_f32_16x16x32_bf16 v[124:127], v[36:39], v[12:15], v[124:127]
    ds_read_b64_tr_b16 v[76:77], v7 offset:30752
    v_mfma_f32_16x16x32_bf16 v[128:131], v[36:39], v[16:19], v[128:131]
    ds_read_b64_tr_b16 v[78:79], v7 offset:31520
    v_mfma_f32_16x16x32_bf16 v[132:135], v[36:39], v[20:23], v[132:135]
    ds_read_b64_tr_b16 v[80:81], v9 offset:30752
    v_mfma_f32_16x16x32_bf16 v[136:139], v[36:39], v[24:27], v[136:139]
    ds_read_b64_tr_b16 v[82:83], v9 offset:31520
    s_waitcnt lgkmcnt(15)
    v_mfma_f32_16x16x32_bf16 v[140:143], v[40:43], v[12:15], v[140:143]
    ds_read_b64_tr_b16 v[84:85], v6 offset:30784
    v_mfma_f32_16x16x32_bf16 v[144:147], v[40:43], v[16:19], v[144:147]
    ds_read_b64_tr_b16 v[86:87], v6 offset:31552
    v_mfma_f32_16x16x32_bf16 v[148:151], v[40:43], v[20:23], v[148:151]
    ds_read_b64_tr_b16 v[88:89], v8 offset:30784
    v_mfma_f32_16x16x32_bf16 v[152:155], v[40:43], v[24:27], v[152:155]
    ds_read_b64_tr_b16 v[90:91], v8 offset:31552
    s_waitcnt lgkmcnt(15)
    v_mfma_f32_16x16x32_bf16 v[156:159], v[44:47], v[12:15], v[156:159]
    v_mfma_f32_16x16x32_bf16 v[160:163], v[44:47], v[16:19], v[160:163]
    v_mfma_f32_16x16x32_bf16 v[164:167], v[44:47], v[20:23], v[164:167]
    v_mfma_f32_16x16x32_bf16 v[168:171], v[44:47], v[24:27], v[168:171]
    v_mfma_f32_16x16x32_bf16 v[172:175], v[48:51], v[12:15], v[172:175]
    v_mfma_f32_16x16x32_bf16 v[176:179], v[48:51], v[16:19], v[176:179]
    v_mfma_f32_16x16x32_bf16 v[180:183], v[48:51], v[20:23], v[180:183]
    v_mfma_f32_16x16x32_bf16 v[184:187], v[48:51], v[24:27], v[184:187]
    s_waitcnt lgkmcnt(13)
    v_mfma_f32_16x16x32_bf16 v[92:95], v[68:71], v[52:55], v[92:95]
    s_waitcnt lgkmcnt(0)
    s_barrier
    ds_read_b64_tr_b16 v[28:29], v6 offset:0
    v_mfma_f32_16x16x32_bf16 v[96:99], v[68:71], v[56:59], v[96:99]
    ds_read_b64_tr_b16 v[30:31], v6 offset:768
    v_mfma_f32_16x16x32_bf16 v[100:103], v[68:71], v[60:63], v[100:103]
    ds_read_b128 v[12:15], v2 offset:32768
    v_mfma_f32_16x16x32_bf16 v[104:107], v[68:71], v[64:67], v[104:107]
    ds_read_b128 v[16:19], v2 offset:34816
    v_mfma_f32_16x16x32_bf16 v[108:111], v[72:75], v[52:55], v[108:111]
    ds_read_b128 v[20:23], v3 offset:32768
    v_mfma_f32_16x16x32_bf16 v[112:115], v[72:75], v[56:59], v[112:115]
    ds_read_b128 v[24:27], v3 offset:34816
    v_mfma_f32_16x16x32_bf16 v[116:119], v[72:75], v[60:63], v[116:119]
    ds_read_b64_tr_b16 v[32:33], v8 offset:0
    v_mfma_f32_16x16x32_bf16 v[120:123], v[72:75], v[64:67], v[120:123]
    ds_read_b64_tr_b16 v[34:35], v8 offset:768
    v_mfma_f32_16x16x32_bf16 v[124:127], v[76:79], v[52:55], v[124:127]
    ds_read_b64_tr_b16 v[36:37], v7 offset:32
    v_mfma_f32_16x16x32_bf16 v[128:131], v[76:79], v[56:59], v[128:131]
    ds_read_b64_tr_b16 v[38:39], v7 offset:800
    v_mfma_f32_16x16x32_bf16 v[132:135], v[76:79], v[60:63], v[132:135]
    ds_read_b64_tr_b16 v[40:41], v9 offset:32
    v_mfma_f32_16x16x32_bf16 v[136:139], v[76:79], v[64:67], v[136:139]
    ds_read_b64_tr_b16 v[42:43], v9 offset:800
    v_mfma_f32_16x16x32_bf16 v[140:143], v[80:83], v[52:55], v[140:143]
    ds_read_b64_tr_b16 v[44:45], v6 offset:64
    v_mfma_f32_16x16x32_bf16 v[144:147], v[80:83], v[56:59], v[144:147]
    ds_read_b64_tr_b16 v[46:47], v6 offset:832
    v_mfma_f32_16x16x32_bf16 v[148:151], v[80:83], v[60:63], v[148:151]
    ds_read_b64_tr_b16 v[48:49], v8 offset:64
    v_mfma_f32_16x16x32_bf16 v[152:155], v[80:83], v[64:67], v[152:155]
    ds_read_b64_tr_b16 v[50:51], v8 offset:832
    v_mfma_f32_16x16x32_bf16 v[156:159], v[84:87], v[52:55], v[156:159]
    v_mfma_f32_16x16x32_bf16 v[160:163], v[84:87], v[56:59], v[160:163]
    v_mfma_f32_16x16x32_bf16 v[164:167], v[84:87], v[60:63], v[164:167]
    v_mfma_f32_16x16x32_bf16 v[168:171], v[84:87], v[64:67], v[168:171]
    v_mfma_f32_16x16x32_bf16 v[172:175], v[88:91], v[52:55], v[172:175]
    v_mfma_f32_16x16x32_bf16 v[176:179], v[88:91], v[56:59], v[176:179]
    v_mfma_f32_16x16x32_bf16 v[180:183], v[88:91], v[60:63], v[180:183]
    v_mfma_f32_16x16x32_bf16 v[184:187], v[88:91], v[64:67], v[184:187]
    s_waitcnt lgkmcnt(13)
    v_mfma_f32_16x16x32_bf16 v[92:95], v[28:31], v[12:15], v[92:95]
    ds_read_b64_tr_b16 v[68:69], v6 offset:6144
    ds_read_b128 v[232:235], v10 offset:2048
    s_waitcnt lgkmcnt(14)
    v_mfma_f32_16x16x32_bf16 v[96:99], v[28:31], v[16:19], v[96:99]
    ds_read_b64_tr_b16 v[70:71], v6 offset:6912
    ds_read_b128 v[240:243], v10 offset:2560
    s_waitcnt lgkmcnt(15)
    v_mfma_f32_16x16x32_bf16 v[100:103], v[28:31], v[20:23], v[100:103]
    ds_read_b128 v[52:55], v4 offset:32768
    ds_read_b128 v[236:239], v10 offset:2112
    s_waitcnt lgkmcnt(15)
    v_mfma_f32_16x16x32_bf16 v[104:107], v[28:31], v[24:27], v[104:107]
    ds_read_b128 v[56:59], v4 offset:34816
    ds_read_b128 v[244:247], v10 offset:2624
    s_waitcnt lgkmcnt(15)
    v_mfma_f32_16x16x32_bf16 v[108:111], v[32:35], v[12:15], v[108:111]
    ds_read_b128 v[60:63], v5 offset:32768
    v_mov_b32 v249, 159616
    v_mfma_f32_16x16x32_bf16 v[112:115], v[32:35], v[16:19], v[112:115]
    ds_read_b128 v[64:67], v5 offset:34816
    ds_read_b32 v248, v249
    v_mfma_f32_16x16x32_bf16 v[116:119], v[32:35], v[20:23], v[116:119]
    ds_read_b64_tr_b16 v[72:73], v8 offset:6144
    s_nop 0
    v_mfma_f32_16x16x32_bf16 v[120:123], v[32:35], v[24:27], v[120:123]
    ds_read_b64_tr_b16 v[74:75], v8 offset:6912
    s_nop 0
    s_waitcnt lgkmcnt(15)
    v_mfma_f32_16x16x32_bf16 v[124:127], v[36:39], v[12:15], v[124:127]
    ds_read_b64_tr_b16 v[76:77], v7 offset:6176
    s_nop 0
    v_mfma_f32_16x16x32_bf16 v[128:131], v[36:39], v[16:19], v[128:131]
    ds_read_b64_tr_b16 v[78:79], v7 offset:6944
    s_nop 0
    v_mfma_f32_16x16x32_bf16 v[132:135], v[36:39], v[20:23], v[132:135]
    ds_read_b64_tr_b16 v[80:81], v9 offset:6176
    s_nop 0
    v_mfma_f32_16x16x32_bf16 v[136:139], v[36:39], v[24:27], v[136:139]
    ds_read_b64_tr_b16 v[82:83], v9 offset:6944
    s_nop 0
    v_mfma_f32_16x16x32_bf16 v[140:143], v[40:43], v[12:15], v[140:143]
    ds_read_b64_tr_b16 v[84:85], v6 offset:6208
    s_waitcnt lgkmcnt(7)
    v_mfma_f32_16x16x32_bf16 v[144:147], v[40:43], v[16:19], v[144:147]
    ds_read_b64_tr_b16 v[86:87], v6 offset:6976
    v_fmac_f32 v188, v232, v228
    v_mfma_f32_16x16x32_bf16 v[148:151], v[40:43], v[20:23], v[148:151]
    ds_read_b64_tr_b16 v[88:89], v8 offset:6208
    v_fmac_f32 v189, v233, v228
    v_mfma_f32_16x16x32_bf16 v[152:155], v[40:43], v[24:27], v[152:155]
    ds_read_b64_tr_b16 v[90:91], v8 offset:6976
    v_add_u32 v2, 49152, v2
    v_mfma_f32_16x16x32_bf16 v[156:159], v[44:47], v[12:15], v[156:159]
    v_add_u32 v3, 49152, v3
    v_add_u32 v4, 49152, v4
    v_mfma_f32_16x16x32_bf16 v[160:163], v[44:47], v[16:19], v[160:163]
    v_add_u32 v5, 49152, v5
    v_fmac_f32 v190, v234, v228
    v_mfma_f32_16x16x32_bf16 v[164:167], v[44:47], v[20:23], v[164:167]
    v_fmac_f32 v191, v235, v228
    v_fmac_f32 v192, v236, v228
    v_mfma_f32_16x16x32_bf16 v[168:171], v[44:47], v[24:27], v[168:171]
    v_fmac_f32 v193, v237, v228
    v_fmac_f32 v194, v238, v228
    v_mfma_f32_16x16x32_bf16 v[172:175], v[48:51], v[12:15], v[172:175]
    v_fmac_f32 v195, v239, v228
    v_mul_f32 v188, v188, v240
    v_mfma_f32_16x16x32_bf16 v[176:179], v[48:51], v[16:19], v[176:179]
    v_mul_f32 v189, v189, v241
    v_mul_f32 v190, v190, v242
    v_mfma_f32_16x16x32_bf16 v[180:183], v[48:51], v[20:23], v[180:183]
    v_mul_f32 v191, v191, v243
    v_mul_f32 v192, v192, v244
    v_mfma_f32_16x16x32_bf16 v[184:187], v[48:51], v[24:27], v[184:187]
    v_mul_f32 v193, v193, v245
    v_mul_f32 v194, v194, v246
    v_mfma_f32_16x16x32_bf16 v[92:95], v[68:71], v[52:55], v[92:95]
    s_waitcnt lgkmcnt(0)
    s_barrier
    ds_read_b64_tr_b16 v[28:29], v6 offset:49152
    v_mul_f32 v195, v195, v247
    v_mfma_f32_16x16x32_bf16 v[96:99], v[68:71], v[56:59], v[96:99]
    ds_read_b64_tr_b16 v[30:31], v6 offset:49920
    v_cvt_pk_bf16_f32 v188, v188, v189
    v_mfma_f32_16x16x32_bf16 v[100:103], v[68:71], v[60:63], v[100:103]
    ds_read_b128 v[12:15], v2 offset:0
    v_cvt_pk_bf16_f32 v189, v190, v191
    v_mfma_f32_16x16x32_bf16 v[104:107], v[68:71], v[64:67], v[104:107]
    ds_read_b128 v[16:19], v2 offset:2048
    v_cvt_pk_bf16_f32 v190, v192, v193
    v_mfma_f32_16x16x32_bf16 v[108:111], v[72:75], v[52:55], v[108:111]
    ds_read_b128 v[20:23], v3 offset:0
    v_cvt_pk_bf16_f32 v191, v194, v195
    v_mfma_f32_16x16x32_bf16 v[112:115], v[72:75], v[56:59], v[112:115]
    ds_read_b128 v[24:27], v3 offset:2048
    s_nop 0
    v_mfma_f32_16x16x32_bf16 v[116:119], v[72:75], v[60:63], v[116:119]
    ds_read_b64_tr_b16 v[32:33], v8 offset:49152
    v_permlane16_swap_b32 v188, v190
    v_mfma_f32_16x16x32_bf16 v[120:123], v[72:75], v[64:67], v[120:123]
    ds_read_b64_tr_b16 v[34:35], v8 offset:49920
    s_nop 0
    v_mfma_f32_16x16x32_bf16 v[124:127], v[76:79], v[52:55], v[124:127]
    ds_read_b64_tr_b16 v[36:37], v7 offset:49184
    v_permlane16_swap_b32 v189, v191
    v_mfma_f32_16x16x32_bf16 v[128:131], v[76:79], v[56:59], v[128:131]
    ds_read_b64_tr_b16 v[38:39], v7 offset:49952
    buffer_store_dwordx4 v[188:191], v11, s[48:51], s59 offen offset:0 sc1
    v_mfma_f32_16x16x32_bf16 v[132:135], v[76:79], v[60:63], v[132:135]
    ds_read_b64_tr_b16 v[40:41], v9 offset:49184
    v_fmac_f32 v204, v232, v229
    v_mfma_f32_16x16x32_bf16 v[136:139], v[76:79], v[64:67], v[136:139]
    ds_read_b64_tr_b16 v[42:43], v9 offset:49952
    v_fmac_f32 v205, v233, v229
    v_mfma_f32_16x16x32_bf16 v[140:143], v[80:83], v[52:55], v[140:143]
    ds_read_b64_tr_b16 v[44:45], v6 offset:49216
    v_fmac_f32 v206, v234, v229
    v_mfma_f32_16x16x32_bf16 v[144:147], v[80:83], v[56:59], v[144:147]
    ds_read_b64_tr_b16 v[46:47], v6 offset:49984
    v_fmac_f32 v207, v235, v229
    v_mfma_f32_16x16x32_bf16 v[148:151], v[80:83], v[60:63], v[148:151]
    ds_read_b64_tr_b16 v[48:49], v8 offset:49216
    v_fmac_f32 v208, v236, v229
    v_mfma_f32_16x16x32_bf16 v[152:155], v[80:83], v[64:67], v[152:155]
    ds_read_b64_tr_b16 v[50:51], v8 offset:49984
    v_fmac_f32 v209, v237, v229
    v_mfma_f32_16x16x32_bf16 v[156:159], v[84:87], v[52:55], v[156:159]
    v_fmac_f32 v210, v238, v229
    v_fmac_f32 v211, v239, v229
    v_mfma_f32_16x16x32_bf16 v[160:163], v[84:87], v[56:59], v[160:163]
    v_mul_f32 v204, v204, v240
    v_mul_f32 v205, v205, v241
    v_mfma_f32_16x16x32_bf16 v[164:167], v[84:87], v[60:63], v[164:167]
    v_mul_f32 v206, v206, v242
    v_mul_f32 v207, v207, v243
    v_mfma_f32_16x16x32_bf16 v[168:171], v[84:87], v[64:67], v[168:171]
    v_mul_f32 v208, v208, v244
    v_mul_f32 v209, v209, v245
    v_mfma_f32_16x16x32_bf16 v[172:175], v[88:91], v[52:55], v[172:175]
    v_mul_f32 v210, v210, v246
    v_mul_f32 v211, v211, v247
    v_mfma_f32_16x16x32_bf16 v[176:179], v[88:91], v[56:59], v[176:179]
    v_cvt_pk_bf16_f32 v204, v204, v205
    v_cvt_pk_bf16_f32 v205, v206, v207
    v_mfma_f32_16x16x32_bf16 v[180:183], v[88:91], v[60:63], v[180:183]
    v_cvt_pk_bf16_f32 v206, v208, v209
    v_cvt_pk_bf16_f32 v207, v210, v211
    v_mfma_f32_16x16x32_bf16 v[184:187], v[88:91], v[64:67], v[184:187]
    s_nop 0
    v_permlane16_swap_b32 v204, v206
    s_waitcnt lgkmcnt(13)
    v_mfma_f32_16x16x32_bf16 v[92:95], v[28:31], v[12:15], v[92:95]
    ds_read_b64_tr_b16 v[68:69], v6 offset:55296
    s_nop 0
    s_waitcnt lgkmcnt(13)
    v_mfma_f32_16x16x32_bf16 v[96:99], v[28:31], v[16:19], v[96:99]
    ds_read_b64_tr_b16 v[70:71], v6 offset:56064
    v_permlane16_swap_b32 v205, v207
    s_waitcnt lgkmcnt(13)
    v_mfma_f32_16x16x32_bf16 v[100:103], v[28:31], v[20:23], v[100:103]
    ds_read_b128 v[52:55], v4 offset:0
    buffer_store_dwordx4 v[204:207], v11, s[48:51], s59 offen offset:1024 sc1
    s_waitcnt lgkmcnt(13)
    v_mfma_f32_16x16x32_bf16 v[104:107], v[28:31], v[24:27], v[104:107]
    ds_read_b128 v[56:59], v4 offset:2048
    v_fmac_f32 v220, v232, v230
    s_waitcnt lgkmcnt(12)
    v_mfma_f32_16x16x32_bf16 v[108:111], v[32:35], v[12:15], v[108:111]
    ds_read_b128 v[60:63], v5 offset:0
    v_fmac_f32 v221, v233, v230
    v_mfma_f32_16x16x32_bf16 v[112:115], v[32:35], v[16:19], v[112:115]
    ds_read_b128 v[64:67], v5 offset:2048
    v_fmac_f32 v222, v234, v230
    v_mfma_f32_16x16x32_bf16 v[116:119], v[32:35], v[20:23], v[116:119]
    ds_read_b64_tr_b16 v[72:73], v8 offset:55296
    v_fmac_f32 v223, v235, v230
    v_mfma_f32_16x16x32_bf16 v[120:123], v[32:35], v[24:27], v[120:123]
    ds_read_b64_tr_b16 v[74:75], v8 offset:56064
    v_fmac_f32 v224, v236, v230
    s_waitcnt lgkmcnt(14)
    v_mfma_f32_16x16x32_bf16 v[124:127], v[36:39], v[12:15], v[124:127]
    ds_read_b64_tr_b16 v[76:77], v7 offset:55328
    v_fmac_f32 v225, v237, v230
    v_mfma_f32_16x16x32_bf16 v[128:131], v[36:39], v[16:19], v[128:131]
    ds_read_b64_tr_b16 v[78:79], v7 offset:56096
    v_fmac_f32 v226, v238, v230
    v_mfma_f32_16x16x32_bf16 v[132:135], v[36:39], v[20:23], v[132:135]
    ds_read_b64_tr_b16 v[80:81], v9 offset:55328
    v_fmac_f32 v227, v239, v230
    v_mfma_f32_16x16x32_bf16 v[136:139], v[36:39], v[24:27], v[136:139]
    ds_read_b64_tr_b16 v[82:83], v9 offset:56096
    v_mul_f32 v220, v220, v240
    s_waitcnt lgkmcnt(15)
    v_mfma_f32_16x16x32_bf16 v[140:143], v[40:43], v[12:15], v[140:143]
    ds_read_b64_tr_b16 v[84:85], v6 offset:55360
    v_mul_f32 v221, v221, v241
    v_mfma_f32_16x16x32_bf16 v[144:147], v[40:43], v[16:19], v[144:147]
    ds_read_b64_tr_b16 v[86:87], v6 offset:56128
    v_mul_f32 v222, v222, v242
    v_mfma_f32_16x16x32_bf16 v[148:151], v[40:43], v[20:23], v[148:151]
    ds_read_b64_tr_b16 v[88:89], v8 offset:55360
    v_mul_f32 v223, v223, v243
    v_mfma_f32_16x16x32_bf16 v[152:155], v[40:43], v[24:27], v[152:155]
    ds_read_b64_tr_b16 v[90:91], v8 offset:56128
    v_mul_f32 v224, v224, v244
    s_waitcnt lgkmcnt(15)
    v_mfma_f32_16x16x32_bf16 v[156:159], v[44:47], v[12:15], v[156:159]
    v_mul_f32 v225, v225, v245
    v_mul_f32 v226, v226, v246
    v_mfma_f32_16x16x32_bf16 v[160:163], v[44:47], v[16:19], v[160:163]
    v_mul_f32 v227, v227, v247
    v_cvt_pk_bf16_f32 v220, v220, v221
    v_mfma_f32_16x16x32_bf16 v[164:167], v[44:47], v[20:23], v[164:167]
    v_cvt_pk_bf16_f32 v221, v222, v223
    v_cvt_pk_bf16_f32 v222, v224, v225
    v_mfma_f32_16x16x32_bf16 v[168:171], v[44:47], v[24:27], v[168:171]
    v_cvt_pk_bf16_f32 v223, v226, v227
    s_nop 0
    v_mfma_f32_16x16x32_bf16 v[172:175], v[48:51], v[12:15], v[172:175]
    v_permlane16_swap_b32 v220, v222
    s_nop 0
    v_mfma_f32_16x16x32_bf16 v[176:179], v[48:51], v[16:19], v[176:179]
    v_permlane16_swap_b32 v221, v223
    buffer_store_dwordx4 v[220:223], v11, s[48:51], s63 offen offset:0 sc1
    v_mfma_f32_16x16x32_bf16 v[180:183], v[48:51], v[20:23], v[180:183]
    v_xor_b32 v10, 128, v10
    ds_read_b128 v[232:235], v10 offset:2048
    v_mfma_f32_16x16x32_bf16 v[184:187], v[48:51], v[24:27], v[184:187]
    ds_read_b128 v[240:243], v10 offset:2560
    ds_read_b128 v[236:239], v10 offset:2112
    s_waitcnt lgkmcnt(15)
    v_mfma_f32_16x16x32_bf16 v[92:95], v[68:71], v[52:55], v[92:95]
    s_waitcnt lgkmcnt(0)
    s_barrier
    ds_read_b64_tr_b16 v[28:29], v6 offset:24576
    ds_read_b128 v[244:247], v10 offset:2624
    v_mfma_f32_16x16x32_bf16 v[96:99], v[68:71], v[56:59], v[96:99]
    ds_read_b64_tr_b16 v[30:31], v6 offset:25344
    s_nop 0
    v_mfma_f32_16x16x32_bf16 v[100:103], v[68:71], v[60:63], v[100:103]
    ds_read_b128 v[12:15], v2 offset:16384
    s_nop 0
    v_mfma_f32_16x16x32_bf16 v[104:107], v[68:71], v[64:67], v[104:107]
    ds_read_b128 v[16:19], v2 offset:18432
    s_nop 0
    v_mfma_f32_16x16x32_bf16 v[108:111], v[72:75], v[52:55], v[108:111]
    ds_read_b128 v[20:23], v3 offset:16384
    s_nop 0
    v_mfma_f32_16x16x32_bf16 v[112:115], v[72:75], v[56:59], v[112:115]
    ds_read_b128 v[24:27], v3 offset:18432
    s_nop 0
    v_mfma_f32_16x16x32_bf16 v[116:119], v[72:75], v[60:63], v[116:119]
    ds_read_b64_tr_b16 v[32:33], v8 offset:24576
    s_nop 0
    v_mfma_f32_16x16x32_bf16 v[120:123], v[72:75], v[64:67], v[120:123]
    ds_read_b64_tr_b16 v[34:35], v8 offset:25344
    s_waitcnt lgkmcnt(7)
    v_mfma_f32_16x16x32_bf16 v[124:127], v[76:79], v[52:55], v[124:127]
    ds_read_b64_tr_b16 v[36:37], v7 offset:24608
    v_fmac_f32 v196, v232, v228
    v_mfma_f32_16x16x32_bf16 v[128:131], v[76:79], v[56:59], v[128:131]
    ds_read_b64_tr_b16 v[38:39], v7 offset:25376
    v_fmac_f32 v197, v233, v228
    v_mfma_f32_16x16x32_bf16 v[132:135], v[76:79], v[60:63], v[132:135]
    ds_read_b64_tr_b16 v[40:41], v9 offset:24608
    v_fmac_f32 v198, v234, v228
    v_mfma_f32_16x16x32_bf16 v[136:139], v[76:79], v[64:67], v[136:139]
    ds_read_b64_tr_b16 v[42:43], v9 offset:25376
    v_fmac_f32 v199, v235, v228
    v_mfma_f32_16x16x32_bf16 v[140:143], v[80:83], v[52:55], v[140:143]
    ds_read_b64_tr_b16 v[44:45], v6 offset:24640
    v_fmac_f32 v200, v236, v228
    v_mfma_f32_16x16x32_bf16 v[144:147], v[80:83], v[56:59], v[144:147]
    ds_read_b64_tr_b16 v[46:47], v6 offset:25408
    v_fmac_f32 v201, v237, v228
    v_mfma_f32_16x16x32_bf16 v[148:151], v[80:83], v[60:63], v[148:151]
    ds_read_b64_tr_b16 v[48:49], v8 offset:24640
    v_fmac_f32 v202, v238, v228
    v_mfma_f32_16x16x32_bf16 v[152:155], v[80:83], v[64:67], v[152:155]
    ds_read_b64_tr_b16 v[50:51], v8 offset:25408
    v_fmac_f32 v203, v239, v228
    v_mfma_f32_16x16x32_bf16 v[156:159], v[84:87], v[52:55], v[156:159]
    v_mul_f32 v196, v196, v240
    v_mul_f32 v197, v197, v241
    v_mfma_f32_16x16x32_bf16 v[160:163], v[84:87], v[56:59], v[160:163]
    v_mul_f32 v198, v198, v242
    v_mul_f32 v199, v199, v243
    v_mfma_f32_16x16x32_bf16 v[164:167], v[84:87], v[60:63], v[164:167]
    v_mul_f32 v200, v200, v244
    v_mul_f32 v201, v201, v245
    v_mfma_f32_16x16x32_bf16 v[168:171], v[84:87], v[64:67], v[168:171]
    v_mul_f32 v202, v202, v246
    v_mul_f32 v203, v203, v247
    v_mfma_f32_16x16x32_bf16 v[172:175], v[88:91], v[52:55], v[172:175]
    v_cvt_pk_bf16_f32 v196, v196, v197
    v_cvt_pk_bf16_f32 v197, v198, v199
    v_mfma_f32_16x16x32_bf16 v[176:179], v[88:91], v[56:59], v[176:179]
    v_cvt_pk_bf16_f32 v198, v200, v201
    v_cvt_pk_bf16_f32 v199, v202, v203
    v_mfma_f32_16x16x32_bf16 v[180:183], v[88:91], v[60:63], v[180:183]
    s_nop 0
    v_permlane16_swap_b32 v196, v198
    v_mfma_f32_16x16x32_bf16 v[184:187], v[88:91], v[64:67], v[184:187]
    s_nop 0
    v_permlane16_swap_b32 v197, v199
    s_waitcnt lgkmcnt(13)
    v_mfma_f32_16x16x32_bf16 v[92:95], v[28:31], v[12:15], v[92:95]
    ds_read_b64_tr_b16 v[68:69], v6 offset:30720
    buffer_store_dwordx4 v[196:199], v11, s[48:51], s60 offen offset:0 sc1
    s_waitcnt lgkmcnt(13)
    v_mfma_f32_16x16x32_bf16 v[96:99], v[28:31], v[16:19], v[96:99]
    ds_read_b64_tr_b16 v[70:71], v6 offset:31488
    v_fmac_f32 v212, v232, v229
    s_waitcnt lgkmcnt(13)
    v_mfma_f32_16x16x32_bf16 v[100:103], v[28:31], v[20:23], v[100:103]
    ds_read_b128 v[52:55], v4 offset:16384
    v_fmac_f32 v213, v233, v229
    s_waitcnt lgkmcnt(13)
    v_mfma_f32_16x16x32_bf16 v[104:107], v[28:31], v[24:27], v[104:107]
    ds_read_b128 v[56:59], v4 offset:18432
    v_fmac_f32 v214, v234, v229
    s_waitcnt lgkmcnt(12)
    v_mfma_f32_16x16x32_bf16 v[108:111], v[32:35], v[12:15], v[108:111]
    ds_read_b128 v[60:63], v5 offset:16384
    v_fmac_f32 v215, v235, v229
    v_mfma_f32_16x16x32_bf16 v[112:115], v[32:35], v[16:19], v[112:115]
    ds_read_b128 v[64:67], v5 offset:18432
    v_fmac_f32 v216, v236, v229
    v_mfma_f32_16x16x32_bf16 v[116:119], v[32:35], v[20:23], v[116:119]
    ds_read_b64_tr_b16 v[72:73], v8 offset:30720
    v_fmac_f32 v217, v237, v229
    v_mfma_f32_16x16x32_bf16 v[120:123], v[32:35], v[24:27], v[120:123]
    ds_read_b64_tr_b16 v[74:75], v8 offset:31488
    v_fmac_f32 v218, v238, v229
    s_waitcnt lgkmcnt(14)
    v_mfma_f32_16x16x32_bf16 v[124:127], v[36:39], v[12:15], v[124:127]
    ds_read_b64_tr_b16 v[76:77], v7 offset:30752
    v_fmac_f32 v219, v239, v229
    v_mfma_f32_16x16x32_bf16 v[128:131], v[36:39], v[16:19], v[128:131]
    ds_read_b64_tr_b16 v[78:79], v7 offset:31520
    v_mul_f32 v212, v212, v240
    v_mfma_f32_16x16x32_bf16 v[132:135], v[36:39], v[20:23], v[132:135]
    ds_read_b64_tr_b16 v[80:81], v9 offset:30752
    v_mul_f32 v213, v213, v241
    v_mfma_f32_16x16x32_bf16 v[136:139], v[36:39], v[24:27], v[136:139]
    ds_read_b64_tr_b16 v[82:83], v9 offset:31520
    v_mul_f32 v214, v214, v242
    s_waitcnt lgkmcnt(15)
    v_mfma_f32_16x16x32_bf16 v[140:143], v[40:43], v[12:15], v[140:143]
    ds_read_b64_tr_b16 v[84:85], v6 offset:30784
    v_mul_f32 v215, v215, v243
    v_mfma_f32_16x16x32_bf16 v[144:147], v[40:43], v[16:19], v[144:147]
    ds_read_b64_tr_b16 v[86:87], v6 offset:31552
    v_mul_f32 v216, v216, v244
    v_mfma_f32_16x16x32_bf16 v[148:151], v[40:43], v[20:23], v[148:151]
    ds_read_b64_tr_b16 v[88:89], v8 offset:30784
    v_mul_f32 v217, v217, v245
    v_mfma_f32_16x16x32_bf16 v[152:155], v[40:43], v[24:27], v[152:155]
    ds_read_b64_tr_b16 v[90:91], v8 offset:31552
    v_subrev_u32 v2, 49152, v2
    s_waitcnt lgkmcnt(15)
    v_mfma_f32_16x16x32_bf16 v[156:159], v[44:47], v[12:15], v[156:159]
    v_subrev_u32 v3, 49152, v3
    v_subrev_u32 v4, 49152, v4
    v_mfma_f32_16x16x32_bf16 v[160:163], v[44:47], v[16:19], v[160:163]
    v_subrev_u32 v5, 49152, v5
    v_mul_f32 v218, v218, v246
    v_mfma_f32_16x16x32_bf16 v[164:167], v[44:47], v[20:23], v[164:167]
    v_mul_f32 v219, v219, v247
    v_cvt_pk_bf16_f32 v212, v212, v213
    v_mfma_f32_16x16x32_bf16 v[168:171], v[44:47], v[24:27], v[168:171]
    v_cvt_pk_bf16_f32 v213, v214, v215
    v_cvt_pk_bf16_f32 v214, v216, v217
    v_mfma_f32_16x16x32_bf16 v[172:175], v[48:51], v[12:15], v[172:175]
    v_cvt_pk_bf16_f32 v215, v218, v219
    s_nop 0
    v_mfma_f32_16x16x32_bf16 v[176:179], v[48:51], v[16:19], v[176:179]
    v_permlane16_swap_b32 v212, v214
    s_nop 0
    v_mfma_f32_16x16x32_bf16 v[180:183], v[48:51], v[20:23], v[180:183]
    v_permlane16_swap_b32 v213, v215
    buffer_store_dwordx4 v[212:215], v11, s[48:51], s60 offen offset:1024 sc1
    v_mfma_f32_16x16x32_bf16 v[184:187], v[48:51], v[24:27], v[184:187]
    s_waitcnt lgkmcnt(13)
    v_mfma_f32_16x16x32_bf16 v[92:95], v[68:71], v[52:55], v[92:95]
    s_waitcnt lgkmcnt(0)
    s_barrier
    ds_read_b64_tr_b16 v[28:29], v6 offset:0
    v_mfma_f32_16x16x32_bf16 v[96:99], v[68:71], v[56:59], v[96:99]
    ds_read_b64_tr_b16 v[30:31], v6 offset:768
    v_mfma_f32_16x16x32_bf16 v[100:103], v[68:71], v[60:63], v[100:103]
    ds_read_b128 v[12:15], v2 offset:0
    v_mfma_f32_16x16x32_bf16 v[104:107], v[68:71], v[64:67], v[104:107]
    ds_read_b128 v[16:19], v2 offset:2048
    v_mfma_f32_16x16x32_bf16 v[108:111], v[72:75], v[52:55], v[108:111]
    ds_read_b128 v[20:23], v3 offset:0
    v_mfma_f32_16x16x32_bf16 v[112:115], v[72:75], v[56:59], v[112:115]
    ds_read_b128 v[24:27], v3 offset:2048
    v_mfma_f32_16x16x32_bf16 v[116:119], v[72:75], v[60:63], v[116:119]
    ds_read_b64_tr_b16 v[32:33], v8 offset:0
    v_mfma_f32_16x16x32_bf16 v[120:123], v[72:75], v[64:67], v[120:123]
    ds_read_b64_tr_b16 v[34:35], v8 offset:768
    v_mfma_f32_16x16x32_bf16 v[124:127], v[76:79], v[52:55], v[124:127]
    ds_read_b64_tr_b16 v[36:37], v7 offset:32
    v_mfma_f32_16x16x32_bf16 v[128:131], v[76:79], v[56:59], v[128:131]
    ds_read_b64_tr_b16 v[38:39], v7 offset:800
    v_mfma_f32_16x16x32_bf16 v[132:135], v[76:79], v[60:63], v[132:135]
    ds_read_b64_tr_b16 v[40:41], v9 offset:32
    v_mfma_f32_16x16x32_bf16 v[136:139], v[76:79], v[64:67], v[136:139]
    ds_read_b64_tr_b16 v[42:43], v9 offset:800
    v_mfma_f32_16x16x32_bf16 v[140:143], v[80:83], v[52:55], v[140:143]
    ds_read_b64_tr_b16 v[44:45], v6 offset:64
    v_mfma_f32_16x16x32_bf16 v[144:147], v[80:83], v[56:59], v[144:147]
    ds_read_b64_tr_b16 v[46:47], v6 offset:832
    v_mfma_f32_16x16x32_bf16 v[148:151], v[80:83], v[60:63], v[148:151]
    ds_read_b64_tr_b16 v[48:49], v8 offset:64
    v_mfma_f32_16x16x32_bf16 v[152:155], v[80:83], v[64:67], v[152:155]
    ds_read_b64_tr_b16 v[50:51], v8 offset:832
    v_mfma_f32_16x16x32_bf16 v[156:159], v[84:87], v[52:55], v[156:159]
    v_mfma_f32_16x16x32_bf16 v[160:163], v[84:87], v[56:59], v[160:163]
    v_mfma_f32_16x16x32_bf16 v[164:167], v[84:87], v[60:63], v[164:167]
    v_mfma_f32_16x16x32_bf16 v[168:171], v[84:87], v[64:67], v[168:171]
    v_mfma_f32_16x16x32_bf16 v[172:175], v[88:91], v[52:55], v[172:175]
    v_mfma_f32_16x16x32_bf16 v[176:179], v[88:91], v[56:59], v[176:179]
    v_mfma_f32_16x16x32_bf16 v[180:183], v[88:91], v[60:63], v[180:183]
    v_mfma_f32_16x16x32_bf16 v[184:187], v[88:91], v[64:67], v[184:187]
    s_waitcnt lgkmcnt(13)
    v_mfma_f32_16x16x32_bf16 v[92:95], v[28:31], v[12:15], v[92:95]
    ds_read_b64_tr_b16 v[68:69], v6 offset:6144
    s_waitcnt lgkmcnt(13)
    v_mfma_f32_16x16x32_bf16 v[96:99], v[28:31], v[16:19], v[96:99]
    ds_read_b64_tr_b16 v[70:71], v6 offset:6912
    s_waitcnt lgkmcnt(13)
    v_mfma_f32_16x16x32_bf16 v[100:103], v[28:31], v[20:23], v[100:103]
    ds_read_b128 v[52:55], v4 offset:0
    s_waitcnt lgkmcnt(13)
    v_mfma_f32_16x16x32_bf16 v[104:107], v[28:31], v[24:27], v[104:107]
    ds_read_b128 v[56:59], v4 offset:2048
    s_waitcnt lgkmcnt(12)
    v_mfma_f32_16x16x32_bf16 v[108:111], v[32:35], v[12:15], v[108:111]
    ds_read_b128 v[60:63], v5 offset:0
    v_mfma_f32_16x16x32_bf16 v[112:115], v[32:35], v[16:19], v[112:115]
    ds_read_b128 v[64:67], v5 offset:2048
    v_mfma_f32_16x16x32_bf16 v[116:119], v[32:35], v[20:23], v[116:119]
    ds_read_b64_tr_b16 v[72:73], v8 offset:6144
    v_mfma_f32_16x16x32_bf16 v[120:123], v[32:35], v[24:27], v[120:123]
    ds_read_b64_tr_b16 v[74:75], v8 offset:6912
    s_waitcnt lgkmcnt(14)
    v_mfma_f32_16x16x32_bf16 v[124:127], v[36:39], v[12:15], v[124:127]
    ds_read_b64_tr_b16 v[76:77], v7 offset:6176
    v_mfma_f32_16x16x32_bf16 v[128:131], v[36:39], v[16:19], v[128:131]
    ds_read_b64_tr_b16 v[78:79], v7 offset:6944
    v_mfma_f32_16x16x32_bf16 v[132:135], v[36:39], v[20:23], v[132:135]
    ds_read_b64_tr_b16 v[80:81], v9 offset:6176
    v_mfma_f32_16x16x32_bf16 v[136:139], v[36:39], v[24:27], v[136:139]
    ds_read_b64_tr_b16 v[82:83], v9 offset:6944
    s_waitcnt lgkmcnt(15)
    v_mfma_f32_16x16x32_bf16 v[140:143], v[40:43], v[12:15], v[140:143]
    ds_read_b64_tr_b16 v[84:85], v6 offset:6208
    v_mfma_f32_16x16x32_bf16 v[144:147], v[40:43], v[16:19], v[144:147]
    ds_read_b64_tr_b16 v[86:87], v6 offset:6976
    v_mfma_f32_16x16x32_bf16 v[148:151], v[40:43], v[20:23], v[148:151]
    ds_read_b64_tr_b16 v[88:89], v8 offset:6208
    v_mfma_f32_16x16x32_bf16 v[152:155], v[40:43], v[24:27], v[152:155]
    ds_read_b64_tr_b16 v[90:91], v8 offset:6976
    v_lshlrev_b32 v249, 2, v1
    s_waitcnt lgkmcnt(15)
    v_mfma_f32_16x16x32_bf16 v[156:159], v[44:47], v[12:15], v[156:159]
    s_waitcnt vmcnt(0)
    v_mfma_f32_16x16x32_bf16 v[160:163], v[44:47], v[16:19], v[160:163]
    v_mfma_f32_16x16x32_bf16 v[164:167], v[44:47], v[20:23], v[164:167]
    v_mfma_f32_16x16x32_bf16 v[168:171], v[44:47], v[24:27], v[168:171]
    v_mfma_f32_16x16x32_bf16 v[172:175], v[48:51], v[12:15], v[172:175]
    v_mfma_f32_16x16x32_bf16 v[176:179], v[48:51], v[16:19], v[176:179]
    v_mfma_f32_16x16x32_bf16 v[180:183], v[48:51], v[20:23], v[180:183]
    v_mfma_f32_16x16x32_bf16 v[184:187], v[48:51], v[24:27], v[184:187]
    s_waitcnt lgkmcnt(13)
    v_mfma_f32_16x16x32_bf16 v[92:95], v[68:71], v[52:55], v[92:95]
    s_waitcnt lgkmcnt(0)
    s_barrier
    ds_read_b64_tr_b16 v[28:29], v6 offset:49152
    s_cmp_lg_u32 s28, 0
    s_cbranch_scc1 .f_fls61
    buffer_store_dword v248, off, s[52:55], s61 sc1
.f_fls61:
    v_mfma_f32_16x16x32_bf16 v[96:99], v[68:71], v[56:59], v[96:99]
    ds_read_b64_tr_b16 v[30:31], v6 offset:49920
    v_mfma_f32_16x16x32_bf16 v[100:103], v[68:71], v[60:63], v[100:103]
    ds_read_b128 v[12:15], v2 offset:16384
    v_mfma_f32_16x16x32_bf16 v[104:107], v[68:71], v[64:67], v[104:107]
    ds_read_b128 v[16:19], v2 offset:18432
    v_mfma_f32_16x16x32_bf16 v[108:111], v[72:75], v[52:55], v[108:111]
    ds_read_b128 v[20:23], v3 offset:16384
    v_mfma_f32_16x16x32_bf16 v[112:115], v[72:75], v[56:59], v[112:115]
    ds_read_b128 v[24:27], v3 offset:18432
    v_mfma_f32_16x16x32_bf16 v[116:119], v[72:75], v[60:63], v[116:119]
    ds_read_b64_tr_b16 v[32:33], v8 offset:49152
    v_mfma_f32_16x16x32_bf16 v[120:123], v[72:75], v[64:67], v[120:123]
    ds_read_b64_tr_b16 v[34:35], v8 offset:49920
    v_mfma_f32_16x16x32_bf16 v[124:127], v[76:79], v[52:55], v[124:127]
    ds_read_b64_tr_b16 v[36:37], v7 offset:49184
    v_mfma_f32_16x16x32_bf16 v[128:131], v[76:79], v[56:59], v[128:131]
    ds_read_b64_tr_b16 v[38:39], v7 offset:49952
    v_mfma_f32_16x16x32_bf16 v[132:135], v[76:79], v[60:63], v[132:135]
    ds_read_b64_tr_b16 v[40:41], v9 offset:49184
    v_mfma_f32_16x16x32_bf16 v[136:139], v[76:79], v[64:67], v[136:139]
    ds_read_b64_tr_b16 v[42:43], v9 offset:49952
    v_mfma_f32_16x16x32_bf16 v[140:143], v[80:83], v[52:55], v[140:143]
    ds_read_b64_tr_b16 v[44:45], v6 offset:49216
    v_mfma_f32_16x16x32_bf16 v[144:147], v[80:83], v[56:59], v[144:147]
    ds_read_b64_tr_b16 v[46:47], v6 offset:49984
    v_mfma_f32_16x16x32_bf16 v[148:151], v[80:83], v[60:63], v[148:151]
    ds_read_b64_tr_b16 v[48:49], v8 offset:49216
    v_mfma_f32_16x16x32_bf16 v[152:155], v[80:83], v[64:67], v[152:155]
    ds_read_b64_tr_b16 v[50:51], v8 offset:49984
    v_mfma_f32_16x16x32_bf16 v[156:159], v[84:87], v[52:55], v[156:159]
    v_mfma_f32_16x16x32_bf16 v[160:163], v[84:87], v[56:59], v[160:163]
    v_mfma_f32_16x16x32_bf16 v[164:167], v[84:87], v[60:63], v[164:167]
    v_mfma_f32_16x16x32_bf16 v[168:171], v[84:87], v[64:67], v[168:171]
    v_mfma_f32_16x16x32_bf16 v[172:175], v[88:91], v[52:55], v[172:175]
    v_mfma_f32_16x16x32_bf16 v[176:179], v[88:91], v[56:59], v[176:179]
    v_mfma_f32_16x16x32_bf16 v[180:183], v[88:91], v[60:63], v[180:183]
    v_mfma_f32_16x16x32_bf16 v[184:187], v[88:91], v[64:67], v[184:187]
    s_waitcnt lgkmcnt(13)
    v_mfma_f32_16x16x32_bf16 v[92:95], v[28:31], v[12:15], v[92:95]
    ds_read_b64_tr_b16 v[68:69], v6 offset:55296
    s_waitcnt lgkmcnt(13)
    v_mfma_f32_16x16x32_bf16 v[96:99], v[28:31], v[16:19], v[96:99]
    ds_read_b64_tr_b16 v[70:71], v6 offset:56064
    s_waitcnt lgkmcnt(13)
    v_mfma_f32_16x16x32_bf16 v[100:103], v[28:31], v[20:23], v[100:103]
    ds_read_b128 v[52:55], v4 offset:16384
    s_waitcnt lgkmcnt(13)
    v_mfma_f32_16x16x32_bf16 v[104:107], v[28:31], v[24:27], v[104:107]
    ds_read_b128 v[56:59], v4 offset:18432
    s_waitcnt lgkmcnt(12)
    v_mfma_f32_16x16x32_bf16 v[108:111], v[32:35], v[12:15], v[108:111]
    ds_read_b128 v[60:63], v5 offset:16384
    v_mfma_f32_16x16x32_bf16 v[112:115], v[32:35], v[16:19], v[112:115]
    ds_read_b128 v[64:67], v5 offset:18432
    v_mfma_f32_16x16x32_bf16 v[116:119], v[32:35], v[20:23], v[116:119]
    ds_read_b64_tr_b16 v[72:73], v8 offset:55296
    v_mfma_f32_16x16x32_bf16 v[120:123], v[32:35], v[24:27], v[120:123]
    ds_read_b64_tr_b16 v[74:75], v8 offset:56064
    s_waitcnt lgkmcnt(14)
    v_mfma_f32_16x16x32_bf16 v[124:127], v[36:39], v[12:15], v[124:127]
    ds_read_b64_tr_b16 v[76:77], v7 offset:55328
    v_mfma_f32_16x16x32_bf16 v[128:131], v[36:39], v[16:19], v[128:131]
    ds_read_b64_tr_b16 v[78:79], v7 offset:56096
    v_mfma_f32_16x16x32_bf16 v[132:135], v[36:39], v[20:23], v[132:135]
    ds_read_b64_tr_b16 v[80:81], v9 offset:55328
    v_mfma_f32_16x16x32_bf16 v[136:139], v[36:39], v[24:27], v[136:139]
    ds_read_b64_tr_b16 v[82:83], v9 offset:56096
    s_waitcnt lgkmcnt(15)
    v_mfma_f32_16x16x32_bf16 v[140:143], v[40:43], v[12:15], v[140:143]
    ds_read_b64_tr_b16 v[84:85], v6 offset:55360
    v_mfma_f32_16x16x32_bf16 v[144:147], v[40:43], v[16:19], v[144:147]
    ds_read_b64_tr_b16 v[86:87], v6 offset:56128
    v_mfma_f32_16x16x32_bf16 v[148:151], v[40:43], v[20:23], v[148:151]
    ds_read_b64_tr_b16 v[88:89], v8 offset:55360
    v_mfma_f32_16x16x32_bf16 v[152:155], v[40:43], v[24:27], v[152:155]
    ds_read_b64_tr_b16 v[90:91], v8 offset:56128
    s_waitcnt lgkmcnt(15)
    v_mfma_f32_16x16x32_bf16 v[156:159], v[44:47], v[12:15], v[156:159]
    v_mfma_f32_16x16x32_bf16 v[160:163], v[44:47], v[16:19], v[160:163]
    v_mfma_f32_16x16x32_bf16 v[164:167], v[44:47], v[20:23], v[164:167]
    v_mfma_f32_16x16x32_bf16 v[168:171], v[44:47], v[24:27], v[168:171]
    v_mfma_f32_16x16x32_bf16 v[172:175], v[48:51], v[12:15], v[172:175]
    v_mfma_f32_16x16x32_bf16 v[176:179], v[48:51], v[16:19], v[176:179]
    v_mfma_f32_16x16x32_bf16 v[180:183], v[48:51], v[20:23], v[180:183]
    v_mfma_f32_16x16x32_bf16 v[184:187], v[48:51], v[24:27], v[184:187]
    s_waitcnt lgkmcnt(13)
    v_mfma_f32_16x16x32_bf16 v[92:95], v[68:71], v[52:55], v[92:95]
    s_waitcnt lgkmcnt(0)
    s_barrier
    ds_read_b64_tr_b16 v[28:29], v6 offset:24576
    v_mfma_f32_16x16x32_bf16 v[96:99], v[68:71], v[56:59], v[96:99]
    ds_read_b64_tr_b16 v[30:31], v6 offset:25344
    v_mfma_f32_16x16x32_bf16 v[100:103], v[68:71], v[60:63], v[100:103]
    ds_read_b128 v[12:15], v2 offset:32768
    v_mfma_f32_16x16x32_bf16 v[104:107], v[68:71], v[64:67], v[104:107]
    ds_read_b128 v[16:19], v2 offset:34816
    v_mfma_f32_16x16x32_bf16 v[108:111], v[72:75], v[52:55], v[108:111]
    ds_read_b128 v[20:23], v3 offset:32768
    v_mfma_f32_16x16x32_bf16 v[112:115], v[72:75], v[56:59], v[112:115]
    ds_read_b128 v[24:27], v3 offset:34816
    v_mfma_f32_16x16x32_bf16 v[116:119], v[72:75], v[60:63], v[116:119]
    ds_read_b64_tr_b16 v[32:33], v8 offset:24576
    v_mfma_f32_16x16x32_bf16 v[120:123], v[72:75], v[64:67], v[120:123]
    ds_read_b64_tr_b16 v[34:35], v8 offset:25344
    v_mfma_f32_16x16x32_bf16 v[124:127], v[76:79], v[52:55], v[124:127]
    ds_read_b64_tr_b16 v[36:37], v7 offset:24608
    v_mfma_f32_16x16x32_bf16 v[128:131], v[76:79], v[56:59], v[128:131]
    ds_read_b64_tr_b16 v[38:39], v7 offset:25376
    v_mfma_f32_16x16x32_bf16 v[132:135], v[76:79], v[60:63], v[132:135]
    ds_read_b64_tr_b16 v[40:41], v9 offset:24608
    v_mfma_f32_16x16x32_bf16 v[136:139], v[76:79], v[64:67], v[136:139]
    ds_read_b64_tr_b16 v[42:43], v9 offset:25376
    v_mfma_f32_16x16x32_bf16 v[140:143], v[80:83], v[52:55], v[140:143]
    ds_read_b64_tr_b16 v[44:45], v6 offset:24640
    v_mfma_f32_16x16x32_bf16 v[144:147], v[80:83], v[56:59], v[144:147]
    ds_read_b64_tr_b16 v[46:47], v6 offset:25408
    v_mfma_f32_16x16x32_bf16 v[148:151], v[80:83], v[60:63], v[148:151]
    ds_read_b64_tr_b16 v[48:49], v8 offset:24640
    v_mfma_f32_16x16x32_bf16 v[152:155], v[80:83], v[64:67], v[152:155]
    ds_read_b64_tr_b16 v[50:51], v8 offset:25408
    v_mfma_f32_16x16x32_bf16 v[156:159], v[84:87], v[52:55], v[156:159]
    v_mfma_f32_16x16x32_bf16 v[160:163], v[84:87], v[56:59], v[160:163]
    v_mfma_f32_16x16x32_bf16 v[164:167], v[84:87], v[60:63], v[164:167]
    v_mfma_f32_16x16x32_bf16 v[168:171], v[84:87], v[64:67], v[168:171]
    v_mfma_f32_16x16x32_bf16 v[172:175], v[88:91], v[52:55], v[172:175]
    v_mfma_f32_16x16x32_bf16 v[176:179], v[88:91], v[56:59], v[176:179]
    v_mfma_f32_16x16x32_bf16 v[180:183], v[88:91], v[60:63], v[180:183]
    v_mfma_f32_16x16x32_bf16 v[184:187], v[88:91], v[64:67], v[184:187]
    s_waitcnt lgkmcnt(13)
    v_mfma_f32_16x16x32_bf16 v[92:95], v[28:31], v[12:15], v[92:95]
    ds_read_b64_tr_b16 v[68:69], v6 offset:30720
    s_waitcnt lgkmcnt(13)
    v_mfma_f32_16x16x32_bf16 v[96:99], v[28:31], v[16:19], v[96:99]
    ds_read_b64_tr_b16 v[70:71], v6 offset:31488
    s_waitcnt lgkmcnt(13)
    v_mfma_f32_16x16x32_bf16 v[100:103], v[28:31], v[20:23], v[100:103]
    ds_read_b128 v[52:55], v4 offset:32768
    s_waitcnt lgkmcnt(13)
    v_mfma_f32_16x16x32_bf16 v[104:107], v[28:31], v[24:27], v[104:107]
    ds_read_b128 v[56:59], v4 offset:34816
    s_waitcnt lgkmcnt(12)
    v_mfma_f32_16x16x32_bf16 v[108:111], v[32:35], v[12:15], v[108:111]
    ds_read_b128 v[60:63], v5 offset:32768
    v_mfma_f32_16x16x32_bf16 v[112:115], v[32:35], v[16:19], v[112:115]
    ds_read_b128 v[64:67], v5 offset:34816
    v_mfma_f32_16x16x32_bf16 v[116:119], v[32:35], v[20:23], v[116:119]
    ds_read_b64_tr_b16 v[72:73], v8 offset:30720
    v_mfma_f32_16x16x32_bf16 v[120:123], v[32:35], v[24:27], v[120:123]
    ds_read_b64_tr_b16 v[74:75], v8 offset:31488
    s_waitcnt lgkmcnt(14)
    v_mfma_f32_16x16x32_bf16 v[124:127], v[36:39], v[12:15], v[124:127]
    ds_read_b64_tr_b16 v[76:77], v7 offset:30752
    v_mfma_f32_16x16x32_bf16 v[128:131], v[36:39], v[16:19], v[128:131]
    ds_read_b64_tr_b16 v[78:79], v7 offset:31520
    v_mfma_f32_16x16x32_bf16 v[132:135], v[36:39], v[20:23], v[132:135]
    ds_read_b64_tr_b16 v[80:81], v9 offset:30752
    v_mfma_f32_16x16x32_bf16 v[136:139], v[36:39], v[24:27], v[136:139]
    ds_read_b64_tr_b16 v[82:83], v9 offset:31520
    s_waitcnt lgkmcnt(15)
    v_mfma_f32_16x16x32_bf16 v[140:143], v[40:43], v[12:15], v[140:143]
    ds_read_b64_tr_b16 v[84:85], v6 offset:30784
    v_mfma_f32_16x16x32_bf16 v[144:147], v[40:43], v[16:19], v[144:147]
    ds_read_b64_tr_b16 v[86:87], v6 offset:31552
    v_mfma_f32_16x16x32_bf16 v[148:151], v[40:43], v[20:23], v[148:151]
    ds_read_b64_tr_b16 v[88:89], v8 offset:30784
    v_mfma_f32_16x16x32_bf16 v[152:155], v[40:43], v[24:27], v[152:155]
    ds_read_b64_tr_b16 v[90:91], v8 offset:31552
    v_add_u32 v2, 49152, v2
    s_waitcnt lgkmcnt(15)
    v_mfma_f32_16x16x32_bf16 v[156:159], v[44:47], v[12:15], v[156:159]
    v_add_u32 v3, 49152, v3
    v_add_u32 v4, 49152, v4
    v_mfma_f32_16x16x32_bf16 v[160:163], v[44:47], v[16:19], v[160:163]
    v_add_u32 v5, 49152, v5
    v_mfma_f32_16x16x32_bf16 v[164:167], v[44:47], v[20:23], v[164:167]
    v_mfma_f32_16x16x32_bf16 v[168:171], v[44:47], v[24:27], v[168:171]
    v_mfma_f32_16x16x32_bf16 v[172:175], v[48:51], v[12:15], v[172:175]
    v_mfma_f32_16x16x32_bf16 v[176:179], v[48:51], v[16:19], v[176:179]
    v_mfma_f32_16x16x32_bf16 v[180:183], v[48:51], v[20:23], v[180:183]
    v_mfma_f32_16x16x32_bf16 v[184:187], v[48:51], v[24:27], v[184:187]
    s_waitcnt lgkmcnt(13)
    v_mfma_f32_16x16x32_bf16 v[92:95], v[68:71], v[52:55], v[92:95]
    s_waitcnt lgkmcnt(0)
    s_barrier
    ds_read_b64_tr_b16 v[28:29], v6 offset:0
    v_mfma_f32_16x16x32_bf16 v[96:99], v[68:71], v[56:59], v[96:99]
    ds_read_b64_tr_b16 v[30:31], v6 offset:768
    v_mfma_f32_16x16x32_bf16 v[100:103], v[68:71], v[60:63], v[100:103]
    ds_read_b128 v[12:15], v2 offset:0
    v_mfma_f32_16x16x32_bf16 v[104:107], v[68:71], v[64:67], v[104:107]
    ds_read_b128 v[16:19], v2 offset:2048
    v_mfma_f32_16x16x32_bf16 v[108:111], v[72:75], v[52:55], v[108:111]
    ds_read_b128 v[20:23], v3 offset:0
    v_mfma_f32_16x16x32_bf16 v[112:115], v[72:75], v[56:59], v[112:115]
    ds_read_b128 v[24:27], v3 offset:2048
    v_mfma_f32_16x16x32_bf16 v[116:119], v[72:75], v[60:63], v[116:119]
    ds_read_b64_tr_b16 v[32:33], v8 offset:0
    v_mfma_f32_16x16x32_bf16 v[120:123], v[72:75], v[64:67], v[120:123]
    ds_read_b64_tr_b16 v[34:35], v8 offset:768
    v_mfma_f32_16x16x32_bf16 v[124:127], v[76:79], v[52:55], v[124:127]
    ds_read_b64_tr_b16 v[36:37], v7 offset:32
    v_mfma_f32_16x16x32_bf16 v[128:131], v[76:79], v[56:59], v[128:131]
    ds_read_b64_tr_b16 v[38:39], v7 offset:800
    v_mfma_f32_16x16x32_bf16 v[132:135], v[76:79], v[60:63], v[132:135]
    ds_read_b64_tr_b16 v[40:41], v9 offset:32
    v_mfma_f32_16x16x32_bf16 v[136:139], v[76:79], v[64:67], v[136:139]
    ds_read_b64_tr_b16 v[42:43], v9 offset:800
    v_mfma_f32_16x16x32_bf16 v[140:143], v[80:83], v[52:55], v[140:143]
    ds_read_b64_tr_b16 v[44:45], v6 offset:64
    v_mfma_f32_16x16x32_bf16 v[144:147], v[80:83], v[56:59], v[144:147]
    ds_read_b64_tr_b16 v[46:47], v6 offset:832
    v_mfma_f32_16x16x32_bf16 v[148:151], v[80:83], v[60:63], v[148:151]
    ds_read_b64_tr_b16 v[48:49], v8 offset:64
    v_mfma_f32_16x16x32_bf16 v[152:155], v[80:83], v[64:67], v[152:155]
    ds_read_b64_tr_b16 v[50:51], v8 offset:832
    v_mfma_f32_16x16x32_bf16 v[156:159], v[84:87], v[52:55], v[156:159]
    v_mfma_f32_16x16x32_bf16 v[160:163], v[84:87], v[56:59], v[160:163]
    v_mfma_f32_16x16x32_bf16 v[164:167], v[84:87], v[60:63], v[164:167]
    v_mfma_f32_16x16x32_bf16 v[168:171], v[84:87], v[64:67], v[168:171]
    v_mfma_f32_16x16x32_bf16 v[172:175], v[88:91], v[52:55], v[172:175]
    v_mfma_f32_16x16x32_bf16 v[176:179], v[88:91], v[56:59], v[176:179]
    v_mfma_f32_16x16x32_bf16 v[180:183], v[88:91], v[60:63], v[180:183]
    v_mfma_f32_16x16x32_bf16 v[184:187], v[88:91], v[64:67], v[184:187]
    s_waitcnt lgkmcnt(13)
    v_mfma_f32_16x16x32_bf16 v[92:95], v[28:31], v[12:15], v[92:95]
    ds_read_b64_tr_b16 v[68:69], v6 offset:6144
    s_waitcnt lgkmcnt(13)
    v_mfma_f32_16x16x32_bf16 v[96:99], v[28:31], v[16:19], v[96:99]
    ds_read_b64_tr_b16 v[70:71], v6 offset:6912
    s_waitcnt lgkmcnt(13)
    v_mfma_f32_16x16x32_bf16 v[100:103], v[28:31], v[20:23], v[100:103]
    ds_read_b128 v[52:55], v4 offset:0
    s_waitcnt lgkmcnt(13)
    v_mfma_f32_16x16x32_bf16 v[104:107], v[28:31], v[24:27], v[104:107]
    ds_read_b128 v[56:59], v4 offset:2048
    s_waitcnt lgkmcnt(12)
    v_mfma_f32_16x16x32_bf16 v[108:111], v[32:35], v[12:15], v[108:111]
    ds_read_b128 v[60:63], v5 offset:0
    v_mfma_f32_16x16x32_bf16 v[112:115], v[32:35], v[16:19], v[112:115]
    ds_read_b128 v[64:67], v5 offset:2048
    v_mfma_f32_16x16x32_bf16 v[116:119], v[32:35], v[20:23], v[116:119]
    ds_read_b64_tr_b16 v[72:73], v8 offset:6144
    v_mfma_f32_16x16x32_bf16 v[120:123], v[32:35], v[24:27], v[120:123]
    ds_read_b64_tr_b16 v[74:75], v8 offset:6912
    s_waitcnt lgkmcnt(14)
    v_mfma_f32_16x16x32_bf16 v[124:127], v[36:39], v[12:15], v[124:127]
    ds_read_b64_tr_b16 v[76:77], v7 offset:6176
    v_mfma_f32_16x16x32_bf16 v[128:131], v[36:39], v[16:19], v[128:131]
    ds_read_b64_tr_b16 v[78:79], v7 offset:6944
    v_mfma_f32_16x16x32_bf16 v[132:135], v[36:39], v[20:23], v[132:135]
    ds_read_b64_tr_b16 v[80:81], v9 offset:6176
    v_mfma_f32_16x16x32_bf16 v[136:139], v[36:39], v[24:27], v[136:139]
    ds_read_b64_tr_b16 v[82:83], v9 offset:6944
    s_waitcnt lgkmcnt(15)
    v_mfma_f32_16x16x32_bf16 v[140:143], v[40:43], v[12:15], v[140:143]
    ds_read_b64_tr_b16 v[84:85], v6 offset:6208
    v_mfma_f32_16x16x32_bf16 v[144:147], v[40:43], v[16:19], v[144:147]
    ds_read_b64_tr_b16 v[86:87], v6 offset:6976
    v_mfma_f32_16x16x32_bf16 v[148:151], v[40:43], v[20:23], v[148:151]
    ds_read_b64_tr_b16 v[88:89], v8 offset:6208
    v_mfma_f32_16x16x32_bf16 v[152:155], v[40:43], v[24:27], v[152:155]
    ds_read_b64_tr_b16 v[90:91], v8 offset:6976
    s_waitcnt lgkmcnt(15)
    v_mfma_f32_16x16x32_bf16 v[156:159], v[44:47], v[12:15], v[156:159]
    v_mfma_f32_16x16x32_bf16 v[160:163], v[44:47], v[16:19], v[160:163]
    v_mfma_f32_16x16x32_bf16 v[164:167], v[44:47], v[20:23], v[164:167]
    v_mfma_f32_16x16x32_bf16 v[168:171], v[44:47], v[24:27], v[168:171]
    v_mfma_f32_16x16x32_bf16 v[172:175], v[48:51], v[12:15], v[172:175]
    v_mfma_f32_16x16x32_bf16 v[176:179], v[48:51], v[16:19], v[176:179]
    v_mfma_f32_16x16x32_bf16 v[180:183], v[48:51], v[20:23], v[180:183]
    v_mfma_f32_16x16x32_bf16 v[184:187], v[48:51], v[24:27], v[184:187]
    s_waitcnt lgkmcnt(13)
    v_mfma_f32_16x16x32_bf16 v[92:95], v[68:71], v[52:55], v[92:95]
    s_waitcnt lgkmcnt(0)
    s_barrier
    ds_read_b64_tr_b16 v[28:29], v6 offset:49152
    v_mfma_f32_16x16x32_bf16 v[96:99], v[68:71], v[56:59], v[96:99]
    ds_read_b64_tr_b16 v[30:31], v6 offset:49920
    v_mfma_f32_16x16x32_bf16 v[100:103], v[68:71], v[60:63], v[100:103]
    ds_read_b128 v[12:15], v2 offset:16384
    v_mfma_f32_16x16x32_bf16 v[104:107], v[68:71], v[64:67], v[104:107]
    ds_read_b128 v[16:19], v2 offset:18432
    v_mfma_f32_16x16x32_bf16 v[108:111], v[72:75], v[52:55], v[108:111]
    ds_read_b128 v[20:23], v3 offset:16384
    v_mfma_f32_16x16x32_bf16 v[112:115], v[72:75], v[56:59], v[112:115]
    ds_read_b128 v[24:27], v3 offset:18432
    v_mfma_f32_16x16x32_bf16 v[116:119], v[72:75], v[60:63], v[116:119]
    ds_read_b64_tr_b16 v[32:33], v8 offset:49152
    v_mfma_f32_16x16x32_bf16 v[120:123], v[72:75], v[64:67], v[120:123]
    ds_read_b64_tr_b16 v[34:35], v8 offset:49920
    v_mfma_f32_16x16x32_bf16 v[124:127], v[76:79], v[52:55], v[124:127]
    ds_read_b64_tr_b16 v[36:37], v7 offset:49184
    v_mfma_f32_16x16x32_bf16 v[128:131], v[76:79], v[56:59], v[128:131]
    ds_read_b64_tr_b16 v[38:39], v7 offset:49952
    v_mfma_f32_16x16x32_bf16 v[132:135], v[76:79], v[60:63], v[132:135]
    ds_read_b64_tr_b16 v[40:41], v9 offset:49184
    v_mfma_f32_16x16x32_bf16 v[136:139], v[76:79], v[64:67], v[136:139]
    ds_read_b64_tr_b16 v[42:43], v9 offset:49952
    v_mfma_f32_16x16x32_bf16 v[140:143], v[80:83], v[52:55], v[140:143]
    ds_read_b64_tr_b16 v[44:45], v6 offset:49216
    v_mfma_f32_16x16x32_bf16 v[144:147], v[80:83], v[56:59], v[144:147]
    ds_read_b64_tr_b16 v[46:47], v6 offset:49984
    v_mfma_f32_16x16x32_bf16 v[148:151], v[80:83], v[60:63], v[148:151]
    ds_read_b64_tr_b16 v[48:49], v8 offset:49216
    v_mfma_f32_16x16x32_bf16 v[152:155], v[80:83], v[64:67], v[152:155]
    ds_read_b64_tr_b16 v[50:51], v8 offset:49984
    v_mfma_f32_16x16x32_bf16 v[156:159], v[84:87], v[52:55], v[156:159]
    v_mfma_f32_16x16x32_bf16 v[160:163], v[84:87], v[56:59], v[160:163]
    v_mfma_f32_16x16x32_bf16 v[164:167], v[84:87], v[60:63], v[164:167]
    v_mfma_f32_16x16x32_bf16 v[168:171], v[84:87], v[64:67], v[168:171]
    v_mfma_f32_16x16x32_bf16 v[172:175], v[88:91], v[52:55], v[172:175]
    v_mfma_f32_16x16x32_bf16 v[176:179], v[88:91], v[56:59], v[176:179]
    v_mfma_f32_16x16x32_bf16 v[180:183], v[88:91], v[60:63], v[180:183]
    v_mfma_f32_16x16x32_bf16 v[184:187], v[88:91], v[64:67], v[184:187]
    s_waitcnt lgkmcnt(13)
    v_mfma_f32_16x16x32_bf16 v[92:95], v[28:31], v[12:15], v[92:95]
    ds_read_b64_tr_b16 v[68:69], v6 offset:55296
    s_waitcnt lgkmcnt(13)
    v_mfma_f32_16x16x32_bf16 v[96:99], v[28:31], v[16:19], v[96:99]
    ds_read_b64_tr_b16 v[70:71], v6 offset:56064
    s_waitcnt lgkmcnt(13)
    v_mfma_f32_16x16x32_bf16 v[100:103], v[28:31], v[20:23], v[100:103]
    ds_read_b128 v[52:55], v4 offset:16384
    s_waitcnt lgkmcnt(13)
    v_mfma_f32_16x16x32_bf16 v[104:107], v[28:31], v[24:27], v[104:107]
    ds_read_b128 v[56:59], v4 offset:18432
    s_waitcnt lgkmcnt(12)
    v_mfma_f32_16x16x32_bf16 v[108:111], v[32:35], v[12:15], v[108:111]
    ds_read_b128 v[60:63], v5 offset:16384
    v_mfma_f32_16x16x32_bf16 v[112:115], v[32:35], v[16:19], v[112:115]
    ds_read_b128 v[64:67], v5 offset:18432
    v_mfma_f32_16x16x32_bf16 v[116:119], v[32:35], v[20:23], v[116:119]
    ds_read_b64_tr_b16 v[72:73], v8 offset:55296
    v_mfma_f32_16x16x32_bf16 v[120:123], v[32:35], v[24:27], v[120:123]
    ds_read_b64_tr_b16 v[74:75], v8 offset:56064
    s_waitcnt lgkmcnt(14)
    v_mfma_f32_16x16x32_bf16 v[124:127], v[36:39], v[12:15], v[124:127]
    ds_read_b64_tr_b16 v[76:77], v7 offset:55328
    v_mfma_f32_16x16x32_bf16 v[128:131], v[36:39], v[16:19], v[128:131]
    ds_read_b64_tr_b16 v[78:79], v7 offset:56096
    v_mfma_f32_16x16x32_bf16 v[132:135], v[36:39], v[20:23], v[132:135]
    ds_read_b64_tr_b16 v[80:81], v9 offset:55328
    v_mfma_f32_16x16x32_bf16 v[136:139], v[36:39], v[24:27], v[136:139]
    ds_read_b64_tr_b16 v[82:83], v9 offset:56096
    s_waitcnt lgkmcnt(15)
    v_mfma_f32_16x16x32_bf16 v[140:143], v[40:43], v[12:15], v[140:143]
    ds_read_b64_tr_b16 v[84:85], v6 offset:55360
    v_mfma_f32_16x16x32_bf16 v[144:147], v[40:43], v[16:19], v[144:147]
    ds_read_b64_tr_b16 v[86:87], v6 offset:56128
    v_mfma_f32_16x16x32_bf16 v[148:151], v[40:43], v[20:23], v[148:151]
    ds_read_b64_tr_b16 v[88:89], v8 offset:55360
    v_mfma_f32_16x16x32_bf16 v[152:155], v[40:43], v[24:27], v[152:155]
    ds_read_b64_tr_b16 v[90:91], v8 offset:56128
    s_waitcnt lgkmcnt(15)
    v_mfma_f32_16x16x32_bf16 v[156:159], v[44:47], v[12:15], v[156:159]
    v_mfma_f32_16x16x32_bf16 v[160:163], v[44:47], v[16:19], v[160:163]
    v_mfma_f32_16x16x32_bf16 v[164:167], v[44:47], v[20:23], v[164:167]
    v_mfma_f32_16x16x32_bf16 v[168:171], v[44:47], v[24:27], v[168:171]
    v_mfma_f32_16x16x32_bf16 v[172:175], v[48:51], v[12:15], v[172:175]
    v_mfma_f32_16x16x32_bf16 v[176:179], v[48:51], v[16:19], v[176:179]
    v_mfma_f32_16x16x32_bf16 v[180:183], v[48:51], v[20:23], v[180:183]
    v_mfma_f32_16x16x32_bf16 v[184:187], v[48:51], v[24:27], v[184:187]
    v_and_b32 v2, 15, v1
    v_lshlrev_b32 v2, 4, v2
    s_lshl_b32 s40, s34, 10
    s_lshl_b32 s41, s35, 9
    s_add_u32 s42, s40, s41
    s_add_u32 s42, s42, 155648
    v_add_u32 v2, s42, v2
    v_xor_b32 v3, 512, v2
    v_lshrrev_b32 v4, 4, v1
    s_mul_i32 s40, s35, 192
    s_add_u32 s40, s40, 158720
    v_lshl_add_u32 v4, v4, 4, s40
    s_waitcnt lgkmcnt(13)
    v_mfma_f32_16x16x32_bf16 v[92:95], v[68:71], v[52:55], v[92:95]
    s_waitcnt lgkmcnt(0)
    s_barrier
    ds_read_b128 v[12:15], v2 offset:0
    v_mfma_f32_16x16x32_bf16 v[96:99], v[68:71], v[56:59], v[96:99]
    ds_read_b128 v[16:19], v2 offset:256
    v_mfma_f32_16x16x32_bf16 v[100:103], v[68:71], v[60:63], v[100:103]
    ds_read_b128 v[20:23], v3 offset:0
    v_mfma_f32_16x16x32_bf16 v[104:107], v[68:71], v[64:67], v[104:107]
    ds_read_b128 v[24:27], v3 offset:256
    v_mfma_f32_16x16x32_bf16 v[108:111], v[72:75], v[52:55], v[108:111]
    ds_read_b128 v[28:31], v4 offset:0
    v_mfma_f32_16x16x32_bf16 v[112:115], v[72:75], v[56:59], v[112:115]
    ds_read_b128 v[32:35], v4 offset:384
    v_mfma_f32_16x16x32_bf16 v[116:119], v[72:75], v[60:63], v[116:119]
    ds_read_b128 v[36:39], v4 offset:64
    v_mfma_f32_16x16x32_bf16 v[120:123], v[72:75], v[64:67], v[120:123]
    ds_read_b128 v[40:43], v4 offset:448
    v_mfma_f32_16x16x32_bf16 v[124:127], v[76:79], v[52:55], v[124:127]
    ds_read_b128 v[44:47], v4 offset:128
    v_mfma_f32_16x16x32_bf16 v[128:131], v[76:79], v[56:59], v[128:131]
    ds_read_b128 v[48:51], v4 offset:512
    v_mfma_f32_16x16x32_bf16 v[132:135], v[76:79], v[60:63], v[132:135]
    v_and_b32 v5, 512, v11
    v_add_u32 v5, v5, v11
    v_mfma_f32_16x16x32_bf16 v[136:139], v[76:79], v[64:67], v[136:139]
    s_lshl_b32 s40, s35, 11
    v_add_u32 v5, s40, v5
    v_mfma_f32_16x16x32_bf16 v[140:143], v[80:83], v[52:55], v[140:143]
    v_xor_b32 v6, 2048, v5
    v_mfma_f32_16x16x32_bf16 v[144:147], v[80:83], v[56:59], v[144:147]
    v_mfma_f32_16x16x32_bf16 v[148:151], v[80:83], v[60:63], v[148:151]
    v_mfma_f32_16x16x32_bf16 v[152:155], v[80:83], v[64:67], v[152:155]
    v_mfma_f32_16x16x32_bf16 v[156:159], v[84:87], v[52:55], v[156:159]
    v_mfma_f32_16x16x32_bf16 v[160:163], v[84:87], v[56:59], v[160:163]
    v_mfma_f32_16x16x32_bf16 v[164:167], v[84:87], v[60:63], v[164:167]
    v_mfma_f32_16x16x32_bf16 v[168:171], v[84:87], v[64:67], v[168:171]
    v_mfma_f32_16x16x32_bf16 v[172:175], v[88:91], v[52:55], v[172:175]
    v_mfma_f32_16x16x32_bf16 v[176:179], v[88:91], v[56:59], v[176:179]
    v_mfma_f32_16x16x32_bf16 v[180:183], v[88:91], v[60:63], v[180:183]
    v_mfma_f32_16x16x32_bf16 v[184:187], v[88:91], v[64:67], v[184:187]
    s_waitcnt lgkmcnt(0)
    s_nop 1
    v_pk_fma_f32 v[92:93], v[28:29], v[12:13], v[92:93] op_sel_hi:[1,0,1]
    v_pk_fma_f32 v[94:95], v[30:31], v[12:13], v[94:95] op_sel_hi:[1,0,1]
    v_pk_fma_f32 v[96:97], v[28:29], v[16:17], v[96:97] op_sel_hi:[1,0,1]
    v_pk_fma_f32 v[98:99], v[30:31], v[16:17], v[98:99] op_sel_hi:[1,0,1]
    v_pk_mul_f32 v[52:53], v[92:93], v[92:93]
    v_pk_mul_f32 v[54:55], v[94:95], v[94:95]
    v_pk_mul_f32 v[56:57], v[96:97], v[96:97]
    v_pk_mul_f32 v[58:59], v[98:99], v[98:99]
    v_pk_fma_f32 v[52:53], v[52:53], v[14:15], v[12:13] op_sel:[0,0,1] op_sel_hi:[1,0,1]
    v_pk_fma_f32 v[54:55], v[54:55], v[14:15], v[12:13] op_sel:[0,0,1] op_sel_hi:[1,0,1]
    v_pk_fma_f32 v[56:57], v[56:57], v[18:19], v[16:17] op_sel:[0,0,1] op_sel_hi:[1,0,1]
    v_pk_fma_f32 v[58:59], v[58:59], v[18:19], v[16:17] op_sel:[0,0,1] op_sel_hi:[1,0,1]
    v_pk_mul_f32 v[52:53], v[52:53], v[92:93]
    v_pk_mul_f32 v[54:55], v[54:55], v[94:95]
    v_pk_mul_f32 v[56:57], v[56:57], v[96:97]
    v_pk_mul_f32 v[58:59], v[58:59], v[98:99]
    v_exp_f32 v52, v52
    v_pk_fma_f32 v[108:109], v[32:33], v[12:13], v[108:109] op_sel_hi:[1,0,1]
    v_exp_f32 v53, v53
    v_pk_fma_f32 v[110:111], v[34:35], v[12:13], v[110:111] op_sel_hi:[1,0,1]
    v_exp_f32 v54, v54
    v_pk_fma_f32 v[112:113], v[32:33], v[16:17], v[112:113] op_sel_hi:[1,0,1]
    v_exp_f32 v55, v55
    v_pk_fma_f32 v[114:115], v[34:35], v[16:17], v[114:115] op_sel_hi:[1,0,1]
    v_exp_f32 v56, v56
    v_pk_mul_f32 v[92:93], v[92:93], v[108:109]
    v_exp_f32 v57, v57
    v_pk_mul_f32 v[94:95], v[94:95], v[110:111]
    v_exp_f32 v58, v58
    v_pk_mul_f32 v[96:97], v[96:97], v[112:113]
    v_exp_f32 v59, v59
    v_pk_mul_f32 v[98:99], v[98:99], v[114:115]
    v_pk_fma_f32 v[52:53], v[52:53], v[14:15], v[14:15] op_sel:[0,1,1] op_sel_hi:[1,1,1]
    v_pk_fma_f32 v[54:55], v[54:55], v[14:15], v[14:15] op_sel:[0,1,1] op_sel_hi:[1,1,1]
    v_pk_fma_f32 v[56:57], v[56:57], v[18:19], v[18:19] op_sel:[0,1,1] op_sel_hi:[1,1,1]
    v_pk_fma_f32 v[58:59], v[58:59], v[18:19], v[18:19] op_sel:[0,1,1] op_sel_hi:[1,1,1]
    v_rcp_f32 v52, v52
    v_pk_fma_f32 v[100:101], v[28:29], v[20:21], v[100:101] op_sel_hi:[1,0,1]
    v_pk_fma_f32 v[102:103], v[30:31], v[20:21], v[102:103] op_sel_hi:[1,0,1]
    v_rcp_f32 v53, v53
    v_pk_fma_f32 v[104:105], v[28:29], v[24:25], v[104:105] op_sel_hi:[1,0,1]
    v_pk_fma_f32 v[106:107], v[30:31], v[24:25], v[106:107] op_sel_hi:[1,0,1]
    v_rcp_f32 v54, v54
    v_pk_mul_f32 v[60:61], v[100:101], v[100:101]
    v_pk_mul_f32 v[62:63], v[102:103], v[102:103]
    v_rcp_f32 v55, v55
    v_pk_mul_f32 v[64:65], v[104:105], v[104:105]
    v_pk_mul_f32 v[66:67], v[106:107], v[106:107]
    v_rcp_f32 v56, v56
    v_pk_fma_f32 v[60:61], v[60:61], v[22:23], v[20:21] op_sel:[0,0,1] op_sel_hi:[1,0,1]
    v_pk_fma_f32 v[62:63], v[62:63], v[22:23], v[20:21] op_sel:[0,0,1] op_sel_hi:[1,0,1]
    v_rcp_f32 v57, v57
    v_pk_fma_f32 v[64:65], v[64:65], v[26:27], v[24:25] op_sel:[0,0,1] op_sel_hi:[1,0,1]
    v_pk_fma_f32 v[66:67], v[66:67], v[26:27], v[24:25] op_sel:[0,0,1] op_sel_hi:[1,0,1]
    v_rcp_f32 v58, v58
    v_pk_mul_f32 v[60:61], v[60:61], v[100:101]
    v_pk_mul_f32 v[62:63], v[62:63], v[102:103]
    v_rcp_f32 v59, v59
    v_pk_mul_f32 v[64:65], v[64:65], v[104:105]
    v_pk_mul_f32 v[66:67], v[66:67], v[106:107]
    v_pk_mul_f32 v[92:93], v[92:93], v[52:53]
    v_pk_mul_f32 v[94:95], v[94:95], v[54:55]
    v_pk_mul_f32 v[96:97], v[96:97], v[56:57]
    v_pk_mul_f32 v[98:99], v[98:99], v[58:59]
    v_exp_f32 v60, v60
    v_pk_fma_f32 v[116:117], v[32:33], v[20:21], v[116:117] op_sel_hi:[1,0,1]
    v_pk_fma_f32 v[118:119], v[34:35], v[20:21], v[118:119] op_sel_hi:[1,0,1]
    v_pk_fma_f32 v[120:121], v[32:33], v[24:25], v[120:121] op_sel_hi:[1,0,1]
    v_exp_f32 v61, v61
    v_pk_fma_f32 v[122:123], v[34:35], v[24:25], v[122:123] op_sel_hi:[1,0,1]
    v_pk_mul_f32 v[100:101], v[100:101], v[116:117]
    v_exp_f32 v62, v62
    v_pk_mul_f32 v[102:103], v[102:103], v[118:119]
    v_pk_mul_f32 v[104:105], v[104:105], v[120:121]
    v_exp_f32 v63, v63
    v_pk_mul_f32 v[106:107], v[106:107], v[122:123]
    v_cvt_pk_bf16_f32 v92, v92, v93
    v_exp_f32 v64, v64
    v_cvt_pk_bf16_f32 v93, v94, v95
    v_cvt_pk_bf16_f32 v94, v96, v97
    v_exp_f32 v65, v65
    v_cvt_pk_bf16_f32 v95, v98, v99
    s_nop 0
    v_exp_f32 v66, v66
    v_permlane16_swap_b32 v92, v94
    s_nop 0
    v_exp_f32 v67, v67
    v_permlane16_swap_b32 v93, v95
    buffer_store_dwordx4 v[92:95], v5, s[44:47], s56 offen sc1
    v_pk_fma_f32 v[60:61], v[60:61], v[22:23], v[22:23] op_sel:[0,1,1] op_sel_hi:[1,1,1]
    v_pk_fma_f32 v[62:63], v[62:63], v[22:23], v[22:23] op_sel:[0,1,1] op_sel_hi:[1,1,1]
    v_pk_fma_f32 v[64:65], v[64:65], v[26:27], v[26:27] op_sel:[0,1,1] op_sel_hi:[1,1,1]
    v_pk_fma_f32 v[66:67], v[66:67], v[26:27], v[26:27] op_sel:[0,1,1] op_sel_hi:[1,1,1]
    v_rcp_f32 v60, v60
    v_pk_fma_f32 v[124:125], v[36:37], v[12:13], v[124:125] op_sel_hi:[1,0,1]
    v_pk_fma_f32 v[126:127], v[38:39], v[12:13], v[126:127] op_sel_hi:[1,0,1]
    v_rcp_f32 v61, v61
    v_pk_fma_f32 v[128:129], v[36:37], v[16:17], v[128:129] op_sel_hi:[1,0,1]
    v_pk_fma_f32 v[130:131], v[38:39], v[16:17], v[130:131] op_sel_hi:[1,0,1]
    v_rcp_f32 v62, v62
    v_pk_mul_f32 v[52:53], v[124:125], v[124:125]
    v_pk_mul_f32 v[54:55], v[126:127], v[126:127]
    v_rcp_f32 v63, v63
    v_pk_mul_f32 v[56:57], v[128:129], v[128:129]
    v_pk_mul_f32 v[58:59], v[130:131], v[130:131]
    v_rcp_f32 v64, v64
    v_pk_fma_f32 v[52:53], v[52:53], v[14:15], v[12:13] op_sel:[0,0,1] op_sel_hi:[1,0,1]
    v_pk_fma_f32 v[54:55], v[54:55], v[14:15], v[12:13] op_sel:[0,0,1] op_sel_hi:[1,0,1]
    v_rcp_f32 v65, v65
    v_pk_fma_f32 v[56:57], v[56:57], v[18:19], v[16:17] op_sel:[0,0,1] op_sel_hi:[1,0,1]
    v_pk_fma_f32 v[58:59], v[58:59], v[18:19], v[16:17] op_sel:[0,0,1] op_sel_hi:[1,0,1]
    v_rcp_f32 v66, v66
    v_pk_mul_f32 v[52:53], v[52:53], v[124:125]
    v_pk_mul_f32 v[54:55], v[54:55], v[126:127]
    v_rcp_f32 v67, v67
    v_pk_mul_f32 v[56:57], v[56:57], v[128:129]
    v_pk_mul_f32 v[58:59], v[58:59], v[130:131]
    v_pk_mul_f32 v[100:101], v[100:101], v[60:61]
    v_pk_mul_f32 v[102:103], v[102:103], v[62:63]
    v_pk_mul_f32 v[104:105], v[104:105], v[64:65]
    v_pk_mul_f32 v[106:107], v[106:107], v[66:67]
    v_exp_f32 v52, v52
    v_pk_fma_f32 v[140:141], v[40:41], v[12:13], v[140:141] op_sel_hi:[1,0,1]
    v_pk_fma_f32 v[142:143], v[42:43], v[12:13], v[142:143] op_sel_hi:[1,0,1]
    v_pk_fma_f32 v[144:145], v[40:41], v[16:17], v[144:145] op_sel_hi:[1,0,1]
    v_exp_f32 v53, v53
    v_pk_fma_f32 v[146:147], v[42:43], v[16:17], v[146:147] op_sel_hi:[1,0,1]
    v_pk_mul_f32 v[124:125], v[124:125], v[140:141]
    v_exp_f32 v54, v54
    v_pk_mul_f32 v[126:127], v[126:127], v[142:143]
    v_pk_mul_f32 v[128:129], v[128:129], v[144:145]
    v_exp_f32 v55, v55
    v_pk_mul_f32 v[130:131], v[130:131], v[146:147]
    v_cvt_pk_bf16_f32 v100, v100, v101
    v_exp_f32 v56, v56
    v_cvt_pk_bf16_f32 v101, v102, v103
    v_cvt_pk_bf16_f32 v102, v104, v105
    v_exp_f32 v57, v57
    v_cvt_pk_bf16_f32 v103, v106, v107
    s_nop 0
    v_exp_f32 v58, v58
    v_permlane16_swap_b32 v100, v102
    s_nop 0
    v_exp_f32 v59, v59
    v_permlane16_swap_b32 v101, v103
    buffer_store_dwordx4 v[100:103], v6, s[44:47], s56 offen sc1
    v_pk_fma_f32 v[52:53], v[52:53], v[14:15], v[14:15] op_sel:[0,1,1] op_sel_hi:[1,1,1]
    v_pk_fma_f32 v[54:55], v[54:55], v[14:15], v[14:15] op_sel:[0,1,1] op_sel_hi:[1,1,1]
    v_pk_fma_f32 v[56:57], v[56:57], v[18:19], v[18:19] op_sel:[0,1,1] op_sel_hi:[1,1,1]
    v_pk_fma_f32 v[58:59], v[58:59], v[18:19], v[18:19] op_sel:[0,1,1] op_sel_hi:[1,1,1]
    v_rcp_f32 v52, v52
    v_pk_fma_f32 v[132:133], v[36:37], v[20:21], v[132:133] op_sel_hi:[1,0,1]
    v_pk_fma_f32 v[134:135], v[38:39], v[20:21], v[134:135] op_sel_hi:[1,0,1]
    v_rcp_f32 v53, v53
    v_pk_fma_f32 v[136:137], v[36:37], v[24:25], v[136:137] op_sel_hi:[1,0,1]
    v_pk_fma_f32 v[138:139], v[38:39], v[24:25], v[138:139] op_sel_hi:[1,0,1]
    v_rcp_f32 v54, v54
    v_pk_mul_f32 v[60:61], v[132:133], v[132:133]
    v_pk_mul_f32 v[62:63], v[134:135], v[134:135]
    v_rcp_f32 v55, v55
    v_pk_mul_f32 v[64:65], v[136:137], v[136:137]
    v_pk_mul_f32 v[66:67], v[138:139], v[138:139]
    v_rcp_f32 v56, v56
    v_pk_fma_f32 v[60:61], v[60:61], v[22:23], v[20:21] op_sel:[0,0,1] op_sel_hi:[1,0,1]
    v_pk_fma_f32 v[62:63], v[62:63], v[22:23], v[20:21] op_sel:[0,0,1] op_sel_hi:[1,0,1]
    v_rcp_f32 v57, v57
    v_pk_fma_f32 v[64:65], v[64:65], v[26:27], v[24:25] op_sel:[0,0,1] op_sel_hi:[1,0,1]
    v_pk_fma_f32 v[66:67], v[66:67], v[26:27], v[24:25] op_sel:[0,0,1] op_sel_hi:[1,0,1]
    v_rcp_f32 v58, v58
    v_pk_mul_f32 v[60:61], v[60:61], v[132:133]
    v_pk_mul_f32 v[62:63], v[62:63], v[134:135]
    v_rcp_f32 v59, v59
    v_pk_mul_f32 v[64:65], v[64:65], v[136:137]
    v_pk_mul_f32 v[66:67], v[66:67], v[138:139]
    v_pk_mul_f32 v[124:125], v[124:125], v[52:53]
    v_pk_mul_f32 v[126:127], v[126:127], v[54:55]
    v_pk_mul_f32 v[128:129], v[128:129], v[56:57]
    v_pk_mul_f32 v[130:131], v[130:131], v[58:59]
    v_exp_f32 v60, v60
    v_pk_fma_f32 v[148:149], v[40:41], v[20:21], v[148:149] op_sel_hi:[1,0,1]
    v_pk_fma_f32 v[150:151], v[42:43], v[20:21], v[150:151] op_sel_hi:[1,0,1]
    v_pk_fma_f32 v[152:153], v[40:41], v[24:25], v[152:153] op_sel_hi:[1,0,1]
    v_exp_f32 v61, v61
    v_pk_fma_f32 v[154:155], v[42:43], v[24:25], v[154:155] op_sel_hi:[1,0,1]
    v_pk_mul_f32 v[132:133], v[132:133], v[148:149]
    v_exp_f32 v62, v62
    v_pk_mul_f32 v[134:135], v[134:135], v[150:151]
    v_pk_mul_f32 v[136:137], v[136:137], v[152:153]
    v_exp_f32 v63, v63
    v_pk_mul_f32 v[138:139], v[138:139], v[154:155]
    v_cvt_pk_bf16_f32 v124, v124, v125
    v_exp_f32 v64, v64
    v_cvt_pk_bf16_f32 v125, v126, v127
    v_cvt_pk_bf16_f32 v126, v128, v129
    v_exp_f32 v65, v65
    v_cvt_pk_bf16_f32 v127, v130, v131
    s_nop 0
    v_exp_f32 v66, v66
    v_permlane16_swap_b32 v124, v126
    s_nop 0
    v_exp_f32 v67, v67
    v_permlane16_swap_b32 v125, v127
    buffer_store_dwordx4 v[124:127], v5, s[44:47], s57 offen sc1
    v_pk_fma_f32 v[60:61], v[60:61], v[22:23], v[22:23] op_sel:[0,1,1] op_sel_hi:[1,1,1]
    v_pk_fma_f32 v[62:63], v[62:63], v[22:23], v[22:23] op_sel:[0,1,1] op_sel_hi:[1,1,1]
    v_pk_fma_f32 v[64:65], v[64:65], v[26:27], v[26:27] op_sel:[0,1,1] op_sel_hi:[1,1,1]
    v_pk_fma_f32 v[66:67], v[66:67], v[26:27], v[26:27] op_sel:[0,1,1] op_sel_hi:[1,1,1]
    v_rcp_f32 v60, v60
    v_pk_fma_f32 v[156:157], v[44:45], v[12:13], v[156:157] op_sel_hi:[1,0,1]
    v_pk_fma_f32 v[158:159], v[46:47], v[12:13], v[158:159] op_sel_hi:[1,0,1]
    v_rcp_f32 v61, v61
    v_pk_fma_f32 v[160:161], v[44:45], v[16:17], v[160:161] op_sel_hi:[1,0,1]
    v_pk_fma_f32 v[162:163], v[46:47], v[16:17], v[162:163] op_sel_hi:[1,0,1]
    v_rcp_f32 v62, v62
    v_pk_mul_f32 v[52:53], v[156:157], v[156:157]
    v_pk_mul_f32 v[54:55], v[158:159], v[158:159]
    v_rcp_f32 v63, v63
    v_pk_mul_f32 v[56:57], v[160:161], v[160:161]
    v_pk_mul_f32 v[58:59], v[162:163], v[162:163]
    v_rcp_f32 v64, v64
    v_pk_fma_f32 v[52:53], v[52:53], v[14:15], v[12:13] op_sel:[0,0,1] op_sel_hi:[1,0,1]
    v_pk_fma_f32 v[54:55], v[54:55], v[14:15], v[12:13] op_sel:[0,0,1] op_sel_hi:[1,0,1]
    v_rcp_f32 v65, v65
    v_pk_fma_f32 v[56:57], v[56:57], v[18:19], v[16:17] op_sel:[0,0,1] op_sel_hi:[1,0,1]
    v_pk_fma_f32 v[58:59], v[58:59], v[18:19], v[16:17] op_sel:[0,0,1] op_sel_hi:[1,0,1]
    v_rcp_f32 v66, v66
    v_pk_mul_f32 v[52:53], v[52:53], v[156:157]
    v_pk_mul_f32 v[54:55], v[54:55], v[158:159]
    v_rcp_f32 v67, v67
    v_pk_mul_f32 v[56:57], v[56:57], v[160:161]
    v_pk_mul_f32 v[58:59], v[58:59], v[162:163]
    v_pk_mul_f32 v[132:133], v[132:133], v[60:61]
    v_pk_mul_f32 v[134:135], v[134:135], v[62:63]
    v_pk_mul_f32 v[136:137], v[136:137], v[64:65]
    v_pk_mul_f32 v[138:139], v[138:139], v[66:67]
    v_exp_f32 v52, v52
    v_pk_fma_f32 v[172:173], v[48:49], v[12:13], v[172:173] op_sel_hi:[1,0,1]
    v_pk_fma_f32 v[174:175], v[50:51], v[12:13], v[174:175] op_sel_hi:[1,0,1]
    v_pk_fma_f32 v[176:177], v[48:49], v[16:17], v[176:177] op_sel_hi:[1,0,1]
    v_exp_f32 v53, v53
    v_pk_fma_f32 v[178:179], v[50:51], v[16:17], v[178:179] op_sel_hi:[1,0,1]
    v_pk_mul_f32 v[156:157], v[156:157], v[172:173]
    v_exp_f32 v54, v54
    v_pk_mul_f32 v[158:159], v[158:159], v[174:175]
    v_pk_mul_f32 v[160:161], v[160:161], v[176:177]
    v_exp_f32 v55, v55
    v_pk_mul_f32 v[162:163], v[162:163], v[178:179]
    v_cvt_pk_bf16_f32 v132, v132, v133
    v_exp_f32 v56, v56
    v_cvt_pk_bf16_f32 v133, v134, v135
    v_cvt_pk_bf16_f32 v134, v136, v137
    v_exp_f32 v57, v57
    v_cvt_pk_bf16_f32 v135, v138, v139
    s_nop 0
    v_exp_f32 v58, v58
    v_permlane16_swap_b32 v132, v134
    s_nop 0
    v_exp_f32 v59, v59
    v_permlane16_swap_b32 v133, v135
    buffer_store_dwordx4 v[132:135], v6, s[44:47], s57 offen sc1
    v_pk_fma_f32 v[52:53], v[52:53], v[14:15], v[14:15] op_sel:[0,1,1] op_sel_hi:[1,1,1]
    v_pk_fma_f32 v[54:55], v[54:55], v[14:15], v[14:15] op_sel:[0,1,1] op_sel_hi:[1,1,1]
    v_pk_fma_f32 v[56:57], v[56:57], v[18:19], v[18:19] op_sel:[0,1,1] op_sel_hi:[1,1,1]
    v_pk_fma_f32 v[58:59], v[58:59], v[18:19], v[18:19] op_sel:[0,1,1] op_sel_hi:[1,1,1]
    v_rcp_f32 v52, v52
    v_pk_fma_f32 v[164:165], v[44:45], v[20:21], v[164:165] op_sel_hi:[1,0,1]
    v_pk_fma_f32 v[166:167], v[46:47], v[20:21], v[166:167] op_sel_hi:[1,0,1]
    v_rcp_f32 v53, v53
    v_pk_fma_f32 v[168:169], v[44:45], v[24:25], v[168:169] op_sel_hi:[1,0,1]
    v_pk_fma_f32 v[170:171], v[46:47], v[24:25], v[170:171] op_sel_hi:[1,0,1]
    v_rcp_f32 v54, v54
    v_pk_mul_f32 v[60:61], v[164:165], v[164:165]
    v_pk_mul_f32 v[62:63], v[166:167], v[166:167]
    v_rcp_f32 v55, v55
    v_pk_mul_f32 v[64:65], v[168:169], v[168:169]
    v_pk_mul_f32 v[66:67], v[170:171], v[170:171]
    v_rcp_f32 v56, v56
    v_pk_fma_f32 v[60:61], v[60:61], v[22:23], v[20:21] op_sel:[0,0,1] op_sel_hi:[1,0,1]
    v_pk_fma_f32 v[62:63], v[62:63], v[22:23], v[20:21] op_sel:[0,0,1] op_sel_hi:[1,0,1]
    v_rcp_f32 v57, v57
    v_pk_fma_f32 v[64:65], v[64:65], v[26:27], v[24:25] op_sel:[0,0,1] op_sel_hi:[1,0,1]
    v_pk_fma_f32 v[66:67], v[66:67], v[26:27], v[24:25] op_sel:[0,0,1] op_sel_hi:[1,0,1]
    v_rcp_f32 v58, v58
    v_pk_mul_f32 v[60:61], v[60:61], v[164:165]
    v_pk_mul_f32 v[62:63], v[62:63], v[166:167]
    v_rcp_f32 v59, v59
    v_pk_mul_f32 v[64:65], v[64:65], v[168:169]
    v_pk_mul_f32 v[66:67], v[66:67], v[170:171]
    v_pk_mul_f32 v[156:157], v[156:157], v[52:53]
    v_pk_mul_f32 v[158:159], v[158:159], v[54:55]
    v_pk_mul_f32 v[160:161], v[160:161], v[56:57]
    v_pk_mul_f32 v[162:163], v[162:163], v[58:59]
    v_exp_f32 v60, v60
    v_pk_fma_f32 v[180:181], v[48:49], v[20:21], v[180:181] op_sel_hi:[1,0,1]
    v_pk_fma_f32 v[182:183], v[50:51], v[20:21], v[182:183] op_sel_hi:[1,0,1]
    v_pk_fma_f32 v[184:185], v[48:49], v[24:25], v[184:185] op_sel_hi:[1,0,1]
    v_exp_f32 v61, v61
    v_pk_fma_f32 v[186:187], v[50:51], v[24:25], v[186:187] op_sel_hi:[1,0,1]
    v_pk_mul_f32 v[164:165], v[164:165], v[180:181]
    v_exp_f32 v62, v62
    v_pk_mul_f32 v[166:167], v[166:167], v[182:183]
    v_pk_mul_f32 v[168:169], v[168:169], v[184:185]
    v_exp_f32 v63, v63
    v_pk_mul_f32 v[170:171], v[170:171], v[186:187]
    v_cvt_pk_bf16_f32 v156, v156, v157
    v_exp_f32 v64, v64
    v_cvt_pk_bf16_f32 v157, v158, v159
    v_cvt_pk_bf16_f32 v158, v160, v161
    v_exp_f32 v65, v65
    v_cvt_pk_bf16_f32 v159, v162, v163
    s_nop 0
    v_exp_f32 v66, v66
    v_permlane16_swap_b32 v156, v158
    s_nop 0
    v_exp_f32 v67, v67
    v_permlane16_swap_b32 v157, v159
    buffer_store_dwordx4 v[156:159], v5, s[44:47], s58 offen sc1
    v_pk_fma_f32 v[60:61], v[60:61], v[22:23], v[22:23] op_sel:[0,1,1] op_sel_hi:[1,1,1]
    v_pk_fma_f32 v[62:63], v[62:63], v[22:23], v[22:23] op_sel:[0,1,1] op_sel_hi:[1,1,1]
    v_pk_fma_f32 v[64:65], v[64:65], v[26:27], v[26:27] op_sel:[0,1,1] op_sel_hi:[1,1,1]
    v_pk_fma_f32 v[66:67], v[66:67], v[26:27], v[26:27] op_sel:[0,1,1] op_sel_hi:[1,1,1]
    v_rcp_f32 v60, v60
    s_nop 0
    v_rcp_f32 v61, v61
    v_rcp_f32 v62, v62
    v_rcp_f32 v63, v63
    v_rcp_f32 v64, v64
    v_rcp_f32 v65, v65
    v_rcp_f32 v66, v66
    v_rcp_f32 v67, v67
    v_pk_mul_f32 v[164:165], v[164:165], v[60:61]
    v_pk_mul_f32 v[166:167], v[166:167], v[62:63]
    v_pk_mul_f32 v[168:169], v[168:169], v[64:65]
    v_pk_mul_f32 v[170:171], v[170:171], v[66:67]
    v_cvt_pk_bf16_f32 v164, v164, v165
    v_cvt_pk_bf16_f32 v165, v166, v167
    v_cvt_pk_bf16_f32 v166, v168, v169
    v_cvt_pk_bf16_f32 v167, v170, v171
    s_nop 0
    v_permlane16_swap_b32 v164, v166
    s_nop 0
    v_permlane16_swap_b32 v165, v167
    buffer_store_dwordx4 v[164:167], v6, s[44:47], s58 offen sc1
    v_lshrrev_b32 v14, 4, v1
    v_and_b32 v12, 15, v1
    v_lshlrev_b32 v12, 7, v12
    v_and_b32 v13, 7, v1
    v_xor_b32 v13, v13, v14
    v_lshl_add_u32 v12, v13, 4, v12
    s_lshl_b32 s40, s34, 13
    v_add_u32 v3, s40, v12
    v_xor_b32 v4, 64, v3
    s_mul_i32 s40, s35, 5120
    s_add_u32 s40, s40, 81920
    v_lshl_add_u32 v2, v1, 4, s40
    s_lshl_b32 s40, s34, 12
    v_lshl_add_u32 v7, v1, 4, s40
    v_bfe_u32 v15, v1, 2, 2
    v_lshl_add_u32 v15, v14, 3, v15
    v_mul_u32_u24 v15, 320, v15
    v_and_b32 v16, 3, v1
    v_lshl_add_u32 v15, v16, 3, v15
    v_and_b32 v16, 1, v14
    s_mul_i32 s40, s35, 5
    v_xor_b32 v17, s40, v16
    v_lshl_add_u32 v5, v17, 5, v15
    v_add_u32 v5, 81920, v5
    s_add_u32 s40, s40, 1
    v_xor_b32 v17, s40, v16
    v_lshl_add_u32 v6, v17, 5, v15
    v_add_u32 v6, 81888, v6
    s_add_u32 s40, s40, 1
    v_lshlrev_b32 v9, 4, v1
    v_lshlrev_b32 v10, 2, v1
    s_mov_b32 s36, 0
    s_mov_b32 s37, 0
    s_mov_b32 s40, 20480
    s_mov_b32 s41, 16384
    s_add_u32 s36, s36, 1
    s_cmp_eq_u32 s36, 4
    s_cselect_b32 s38, 4294905856, s40
    s_cselect_b32 s36, 0, s36
    s_add_u32 s37, s37, 1
    s_cmp_eq_u32 s37, 5
    s_cselect_b32 s39, 4294901760, s41
    s_cselect_b32 s37, 0, s37
    s_mov_b32 s42, 20
    s_cmp_eq_u32 s31, 2
    s_cselect_b32 s42, 6, s42
    s_cmp_eq_u32 s31, 3
    s_cselect_b32 s42, 6, s42
    s_and_b32 s43, s31, 1
    s_lshl_b32 s43, s43, 12
    s_mul_i32 s56, s28, 5120
    s_mov_b32 s57, 143360
    s_cmp_eq_u32 s31, 2
    s_cselect_b32 s57, 102400, s57
    s_cmp_eq_u32 s31, 3
    s_cselect_b32 s57, 102400, s57
    s_add_u32 s57, s57, s56
    v_add_u32 v11, s57, v9
    s_mov_b32 s57, 81920
    s_cmp_eq_u32 s31, 2
    s_cselect_b32 s57, 122880, s57
    s_cmp_eq_u32 s31, 3
    s_cselect_b32 s57, 122880, s57
    s_add_u32 s57, s57, s56
    v_add_u32 v8, s57, v9
    s_mov_b32 s57, 102400
    s_cmp_eq_u32 s31, 2
    s_cselect_b32 s57, 143360, s57
    s_cmp_eq_u32 s31, 3
    s_cselect_b32 s57, 143360, s57
    s_lshl_b32 s56, s28, 8
    s_add_u32 s57, s57, s56
    v_add_u32 v251, s57, v10
    v_and_b32 v249, 0xffff0000, v248
    v_lshlrev_b32 v250, 16, v248
    s_barrier
    ds_read_b128 v[12:15], v2 offset:0
    ds_read_b128 v[32:35], v3 offset:0
    ds_read_b128 v[36:39], v3 offset:2048
    ds_read_b128 v[40:43], v3 offset:4096
    ds_read_b128 v[44:47], v3 offset:6144
    ds_read_b128 v[16:19], v2 offset:1024
    ds_read_b128 v[20:23], v2 offset:2048
    ds_read_b128 v[24:27], v2 offset:3072
    ds_read_b128 v[28:31], v2 offset:4096
    s_waitcnt lgkmcnt(7)
    v_mfma_f32_16x16x32_bf16 v[84:87], v[12:15], v[32:35], 0
    ds_read_b128 v[48:51], v2 offset:10240
    s_waitcnt lgkmcnt(7)
    v_mfma_f32_16x16x32_bf16 v[104:107], v[12:15], v[36:39], 0
    ds_read_b128 v[68:71], v4 offset:0
    s_waitcnt lgkmcnt(7)
    v_mfma_f32_16x16x32_bf16 v[124:127], v[12:15], v[40:43], 0
    ds_read_b128 v[72:75], v4 offset:2048
    s_waitcnt lgkmcnt(7)
    v_mfma_f32_16x16x32_bf16 v[144:147], v[12:15], v[44:47], 0
    ds_read_b128 v[76:79], v4 offset:4096
    s_waitcnt lgkmcnt(7)
    v_mfma_f32_16x16x32_bf16 v[88:91], v[16:19], v[32:35], 0
    ds_read_b128 v[80:83], v4 offset:6144
    v_mfma_f32_16x16x32_bf16 v[108:111], v[16:19], v[36:39], 0
    ds_read_b128 v[52:55], v2 offset:11264
    v_mfma_f32_16x16x32_bf16 v[128:131], v[16:19], v[40:43], 0
    ds_read_b128 v[56:59], v2 offset:12288
    v_mfma_f32_16x16x32_bf16 v[148:151], v[16:19], v[44:47], 0
    ds_read_b128 v[60:63], v2 offset:13312
    s_waitcnt lgkmcnt(10)
    v_mfma_f32_16x16x32_bf16 v[92:95], v[20:23], v[32:35], 0
    ds_read_b128 v[64:67], v2 offset:14336
    v_add_u32 v2, s38, v2
    v_mfma_f32_16x16x32_bf16 v[112:115], v[20:23], v[36:39], 0
    v_add_u32 v5, s38, v5
    v_add_u32 v6, s38, v6
    v_mfma_f32_16x16x32_bf16 v[132:135], v[20:23], v[40:43], 0
    v_add_u32 v3, s39, v3
    v_add_u32 v4, s39, v4
    v_mfma_f32_16x16x32_bf16 v[152:155], v[20:23], v[44:47], 0
    v_add_u32 v7, s39, v7
    s_waitcnt vmcnt(0)
    s_waitcnt lgkmcnt(10)
    v_mfma_f32_16x16x32_bf16 v[96:99], v[24:27], v[32:35], 0
    v_mfma_f32_16x16x32_bf16 v[116:119], v[24:27], v[36:39], 0
    v_mfma_f32_16x16x32_bf16 v[136:139], v[24:27], v[40:43], 0
    v_mfma_f32_16x16x32_bf16 v[156:159], v[24:27], v[44:47], 0
    s_waitcnt lgkmcnt(9)
    v_mfma_f32_16x16x32_bf16 v[100:103], v[28:31], v[32:35], 0
    v_mfma_f32_16x16x32_bf16 v[120:123], v[28:31], v[36:39], 0
    v_mfma_f32_16x16x32_bf16 v[140:143], v[28:31], v[40:43], 0
    v_mfma_f32_16x16x32_bf16 v[160:163], v[28:31], v[44:47], 0
    s_waitcnt lgkmcnt(7)
    v_mfma_f32_16x16x32_bf16 v[84:87], v[48:51], v[68:71], v[84:87]
    s_waitcnt lgkmcnt(0)
    s_barrier
    ds_read_b128 v[12:15], v2 offset:0
    s_cmp_lg_u32 s28, 0
    s_cbranch_scc1 .f_fls62
    buffer_store_dword v248, off, s[52:55], s62 sc1
.f_fls62:
    v_mfma_f32_16x16x32_bf16 v[104:107], v[48:51], v[72:75], v[104:107]
    ds_read_b128 v[32:35], v3 offset:0
    v_mfma_f32_16x16x32_bf16 v[124:127], v[48:51], v[76:79], v[124:127]
    ds_read_b128 v[36:39], v3 offset:2048
    v_mfma_f32_16x16x32_bf16 v[144:147], v[48:51], v[80:83], v[144:147]
    ds_read_b128 v[40:43], v3 offset:4096
    v_mfma_f32_16x16x32_bf16 v[88:91], v[52:55], v[68:71], v[88:91]
    ds_read_b128 v[44:47], v3 offset:6144
    v_mfma_f32_16x16x32_bf16 v[108:111], v[52:55], v[72:75], v[108:111]
    ds_read_b128 v[16:19], v2 offset:1024
    v_mfma_f32_16x16x32_bf16 v[128:131], v[52:55], v[76:79], v[128:131]
    ds_read_b128 v[20:23], v2 offset:2048
    v_mfma_f32_16x16x32_bf16 v[148:151], v[52:55], v[80:83], v[148:151]
    ds_read_b128 v[24:27], v2 offset:3072
    v_mfma_f32_16x16x32_bf16 v[92:95], v[56:59], v[68:71], v[92:95]
    ds_read_b128 v[28:31], v2 offset:4096
    s_add_u32 s36, s36, 1
    v_mfma_f32_16x16x32_bf16 v[112:115], v[56:59], v[72:75], v[112:115]
    s_cmp_eq_u32 s36, 4
    s_cselect_b32 s38, 4294905856, s40
    v_mfma_f32_16x16x32_bf16 v[132:135], v[56:59], v[76:79], v[132:135]
    s_cselect_b32 s36, 0, s36
    s_add_u32 s37, s37, 1
    v_mfma_f32_16x16x32_bf16 v[152:155], v[56:59], v[80:83], v[152:155]
    s_cmp_eq_u32 s37, 5
    s_cselect_b32 s39, 4294901760, s41
    v_mfma_f32_16x16x32_bf16 v[96:99], v[60:63], v[68:71], v[96:99]
    s_cselect_b32 s37, 0, s37
    v_mfma_f32_16x16x32_bf16 v[116:119], v[60:63], v[72:75], v[116:119]
    v_mfma_f32_16x16x32_bf16 v[136:139], v[60:63], v[76:79], v[136:139]
    v_mfma_f32_16x16x32_bf16 v[156:159], v[60:63], v[80:83], v[156:159]
    v_mfma_f32_16x16x32_bf16 v[100:103], v[64:67], v[68:71], v[100:103]
    v_mfma_f32_16x16x32_bf16 v[120:123], v[64:67], v[72:75], v[120:123]
    v_mfma_f32_16x16x32_bf16 v[140:143], v[64:67], v[76:79], v[140:143]
    v_mfma_f32_16x16x32_bf16 v[160:163], v[64:67], v[80:83], v[160:163]
    s_waitcnt lgkmcnt(7)
    v_mfma_f32_16x16x32_bf16 v[84:87], v[12:15], v[32:35], v[84:87]
    ds_read_b128 v[48:51], v2 offset:10240
    s_waitcnt lgkmcnt(7)
    v_mfma_f32_16x16x32_bf16 v[104:107], v[12:15], v[36:39], v[104:107]
    ds_read_b128 v[68:71], v4 offset:0
    s_waitcnt lgkmcnt(7)
    v_mfma_f32_16x16x32_bf16 v[124:127], v[12:15], v[40:43], v[124:127]
    ds_read_b128 v[72:75], v4 offset:2048
    s_waitcnt lgkmcnt(7)
    v_mfma_f32_16x16x32_bf16 v[144:147], v[12:15], v[44:47], v[144:147]
    ds_read_b128 v[76:79], v4 offset:4096
    s_waitcnt lgkmcnt(7)
    v_mfma_f32_16x16x32_bf16 v[88:91], v[16:19], v[32:35], v[88:91]
    ds_read_b128 v[80:83], v4 offset:6144
    v_mfma_f32_16x16x32_bf16 v[108:111], v[16:19], v[36:39], v[108:111]
    ds_read_b128 v[52:55], v2 offset:11264
    v_mfma_f32_16x16x32_bf16 v[128:131], v[16:19], v[40:43], v[128:131]
    ds_read_b128 v[56:59], v2 offset:12288
    v_mfma_f32_16x16x32_bf16 v[148:151], v[16:19], v[44:47], v[148:151]
    ds_read_b128 v[60:63], v2 offset:13312
    s_waitcnt lgkmcnt(10)
    v_mfma_f32_16x16x32_bf16 v[92:95], v[20:23], v[32:35], v[92:95]
    ds_read_b128 v[64:67], v2 offset:14336
    v_mfma_f32_16x16x32_bf16 v[112:115], v[20:23], v[36:39], v[112:115]
    v_add_u32 v2, s38, v2
    v_add_u32 v5, s38, v5
    v_mfma_f32_16x16x32_bf16 v[132:135], v[20:23], v[40:43], v[132:135]
    v_add_u32 v6, s38, v6
    v_add_u32 v3, s39, v3
    v_mfma_f32_16x16x32_bf16 v[152:155], v[20:23], v[44:47], v[152:155]
    v_add_u32 v4, s39, v4
    v_add_u32 v7, s39, v7
    s_waitcnt lgkmcnt(10)
    v_mfma_f32_16x16x32_bf16 v[96:99], v[24:27], v[32:35], v[96:99]
    v_mfma_f32_16x16x32_bf16 v[116:119], v[24:27], v[36:39], v[116:119]
    v_mfma_f32_16x16x32_bf16 v[136:139], v[24:27], v[40:43], v[136:139]
    v_mfma_f32_16x16x32_bf16 v[156:159], v[24:27], v[44:47], v[156:159]
    s_waitcnt lgkmcnt(9)
    v_mfma_f32_16x16x32_bf16 v[100:103], v[28:31], v[32:35], v[100:103]
    v_mfma_f32_16x16x32_bf16 v[120:123], v[28:31], v[36:39], v[120:123]
    v_mfma_f32_16x16x32_bf16 v[140:143], v[28:31], v[40:43], v[140:143]
    v_mfma_f32_16x16x32_bf16 v[160:163], v[28:31], v[44:47], v[160:163]
    s_waitcnt lgkmcnt(7)
    v_mfma_f32_16x16x32_bf16 v[84:87], v[48:51], v[68:71], v[84:87]
    s_waitcnt lgkmcnt(0)
    s_barrier
    ds_read_b128 v[12:15], v2 offset:0
    v_mfma_f32_16x16x32_bf16 v[104:107], v[48:51], v[72:75], v[104:107]
    ds_read_b128 v[32:35], v3 offset:0
    v_mfma_f32_16x16x32_bf16 v[124:127], v[48:51], v[76:79], v[124:127]
    ds_read_b128 v[36:39], v3 offset:2048
    v_mfma_f32_16x16x32_bf16 v[144:147], v[48:51], v[80:83], v[144:147]
    ds_read_b128 v[40:43], v3 offset:4096
    v_mfma_f32_16x16x32_bf16 v[88:91], v[52:55], v[68:71], v[88:91]
    ds_read_b128 v[44:47], v3 offset:6144
    v_mfma_f32_16x16x32_bf16 v[108:111], v[52:55], v[72:75], v[108:111]
    ds_read_b128 v[16:19], v2 offset:1024
    v_mfma_f32_16x16x32_bf16 v[128:131], v[52:55], v[76:79], v[128:131]
    ds_read_b128 v[20:23], v2 offset:2048
    v_mfma_f32_16x16x32_bf16 v[148:151], v[52:55], v[80:83], v[148:151]
    ds_read_b128 v[24:27], v2 offset:3072
    v_mfma_f32_16x16x32_bf16 v[92:95], v[56:59], v[68:71], v[92:95]
    ds_read_b128 v[28:31], v2 offset:4096
    v_mfma_f32_16x16x32_bf16 v[112:115], v[56:59], v[72:75], v[112:115]
    s_add_u32 s36, s36, 1
    s_cmp_eq_u32 s36, 4
    v_mfma_f32_16x16x32_bf16 v[132:135], v[56:59], v[76:79], v[132:135]
    s_cselect_b32 s38, 4294905856, s40
    s_cselect_b32 s36, 0, s36
    v_mfma_f32_16x16x32_bf16 v[152:155], v[56:59], v[80:83], v[152:155]
    s_add_u32 s37, s37, 1
    s_cmp_eq_u32 s37, 5
    v_mfma_f32_16x16x32_bf16 v[96:99], v[60:63], v[68:71], v[96:99]
    s_cselect_b32 s39, 4294901760, s41
    s_cselect_b32 s37, 0, s37
    v_mfma_f32_16x16x32_bf16 v[116:119], v[60:63], v[72:75], v[116:119]
    v_mfma_f32_16x16x32_bf16 v[136:139], v[60:63], v[76:79], v[136:139]
    v_mfma_f32_16x16x32_bf16 v[156:159], v[60:63], v[80:83], v[156:159]
    v_mfma_f32_16x16x32_bf16 v[100:103], v[64:67], v[68:71], v[100:103]
    v_mfma_f32_16x16x32_bf16 v[120:123], v[64:67], v[72:75], v[120:123]
    v_mfma_f32_16x16x32_bf16 v[140:143], v[64:67], v[76:79], v[140:143]
    v_mfma_f32_16x16x32_bf16 v[160:163], v[64:67], v[80:83], v[160:163]
.f_yloop:
    s_waitcnt lgkmcnt(7)
    v_mfma_f32_16x16x32_bf16 v[84:87], v[12:15], v[32:35], v[84:87]
    ds_read_b128 v[48:51], v2 offset:10240
    s_waitcnt lgkmcnt(7)
    v_mfma_f32_16x16x32_bf16 v[104:107], v[12:15], v[36:39], v[104:107]
    ds_read_b128 v[68:71], v4 offset:0
    s_waitcnt lgkmcnt(7)
    v_mfma_f32_16x16x32_bf16 v[124:127], v[12:15], v[40:43], v[124:127]
    ds_read_b128 v[72:75], v4 offset:2048
    s_waitcnt lgkmcnt(7)
    v_mfma_f32_16x16x32_bf16 v[144:147], v[12:15], v[44:47], v[144:147]
    ds_read_b128 v[76:79], v4 offset:4096
    s_waitcnt lgkmcnt(7)
    v_mfma_f32_16x16x32_bf16 v[88:91], v[16:19], v[32:35], v[88:91]
    ds_read_b128 v[80:83], v4 offset:6144
    v_mfma_f32_16x16x32_bf16 v[108:111], v[16:19], v[36:39], v[108:111]
    ds_read_b128 v[52:55], v2 offset:11264
    v_mfma_f32_16x16x32_bf16 v[128:131], v[16:19], v[40:43], v[128:131]
    ds_read_b128 v[56:59], v2 offset:12288
    v_mfma_f32_16x16x32_bf16 v[148:151], v[16:19], v[44:47], v[148:151]
    ds_read_b128 v[60:63], v2 offset:13312
    s_waitcnt lgkmcnt(10)
    v_mfma_f32_16x16x32_bf16 v[92:95], v[20:23], v[32:35], v[92:95]
    ds_read_b128 v[64:67], v2 offset:14336
    v_mfma_f32_16x16x32_bf16 v[112:115], v[20:23], v[36:39], v[112:115]
    v_add_u32 v2, s38, v2
    v_add_u32 v5, s38, v5
    v_mfma_f32_16x16x32_bf16 v[132:135], v[20:23], v[40:43], v[132:135]
    v_add_u32 v6, s38, v6
    v_add_u32 v3, s39, v3
    v_mfma_f32_16x16x32_bf16 v[152:155], v[20:23], v[44:47], v[152:155]
    v_add_u32 v4, s39, v4
    v_add_u32 v7, s39, v7
    s_waitcnt lgkmcnt(10)
    v_mfma_f32_16x16x32_bf16 v[96:99], v[24:27], v[32:35], v[96:99]
    v_mfma_f32_16x16x32_bf16 v[116:119], v[24:27], v[36:39], v[116:119]
    v_mfma_f32_16x16x32_bf16 v[136:139], v[24:27], v[40:43], v[136:139]
    v_mfma_f32_16x16x32_bf16 v[156:159], v[24:27], v[44:47], v[156:159]
    s_waitcnt lgkmcnt(9)
    v_mfma_f32_16x16x32_bf16 v[100:103], v[28:31], v[32:35], v[100:103]
    v_mfma_f32_16x16x32_bf16 v[120:123], v[28:31], v[36:39], v[120:123]
    v_mfma_f32_16x16x32_bf16 v[140:143], v[28:31], v[40:43], v[140:143]
    v_mfma_f32_16x16x32_bf16 v[160:163], v[28:31], v[44:47], v[160:163]
    s_waitcnt lgkmcnt(7)
    v_mfma_f32_16x16x32_bf16 v[84:87], v[48:51], v[68:71], v[84:87]
    s_waitcnt lgkmcnt(0)
    s_barrier
    ds_read_b128 v[12:15], v2 offset:0
    v_mfma_f32_16x16x32_bf16 v[104:107], v[48:51], v[72:75], v[104:107]
    ds_read_b128 v[32:35], v3 offset:0
    v_mfma_f32_16x16x32_bf16 v[124:127], v[48:51], v[76:79], v[124:127]
    ds_read_b128 v[36:39], v3 offset:2048
    v_mfma_f32_16x16x32_bf16 v[144:147], v[48:51], v[80:83], v[144:147]
    ds_read_b128 v[40:43], v3 offset:4096
    v_mfma_f32_16x16x32_bf16 v[88:91], v[52:55], v[68:71], v[88:91]
    ds_read_b128 v[44:47], v3 offset:6144
    v_mfma_f32_16x16x32_bf16 v[108:111], v[52:55], v[72:75], v[108:111]
    ds_read_b128 v[16:19], v2 offset:1024
    v_mfma_f32_16x16x32_bf16 v[128:131], v[52:55], v[76:79], v[128:131]
    ds_read_b128 v[20:23], v2 offset:2048
    v_mfma_f32_16x16x32_bf16 v[148:151], v[52:55], v[80:83], v[148:151]
    ds_read_b128 v[24:27], v2 offset:3072
    v_mfma_f32_16x16x32_bf16 v[92:95], v[56:59], v[68:71], v[92:95]
    ds_read_b128 v[28:31], v2 offset:4096
    v_mfma_f32_16x16x32_bf16 v[112:115], v[56:59], v[72:75], v[112:115]
    s_add_u32 s36, s36, 1
    s_cmp_eq_u32 s36, 4
    v_mfma_f32_16x16x32_bf16 v[132:135], v[56:59], v[76:79], v[132:135]
    s_cselect_b32 s38, 4294905856, s40
    s_cselect_b32 s36, 0, s36
    v_mfma_f32_16x16x32_bf16 v[152:155], v[56:59], v[80:83], v[152:155]
    s_add_u32 s37, s37, 1
    s_cmp_eq_u32 s37, 5
    v_mfma_f32_16x16x32_bf16 v[96:99], v[60:63], v[68:71], v[96:99]
    s_cselect_b32 s39, 4294901760, s41
    s_cselect_b32 s37, 0, s37
    v_mfma_f32_16x16x32_bf16 v[116:119], v[60:63], v[72:75], v[116:119]
    s_sub_u32 s42, s42, 1
    s_cmp_lg_u32 s42, 0
    v_mfma_f32_16x16x32_bf16 v[136:139], v[60:63], v[76:79], v[136:139]
    v_mfma_f32_16x16x32_bf16 v[156:159], v[60:63], v[80:83], v[156:159]
    v_mfma_f32_16x16x32_bf16 v[100:103], v[64:67], v[68:71], v[100:103]
    v_mfma_f32_16x16x32_bf16 v[120:123], v[64:67], v[72:75], v[120:123]
    v_mfma_f32_16x16x32_bf16 v[140:143], v[64:67], v[76:79], v[140:143]
    v_mfma_f32_16x16x32_bf16 v[160:163], v[64:67], v[80:83], v[160:163]
    s_cbranch_scc1 .f_yloop
    s_cmp_ge_u32 s31, 2
    s_cbranch_scc1 .f_yo
    s_waitcnt lgkmcnt(6)
    v_mfma_f32_16x16x32_bf16 v[104:107], v[12:15], v[36:39], v[104:107]
    ds_read_b128 v[48:51], v2 offset:10240
    ds_read_b128 v[72:75], v4 offset:2048
    s_xor_b32 s57, s31, 1
    s_mul_i32 s57, s57, 81920
    s_add_u32 s57, s57, 8192
    s_waitcnt lgkmcnt(5)
    v_mfma_f32_16x16x32_bf16 v[108:111], v[16:19], v[36:39], v[108:111]
    ds_read_b128 v[52:55], v2 offset:11264
    ds_read_b128 v[56:59], v2 offset:12288
    s_xor_b32 s58, s31, 2
    s_mul_i32 s58, s58, 81920
    s_add_u32 s58, s58, 12288
    s_waitcnt lgkmcnt(6)
    v_mfma_f32_16x16x32_bf16 v[112:115], v[20:23], v[36:39], v[112:115]
    ds_read_b128 v[60:63], v2 offset:13312
    ds_read_b128 v[64:67], v2 offset:14336
    s_xor_b32 s59, s31, 3
    s_mul_i32 s59, s59, 81920
    s_add_u32 s59, s59, 16384
    s_waitcnt lgkmcnt(7)
    v_mfma_f32_16x16x32_bf16 v[116:119], v[24:27], v[36:39], v[116:119]
    ds_read_b128 v[76:79], v4 offset:4096
    ds_read_b128 v[80:83], v4 offset:6144
    s_waitcnt lgkmcnt(8)
    v_mfma_f32_16x16x32_bf16 v[120:123], v[28:31], v[36:39], v[120:123]
    ds_read_b128 v[68:71], v4 offset:0
    v_mfma_f32_16x16x32_bf16 v[124:127], v[12:15], v[40:43], v[124:127]
    v_mfma_f32_16x16x32_bf16 v[128:131], v[16:19], v[40:43], v[128:131]
    v_mfma_f32_16x16x32_bf16 v[132:135], v[20:23], v[40:43], v[132:135]
    v_mfma_f32_16x16x32_bf16 v[136:139], v[24:27], v[40:43], v[136:139]
    v_mfma_f32_16x16x32_bf16 v[140:143], v[28:31], v[40:43], v[140:143]
    s_waitcnt lgkmcnt(7)
    v_mfma_f32_16x16x32_bf16 v[104:107], v[48:51], v[72:75], v[104:107]
    s_waitcnt lgkmcnt(6)
    v_mfma_f32_16x16x32_bf16 v[108:111], v[52:55], v[72:75], v[108:111]
    s_waitcnt lgkmcnt(5)
    v_mfma_f32_16x16x32_bf16 v[112:115], v[56:59], v[72:75], v[112:115]
    s_waitcnt lgkmcnt(4)
    v_mfma_f32_16x16x32_bf16 v[116:119], v[60:63], v[72:75], v[116:119]
    s_waitcnt lgkmcnt(3)
    v_mfma_f32_16x16x32_bf16 v[120:123], v[64:67], v[72:75], v[120:123]
    s_waitcnt lgkmcnt(2)
    v_mfma_f32_16x16x32_bf16 v[124:127], v[48:51], v[76:79], v[124:127]
    buffer_store_dword v248, v10, s[64:67], s57 offen offset:3072 sc1
    v_cvt_pk_bf16_f32 v104, v104, v105
    v_cvt_pk_bf16_f32 v105, v106, v107
    v_mfma_f32_16x16x32_bf16 v[128:131], v[52:55], v[76:79], v[128:131]
    v_cvt_pk_bf16_f32 v106, v108, v109
    v_cvt_pk_bf16_f32 v107, v110, v249
    buffer_store_dwordx4 v[104:107], v9, s[64:67], s57 offen offset:0 sc1
    v_mfma_f32_16x16x32_bf16 v[132:135], v[56:59], v[76:79], v[132:135]
    v_cvt_pk_bf16_f32 v108, v111, v112
    v_cvt_pk_bf16_f32 v109, v113, v114
    v_cvt_pk_bf16_f32 v110, v115, v116
    v_mfma_f32_16x16x32_bf16 v[136:139], v[60:63], v[76:79], v[136:139]
    v_cvt_pk_bf16_f32 v111, v117, v250
    buffer_store_dwordx4 v[108:111], v9, s[64:67], s57 offen offset:1024 sc1
    v_cvt_pk_bf16_f32 v112, v118, v119
    v_mfma_f32_16x16x32_bf16 v[140:143], v[64:67], v[76:79], v[140:143]
    v_cvt_pk_bf16_f32 v113, v120, v121
    v_cvt_pk_bf16_f32 v114, v122, v123
    v_mov_b32 v115, v248
    v_mfma_f32_16x16x32_bf16 v[144:147], v[12:15], v[44:47], v[144:147]
    buffer_store_dwordx4 v[112:115], v9, s[64:67], s57 offen offset:2048 sc1
    buffer_store_dword v248, v10, s[64:67], s58 offen offset:3072 sc1
    v_cvt_pk_bf16_f32 v124, v124, v125
    v_mfma_f32_16x16x32_bf16 v[148:151], v[16:19], v[44:47], v[148:151]
    v_cvt_pk_bf16_f32 v125, v126, v127
    v_cvt_pk_bf16_f32 v126, v128, v129
    v_cvt_pk_bf16_f32 v127, v130, v249
    v_mfma_f32_16x16x32_bf16 v[152:155], v[20:23], v[44:47], v[152:155]
    buffer_store_dwordx4 v[124:127], v9, s[64:67], s58 offen offset:0 sc1
    v_cvt_pk_bf16_f32 v128, v131, v132
    v_cvt_pk_bf16_f32 v129, v133, v134
    v_mfma_f32_16x16x32_bf16 v[156:159], v[24:27], v[44:47], v[156:159]
    v_cvt_pk_bf16_f32 v130, v135, v136
    v_cvt_pk_bf16_f32 v131, v137, v250
    buffer_store_dwordx4 v[128:131], v9, s[64:67], s58 offen offset:1024 sc1
    v_mfma_f32_16x16x32_bf16 v[160:163], v[28:31], v[44:47], v[160:163]
    v_cvt_pk_bf16_f32 v132, v138, v139
    v_cvt_pk_bf16_f32 v133, v140, v141
    v_cvt_pk_bf16_f32 v134, v142, v143
    s_waitcnt lgkmcnt(1)
    v_mfma_f32_16x16x32_bf16 v[144:147], v[48:51], v[80:83], v[144:147]
    v_mov_b32 v135, v248
    buffer_store_dwordx4 v[132:135], v9, s[64:67], s58 offen offset:2048 sc1
    v_mfma_f32_16x16x32_bf16 v[148:151], v[52:55], v[80:83], v[148:151]
    v_mfma_f32_16x16x32_bf16 v[152:155], v[56:59], v[80:83], v[152:155]
    v_mfma_f32_16x16x32_bf16 v[156:159], v[60:63], v[80:83], v[156:159]
    v_mfma_f32_16x16x32_bf16 v[160:163], v[64:67], v[80:83], v[160:163]
    v_mfma_f32_16x16x32_bf16 v[84:87], v[12:15], v[32:35], v[84:87]
    buffer_store_dword v248, v10, s[64:67], s59 offen offset:3072 sc1
    v_cvt_pk_bf16_f32 v144, v144, v145
    v_cvt_pk_bf16_f32 v145, v146, v147
    v_mfma_f32_16x16x32_bf16 v[88:91], v[16:19], v[32:35], v[88:91]
    v_cvt_pk_bf16_f32 v146, v148, v149
    v_cvt_pk_bf16_f32 v147, v150, v249
    buffer_store_dwordx4 v[144:147], v9, s[64:67], s59 offen offset:0 sc1
    v_mfma_f32_16x16x32_bf16 v[92:95], v[20:23], v[32:35], v[92:95]
    v_cvt_pk_bf16_f32 v148, v151, v152
    v_cvt_pk_bf16_f32 v149, v153, v154
    v_cvt_pk_bf16_f32 v150, v155, v156
    v_mfma_f32_16x16x32_bf16 v[96:99], v[24:27], v[32:35], v[96:99]
    v_cvt_pk_bf16_f32 v151, v157, v250
    buffer_store_dwordx4 v[148:151], v9, s[64:67], s59 offen offset:1024 sc1
    v_cvt_pk_bf16_f32 v152, v158, v159
    v_mfma_f32_16x16x32_bf16 v[100:103], v[28:31], v[32:35], v[100:103]
    v_cvt_pk_bf16_f32 v153, v160, v161
    v_cvt_pk_bf16_f32 v154, v162, v163
    v_mov_b32 v155, v248
    s_waitcnt lgkmcnt(0)
    v_mfma_f32_16x16x32_bf16 v[84:87], v[48:51], v[68:71], v[84:87]
    buffer_store_dwordx4 v[152:155], v9, s[64:67], s59 offen offset:2048 sc1
    v_mfma_f32_16x16x32_bf16 v[88:91], v[52:55], v[68:71], v[88:91]
    v_mfma_f32_16x16x32_bf16 v[92:95], v[56:59], v[68:71], v[92:95]
    v_mfma_f32_16x16x32_bf16 v[96:99], v[60:63], v[68:71], v[96:99]
    v_mfma_f32_16x16x32_bf16 v[100:103], v[64:67], v[68:71], v[100:103]
    s_nop 7
    ds_write_b128 v11, v[84:87] offset:0
    ds_write_b128 v11, v[88:91] offset:1024
    ds_write_b128 v11, v[92:95] offset:2048
    ds_write_b128 v11, v[96:99] offset:3072
    ds_write_b128 v11, v[100:103] offset:4096
    ds_write_b32 v251, v248
    s_endpgm
.f_yo:
    s_waitcnt lgkmcnt(7)
    v_mfma_f32_16x16x32_bf16 v[84:87], v[12:15], v[32:35], v[84:87]
    ds_read_b128 v[48:51], v2 offset:10240
    s_waitcnt lgkmcnt(7)
    v_mfma_f32_16x16x32_bf16 v[104:107], v[12:15], v[36:39], v[104:107]
    ds_read_b128 v[68:71], v4 offset:0
    s_waitcnt lgkmcnt(7)
    v_mfma_f32_16x16x32_bf16 v[124:127], v[12:15], v[40:43], v[124:127]
    ds_read_b128 v[72:75], v4 offset:2048
    s_waitcnt lgkmcnt(7)
    v_mfma_f32_16x16x32_bf16 v[144:147], v[12:15], v[44:47], v[144:147]
    ds_read_b128 v[76:79], v4 offset:4096
    s_waitcnt lgkmcnt(7)
    v_mfma_f32_16x16x32_bf16 v[88:91], v[16:19], v[32:35], v[88:91]
    ds_read_b128 v[80:83], v4 offset:6144
    v_mfma_f32_16x16x32_bf16 v[108:111], v[16:19], v[36:39], v[108:111]
    ds_read_b128 v[52:55], v2 offset:11264
    v_mfma_f32_16x16x32_bf16 v[128:131], v[16:19], v[40:43], v[128:131]
    ds_read_b128 v[56:59], v2 offset:12288
    v_mfma_f32_16x16x32_bf16 v[148:151], v[16:19], v[44:47], v[148:151]
    ds_read_b128 v[60:63], v2 offset:13312
    s_waitcnt lgkmcnt(10)
    v_mfma_f32_16x16x32_bf16 v[92:95], v[20:23], v[32:35], v[92:95]
    ds_read_b128 v[64:67], v2 offset:14336
    v_mfma_f32_16x16x32_bf16 v[112:115], v[20:23], v[36:39], v[112:115]
    v_add_u32 v2, s38, v2
    v_add_u32 v5, s38, v5
    v_mfma_f32_16x16x32_bf16 v[132:135], v[20:23], v[40:43], v[132:135]
    v_add_u32 v6, s38, v6
    v_add_u32 v3, s39, v3
    v_mfma_f32_16x16x32_bf16 v[152:155], v[20:23], v[44:47], v[152:155]
    v_add_u32 v4, s39, v4
    v_add_u32 v7, s39, v7
    s_waitcnt lgkmcnt(10)
    v_mfma_f32_16x16x32_bf16 v[96:99], v[24:27], v[32:35], v[96:99]
    v_mfma_f32_16x16x32_bf16 v[116:119], v[24:27], v[36:39], v[116:119]
    v_mfma_f32_16x16x32_bf16 v[136:139], v[24:27], v[40:43], v[136:139]
    v_mfma_f32_16x16x32_bf16 v[156:159], v[24:27], v[44:47], v[156:159]
    s_waitcnt lgkmcnt(9)
    v_mfma_f32_16x16x32_bf16 v[100:103], v[28:31], v[32:35], v[100:103]
    v_mfma_f32_16x16x32_bf16 v[120:123], v[28:31], v[36:39], v[120:123]
    v_mfma_f32_16x16x32_bf16 v[140:143], v[28:31], v[40:43], v[140:143]
    v_mfma_f32_16x16x32_bf16 v[160:163], v[28:31], v[44:47], v[160:163]
    s_waitcnt lgkmcnt(7)
    v_mfma_f32_16x16x32_bf16 v[84:87], v[48:51], v[68:71], v[84:87]
    s_waitcnt lgkmcnt(0)
    s_barrier
    ds_read_b64_tr_b16 v[12:13], v5 offset:0
    v_mfma_f32_16x16x32_bf16 v[104:107], v[48:51], v[72:75], v[104:107]
    ds_read_b64_tr_b16 v[14:15], v5 offset:1280
    v_mfma_f32_16x16x32_bf16 v[124:127], v[48:51], v[76:79], v[124:127]
    ds_read_b128 v[32:35], v7 offset:0
    v_mfma_f32_16x16x32_bf16 v[144:147], v[48:51], v[80:83], v[144:147]
    ds_read_b128 v[36:39], v7 offset:1024
    v_mfma_f32_16x16x32_bf16 v[88:91], v[52:55], v[68:71], v[88:91]
    ds_read_b128 v[40:43], v7 offset:2048
    v_mfma_f32_16x16x32_bf16 v[108:111], v[52:55], v[72:75], v[108:111]
    ds_read_b128 v[44:47], v7 offset:3072
    v_mfma_f32_16x16x32_bf16 v[128:131], v[52:55], v[76:79], v[128:131]
    ds_read_b64_tr_b16 v[16:17], v6 offset:32
    v_mfma_f32_16x16x32_bf16 v[148:151], v[52:55], v[80:83], v[148:151]
    ds_read_b64_tr_b16 v[18:19], v6 offset:1312
    v_mfma_f32_16x16x32_bf16 v[92:95], v[56:59], v[68:71], v[92:95]
    ds_read_b64_tr_b16 v[20:21], v5 offset:64
    v_mfma_f32_16x16x32_bf16 v[112:115], v[56:59], v[72:75], v[112:115]
    ds_read_b64_tr_b16 v[22:23], v5 offset:1344
    v_mfma_f32_16x16x32_bf16 v[132:135], v[56:59], v[76:79], v[132:135]
    ds_read_b64_tr_b16 v[24:25], v6 offset:96
    v_mfma_f32_16x16x32_bf16 v[152:155], v[56:59], v[80:83], v[152:155]
    ds_read_b64_tr_b16 v[26:27], v6 offset:1376
    v_mfma_f32_16x16x32_bf16 v[96:99], v[60:63], v[68:71], v[96:99]
    ds_read_b64_tr_b16 v[28:29], v5 offset:128
    v_mfma_f32_16x16x32_bf16 v[116:119], v[60:63], v[72:75], v[116:119]
    ds_read_b64_tr_b16 v[30:31], v5 offset:1408
    v_mfma_f32_16x16x32_bf16 v[136:139], v[60:63], v[76:79], v[136:139]
    s_add_u32 s36, s36, 1
    s_cmp_eq_u32 s36, 4
    v_mfma_f32_16x16x32_bf16 v[156:159], v[60:63], v[80:83], v[156:159]
    s_cselect_b32 s38, 4294905856, s40
    s_cselect_b32 s36, 0, s36
    v_mfma_f32_16x16x32_bf16 v[100:103], v[64:67], v[68:71], v[100:103]
    s_add_u32 s37, s37, 1
    s_cmp_eq_u32 s37, 5
    v_mfma_f32_16x16x32_bf16 v[120:123], v[64:67], v[72:75], v[120:123]
    s_cselect_b32 s39, 4294901760, s41
    s_cselect_b32 s37, 0, s37
    v_mfma_f32_16x16x32_bf16 v[140:143], v[64:67], v[76:79], v[140:143]
    s_xor_b32 s57, s31, 1
    s_mul_i32 s57, s57, 81920
    v_mfma_f32_16x16x32_bf16 v[160:163], v[64:67], v[80:83], v[160:163]
    s_add_u32 s57, s57, s43
    s_xor_b32 s58, s31, 2
    s_mul_i32 s58, s58, 81920
    s_add_u32 s58, s58, s43
    s_xor_b32 s59, s31, 3
    s_mul_i32 s59, s59, 81920
    s_add_u32 s59, s59, s43
    s_waitcnt lgkmcnt(11)
    v_mfma_f32_16x16x32_bf16 v[164:167], v[12:15], v[32:35], 0
    ds_read_b64_tr_b16 v[48:49], v5 offset:10240
    v_cvt_pk_bf16_f32 v104, v104, v105
    s_waitcnt lgkmcnt(11)
    v_mfma_f32_16x16x32_bf16 v[184:187], v[12:15], v[36:39], 0
    ds_read_b64_tr_b16 v[50:51], v5 offset:11520
    v_cvt_pk_bf16_f32 v105, v106, v107
    s_waitcnt lgkmcnt(11)
    v_mfma_f32_16x16x32_bf16 v[204:207], v[12:15], v[40:43], 0
    ds_read_b128 v[68:71], v7 offset:8192
    v_cvt_pk_bf16_f32 v106, v108, v109
    s_waitcnt lgkmcnt(11)
    v_mfma_f32_16x16x32_bf16 v[224:227], v[12:15], v[44:47], 0
    ds_read_b128 v[72:75], v7 offset:9216
    v_cvt_pk_bf16_f32 v107, v110, v249
    s_waitcnt lgkmcnt(10)
    v_mfma_f32_16x16x32_bf16 v[168:171], v[16:19], v[32:35], 0
    ds_read_b128 v[76:79], v7 offset:10240
    buffer_store_dwordx4 v[104:107], v9, s[64:67], s57 offen offset:0 sc1
    v_mfma_f32_16x16x32_bf16 v[188:191], v[16:19], v[36:39], 0
    ds_read_b128 v[80:83], v7 offset:11264
    v_mfma_f32_16x16x32_bf16 v[208:211], v[16:19], v[40:43], 0
    ds_read_b64_tr_b16 v[52:53], v6 offset:10272
    v_mfma_f32_16x16x32_bf16 v[228:231], v[16:19], v[44:47], 0
    ds_read_b64_tr_b16 v[54:55], v6 offset:11552
    s_waitcnt lgkmcnt(12)
    v_mfma_f32_16x16x32_bf16 v[172:175], v[20:23], v[32:35], 0
    ds_read_b64_tr_b16 v[56:57], v5 offset:10304
    v_mfma_f32_16x16x32_bf16 v[192:195], v[20:23], v[36:39], 0
    ds_read_b64_tr_b16 v[58:59], v5 offset:11584
    v_mfma_f32_16x16x32_bf16 v[212:215], v[20:23], v[40:43], 0
    ds_read_b64_tr_b16 v[60:61], v6 offset:10336
    v_mfma_f32_16x16x32_bf16 v[232:235], v[20:23], v[44:47], 0
    ds_read_b64_tr_b16 v[62:63], v6 offset:11616
    s_waitcnt lgkmcnt(14)
    v_mfma_f32_16x16x32_bf16 v[176:179], v[24:27], v[32:35], 0
    ds_read_b64_tr_b16 v[64:65], v5 offset:10368
    v_mfma_f32_16x16x32_bf16 v[196:199], v[24:27], v[36:39], 0
    ds_read_b64_tr_b16 v[66:67], v5 offset:11648
    v_add_u32 v2, s38, v2
    v_mfma_f32_16x16x32_bf16 v[216:219], v[24:27], v[40:43], 0
    v_add_u32 v5, s38, v5
    v_add_u32 v6, s38, v6
    v_mfma_f32_16x16x32_bf16 v[236:239], v[24:27], v[44:47], 0
    v_add_u32 v3, s39, v3
    v_add_u32 v4, s39, v4
    s_waitcnt lgkmcnt(14)
    v_mfma_f32_16x16x32_bf16 v[180:183], v[28:31], v[32:35], 0
    v_add_u32 v7, s39, v7
    v_mfma_f32_16x16x32_bf16 v[200:203], v[28:31], v[36:39], 0
    v_mfma_f32_16x16x32_bf16 v[220:223], v[28:31], v[40:43], 0
    v_mfma_f32_16x16x32_bf16 v[240:243], v[28:31], v[44:47], 0
    s_waitcnt lgkmcnt(11)
    v_mfma_f32_16x16x32_bf16 v[164:167], v[48:51], v[68:71], v[164:167]
    s_waitcnt lgkmcnt(0)
    s_barrier
    ds_read_b64_tr_b16 v[12:13], v5 offset:0
    v_cvt_pk_bf16_f32 v108, v111, v112
    v_mfma_f32_16x16x32_bf16 v[184:187], v[48:51], v[72:75], v[184:187]
    ds_read_b64_tr_b16 v[14:15], v5 offset:1280
    v_cvt_pk_bf16_f32 v109, v113, v114
    v_mfma_f32_16x16x32_bf16 v[204:207], v[48:51], v[76:79], v[204:207]
    ds_read_b128 v[32:35], v7 offset:0
    v_cvt_pk_bf16_f32 v110, v115, v116
    v_mfma_f32_16x16x32_bf16 v[224:227], v[48:51], v[80:83], v[224:227]
    ds_read_b128 v[36:39], v7 offset:1024
    v_cvt_pk_bf16_f32 v111, v117, v250
    v_mfma_f32_16x16x32_bf16 v[168:171], v[52:55], v[68:71], v[168:171]
    ds_read_b128 v[40:43], v7 offset:2048
    buffer_store_dwordx4 v[108:111], v9, s[64:67], s57 offen offset:1024 sc1
    v_mfma_f32_16x16x32_bf16 v[188:191], v[52:55], v[72:75], v[188:191]
    ds_read_b128 v[44:47], v7 offset:3072
    v_mfma_f32_16x16x32_bf16 v[208:211], v[52:55], v[76:79], v[208:211]
    ds_read_b64_tr_b16 v[16:17], v6 offset:32
    v_mfma_f32_16x16x32_bf16 v[228:231], v[52:55], v[80:83], v[228:231]
    ds_read_b64_tr_b16 v[18:19], v6 offset:1312
    v_mfma_f32_16x16x32_bf16 v[172:175], v[56:59], v[68:71], v[172:175]
    ds_read_b64_tr_b16 v[20:21], v5 offset:64
    v_mfma_f32_16x16x32_bf16 v[192:195], v[56:59], v[72:75], v[192:195]
    ds_read_b64_tr_b16 v[22:23], v5 offset:1344
    v_mfma_f32_16x16x32_bf16 v[212:215], v[56:59], v[76:79], v[212:215]
    ds_read_b64_tr_b16 v[24:25], v6 offset:96
    v_mfma_f32_16x16x32_bf16 v[232:235], v[56:59], v[80:83], v[232:235]
    ds_read_b64_tr_b16 v[26:27], v6 offset:1376
    v_mfma_f32_16x16x32_bf16 v[176:179], v[60:63], v[68:71], v[176:179]
    ds_read_b64_tr_b16 v[28:29], v5 offset:128
    v_mfma_f32_16x16x32_bf16 v[196:199], v[60:63], v[72:75], v[196:199]
    ds_read_b64_tr_b16 v[30:31], v5 offset:1408
    s_add_u32 s36, s36, 1
    v_mfma_f32_16x16x32_bf16 v[216:219], v[60:63], v[76:79], v[216:219]
    s_cmp_eq_u32 s36, 4
    s_cselect_b32 s38, 4294905856, s40
    v_mfma_f32_16x16x32_bf16 v[236:239], v[60:63], v[80:83], v[236:239]
    s_cselect_b32 s36, 0, s36
    s_add_u32 s37, s37, 1
    v_mfma_f32_16x16x32_bf16 v[180:183], v[64:67], v[68:71], v[180:183]
    s_cmp_eq_u32 s37, 5
    s_cselect_b32 s39, 4294901760, s41
    v_mfma_f32_16x16x32_bf16 v[200:203], v[64:67], v[72:75], v[200:203]
    s_cselect_b32 s37, 0, s37
    v_mfma_f32_16x16x32_bf16 v[220:223], v[64:67], v[76:79], v[220:223]
    v_mfma_f32_16x16x32_bf16 v[240:243], v[64:67], v[80:83], v[240:243]
    s_waitcnt lgkmcnt(11)
    v_mfma_f32_16x16x32_bf16 v[164:167], v[12:15], v[32:35], v[164:167]
    ds_read_b64_tr_b16 v[48:49], v5 offset:10240
    v_cvt_pk_bf16_f32 v112, v118, v119
    s_waitcnt lgkmcnt(11)
    v_mfma_f32_16x16x32_bf16 v[184:187], v[12:15], v[36:39], v[184:187]
    ds_read_b64_tr_b16 v[50:51], v5 offset:11520
    v_cvt_pk_bf16_f32 v113, v120, v121
    s_waitcnt lgkmcnt(11)
    v_mfma_f32_16x16x32_bf16 v[204:207], v[12:15], v[40:43], v[204:207]
    ds_read_b128 v[68:71], v7 offset:8192
    v_cvt_pk_bf16_f32 v114, v122, v123
    s_waitcnt lgkmcnt(11)
    v_mfma_f32_16x16x32_bf16 v[224:227], v[12:15], v[44:47], v[224:227]
    ds_read_b128 v[72:75], v7 offset:9216
    v_mov_b32 v115, v248
    s_waitcnt lgkmcnt(10)
    v_mfma_f32_16x16x32_bf16 v[168:171], v[16:19], v[32:35], v[168:171]
    ds_read_b128 v[76:79], v7 offset:10240
    buffer_store_dwordx4 v[112:115], v9, s[64:67], s57 offen offset:2048 sc1
    v_mfma_f32_16x16x32_bf16 v[188:191], v[16:19], v[36:39], v[188:191]
    ds_read_b128 v[80:83], v7 offset:11264
    v_mfma_f32_16x16x32_bf16 v[208:211], v[16:19], v[40:43], v[208:211]
    ds_read_b64_tr_b16 v[52:53], v6 offset:10272
    v_mfma_f32_16x16x32_bf16 v[228:231], v[16:19], v[44:47], v[228:231]
    ds_read_b64_tr_b16 v[54:55], v6 offset:11552
    s_waitcnt lgkmcnt(12)
    v_mfma_f32_16x16x32_bf16 v[172:175], v[20:23], v[32:35], v[172:175]
    ds_read_b64_tr_b16 v[56:57], v5 offset:10304
    v_mfma_f32_16x16x32_bf16 v[192:195], v[20:23], v[36:39], v[192:195]
    ds_read_b64_tr_b16 v[58:59], v5 offset:11584
    v_mfma_f32_16x16x32_bf16 v[212:215], v[20:23], v[40:43], v[212:215]
    ds_read_b64_tr_b16 v[60:61], v6 offset:10336
    v_mfma_f32_16x16x32_bf16 v[232:235], v[20:23], v[44:47], v[232:235]
    ds_read_b64_tr_b16 v[62:63], v6 offset:11616
    s_waitcnt lgkmcnt(14)
    v_mfma_f32_16x16x32_bf16 v[176:179], v[24:27], v[32:35], v[176:179]
    ds_read_b64_tr_b16 v[64:65], v5 offset:10368
    v_mfma_f32_16x16x32_bf16 v[196:199], v[24:27], v[36:39], v[196:199]
    ds_read_b64_tr_b16 v[66:67], v5 offset:11648
    v_add_u32 v2, s38, v2
    v_mfma_f32_16x16x32_bf16 v[216:219], v[24:27], v[40:43], v[216:219]
    v_add_u32 v5, s38, v5
    v_add_u32 v6, s38, v6
    v_mfma_f32_16x16x32_bf16 v[236:239], v[24:27], v[44:47], v[236:239]
    v_add_u32 v3, s39, v3
    v_add_u32 v4, s39, v4
    s_waitcnt lgkmcnt(14)
    v_mfma_f32_16x16x32_bf16 v[180:183], v[28:31], v[32:35], v[180:183]
    v_add_u32 v7, s39, v7
    v_mfma_f32_16x16x32_bf16 v[200:203], v[28:31], v[36:39], v[200:203]
    v_mfma_f32_16x16x32_bf16 v[220:223], v[28:31], v[40:43], v[220:223]
    v_mfma_f32_16x16x32_bf16 v[240:243], v[28:31], v[44:47], v[240:243]
    s_waitcnt lgkmcnt(11)
    v_mfma_f32_16x16x32_bf16 v[164:167], v[48:51], v[68:71], v[164:167]
    s_waitcnt lgkmcnt(0)
    s_barrier
    ds_read_b64_tr_b16 v[12:13], v5 offset:0
    v_cvt_pk_bf16_f32 v124, v124, v125
    v_mfma_f32_16x16x32_bf16 v[184:187], v[48:51], v[72:75], v[184:187]
    ds_read_b64_tr_b16 v[14:15], v5 offset:1280
    v_cvt_pk_bf16_f32 v125, v126, v127
    v_mfma_f32_16x16x32_bf16 v[204:207], v[48:51], v[76:79], v[204:207]
    ds_read_b128 v[32:35], v7 offset:0
    v_cvt_pk_bf16_f32 v126, v128, v129
    v_mfma_f32_16x16x32_bf16 v[224:227], v[48:51], v[80:83], v[224:227]
    ds_read_b128 v[36:39], v7 offset:1024
    v_cvt_pk_bf16_f32 v127, v130, v249
    v_mfma_f32_16x16x32_bf16 v[168:171], v[52:55], v[68:71], v[168:171]
    ds_read_b128 v[40:43], v7 offset:2048
    buffer_store_dwordx4 v[124:127], v9, s[64:67], s58 offen offset:0 sc1
    v_mfma_f32_16x16x32_bf16 v[188:191], v[52:55], v[72:75], v[188:191]
    ds_read_b128 v[44:47], v7 offset:3072
    v_mfma_f32_16x16x32_bf16 v[208:211], v[52:55], v[76:79], v[208:211]
    ds_read_b64_tr_b16 v[16:17], v6 offset:32
    v_mfma_f32_16x16x32_bf16 v[228:231], v[52:55], v[80:83], v[228:231]
    ds_read_b64_tr_b16 v[18:19], v6 offset:1312
    v_mfma_f32_16x16x32_bf16 v[172:175], v[56:59], v[68:71], v[172:175]
    ds_read_b64_tr_b16 v[20:21], v5 offset:64
    v_mfma_f32_16x16x32_bf16 v[192:195], v[56:59], v[72:75], v[192:195]
    ds_read_b64_tr_b16 v[22:23], v5 offset:1344
    v_mfma_f32_16x16x32_bf16 v[212:215], v[56:59], v[76:79], v[212:215]
    ds_read_b64_tr_b16 v[24:25], v6 offset:96
    v_mfma_f32_16x16x32_bf16 v[232:235], v[56:59], v[80:83], v[232:235]
    ds_read_b64_tr_b16 v[26:27], v6 offset:1376
    v_mfma_f32_16x16x32_bf16 v[176:179], v[60:63], v[68:71], v[176:179]
    ds_read_b64_tr_b16 v[28:29], v5 offset:128
    v_mfma_f32_16x16x32_bf16 v[196:199], v[60:63], v[72:75], v[196:199]
    ds_read_b64_tr_b16 v[30:31], v5 offset:1408
    s_add_u32 s36, s36, 1
    v_mfma_f32_16x16x32_bf16 v[216:219], v[60:63], v[76:79], v[216:219]
    s_cmp_eq_u32 s36, 4
    s_cselect_b32 s38, 4294905856, s40
    v_mfma_f32_16x16x32_bf16 v[236:239], v[60:63], v[80:83], v[236:239]
    s_cselect_b32 s36, 0, s36
    s_add_u32 s37, s37, 1
    v_mfma_f32_16x16x32_bf16 v[180:183], v[64:67], v[68:71], v[180:183]
    s_cmp_eq_u32 s37, 5
    s_cselect_b32 s39, 4294901760, s41
    v_mfma_f32_16x16x32_bf16 v[200:203], v[64:67], v[72:75], v[200:203]
    s_cselect_b32 s37, 0, s37
    v_mfma_f32_16x16x32_bf16 v[220:223], v[64:67], v[76:79], v[220:223]
    v_mfma_f32_16x16x32_bf16 v[240:243], v[64:67], v[80:83], v[240:243]
    s_waitcnt lgkmcnt(11)
    v_mfma_f32_16x16x32_bf16 v[164:167], v[12:15], v[32:35], v[164:167]
    ds_read_b64_tr_b16 v[48:49], v5 offset:10240
    v_cvt_pk_bf16_f32 v128, v131, v132
    s_waitcnt lgkmcnt(11)
    v_mfma_f32_16x16x32_bf16 v[184:187], v[12:15], v[36:39], v[184:187]
    ds_read_b64_tr_b16 v[50:51], v5 offset:11520
    v_cvt_pk_bf16_f32 v129, v133, v134
    s_waitcnt lgkmcnt(11)
    v_mfma_f32_16x16x32_bf16 v[204:207], v[12:15], v[40:43], v[204:207]
    ds_read_b128 v[68:71], v7 offset:8192
    v_cvt_pk_bf16_f32 v130, v135, v136
    s_waitcnt lgkmcnt(11)
    v_mfma_f32_16x16x32_bf16 v[224:227], v[12:15], v[44:47], v[224:227]
    ds_read_b128 v[72:75], v7 offset:9216
    v_cvt_pk_bf16_f32 v131, v137, v250
    s_waitcnt lgkmcnt(10)
    v_mfma_f32_16x16x32_bf16 v[168:171], v[16:19], v[32:35], v[168:171]
    ds_read_b128 v[76:79], v7 offset:10240
    buffer_store_dwordx4 v[128:131], v9, s[64:67], s58 offen offset:1024 sc1
    v_mfma_f32_16x16x32_bf16 v[188:191], v[16:19], v[36:39], v[188:191]
    ds_read_b128 v[80:83], v7 offset:11264
    v_mfma_f32_16x16x32_bf16 v[208:211], v[16:19], v[40:43], v[208:211]
    ds_read_b64_tr_b16 v[52:53], v6 offset:10272
    v_mfma_f32_16x16x32_bf16 v[228:231], v[16:19], v[44:47], v[228:231]
    ds_read_b64_tr_b16 v[54:55], v6 offset:11552
    s_waitcnt lgkmcnt(12)
    v_mfma_f32_16x16x32_bf16 v[172:175], v[20:23], v[32:35], v[172:175]
    ds_read_b64_tr_b16 v[56:57], v5 offset:10304
    v_mfma_f32_16x16x32_bf16 v[192:195], v[20:23], v[36:39], v[192:195]
    ds_read_b64_tr_b16 v[58:59], v5 offset:11584
    v_mfma_f32_16x16x32_bf16 v[212:215], v[20:23], v[40:43], v[212:215]
    ds_read_b64_tr_b16 v[60:61], v6 offset:10336
    v_mfma_f32_16x16x32_bf16 v[232:235], v[20:23], v[44:47], v[232:235]
    ds_read_b64_tr_b16 v[62:63], v6 offset:11616
    s_waitcnt lgkmcnt(14)
    v_mfma_f32_16x16x32_bf16 v[176:179], v[24:27], v[32:35], v[176:179]
    ds_read_b64_tr_b16 v[64:65], v5 offset:10368
    v_mfma_f32_16x16x32_bf16 v[196:199], v[24:27], v[36:39], v[196:199]
    ds_read_b64_tr_b16 v[66:67], v5 offset:11648
    v_add_u32 v2, s38, v2
    v_mfma_f32_16x16x32_bf16 v[216:219], v[24:27], v[40:43], v[216:219]
    v_add_u32 v5, s38, v5
    v_add_u32 v6, s38, v6
    v_mfma_f32_16x16x32_bf16 v[236:239], v[24:27], v[44:47], v[236:239]
    v_add_u32 v3, s39, v3
    v_add_u32 v4, s39, v4
    s_waitcnt lgkmcnt(14)
    v_mfma_f32_16x16x32_bf16 v[180:183], v[28:31], v[32:35], v[180:183]
    v_add_u32 v7, s39, v7
    v_mfma_f32_16x16x32_bf16 v[200:203], v[28:31], v[36:39], v[200:203]
    v_mfma_f32_16x16x32_bf16 v[220:223], v[28:31], v[40:43], v[220:223]
    v_mfma_f32_16x16x32_bf16 v[240:243], v[28:31], v[44:47], v[240:243]
    s_waitcnt lgkmcnt(11)
    v_mfma_f32_16x16x32_bf16 v[164:167], v[48:51], v[68:71], v[164:167]
    s_waitcnt lgkmcnt(0)
    s_barrier
    ds_read_b64_tr_b16 v[12:13], v5 offset:0
    v_cvt_pk_bf16_f32 v132, v138, v139
    v_mfma_f32_16x16x32_bf16 v[184:187], v[48:51], v[72:75], v[184:187]
    ds_read_b64_tr_b16 v[14:15], v5 offset:1280
    v_cvt_pk_bf16_f32 v133, v140, v141
    v_mfma_f32_16x16x32_bf16 v[204:207], v[48:51], v[76:79], v[204:207]
    ds_read_b128 v[32:35], v7 offset:0
    v_cvt_pk_bf16_f32 v134, v142, v143
    v_mfma_f32_16x16x32_bf16 v[224:227], v[48:51], v[80:83], v[224:227]
    ds_read_b128 v[36:39], v7 offset:1024
    v_mov_b32 v135, v248
    v_mfma_f32_16x16x32_bf16 v[168:171], v[52:55], v[68:71], v[168:171]
    ds_read_b128 v[40:43], v7 offset:2048
    buffer_store_dwordx4 v[132:135], v9, s[64:67], s58 offen offset:2048 sc1
    v_mfma_f32_16x16x32_bf16 v[188:191], v[52:55], v[72:75], v[188:191]
    ds_read_b128 v[44:47], v7 offset:3072
    v_mfma_f32_16x16x32_bf16 v[208:211], v[52:55], v[76:79], v[208:211]
    ds_read_b64_tr_b16 v[16:17], v6 offset:32
    v_mfma_f32_16x16x32_bf16 v[228:231], v[52:55], v[80:83], v[228:231]
    ds_read_b64_tr_b16 v[18:19], v6 offset:1312
    v_mfma_f32_16x16x32_bf16 v[172:175], v[56:59], v[68:71], v[172:175]
    ds_read_b64_tr_b16 v[20:21], v5 offset:64
    v_mfma_f32_16x16x32_bf16 v[192:195], v[56:59], v[72:75], v[192:195]
    ds_read_b64_tr_b16 v[22:23], v5 offset:1344
    v_mfma_f32_16x16x32_bf16 v[212:215], v[56:59], v[76:79], v[212:215]
    ds_read_b64_tr_b16 v[24:25], v6 offset:96
    v_mfma_f32_16x16x32_bf16 v[232:235], v[56:59], v[80:83], v[232:235]
    ds_read_b64_tr_b16 v[26:27], v6 offset:1376
    v_mfma_f32_16x16x32_bf16 v[176:179], v[60:63], v[68:71], v[176:179]
    ds_read_b64_tr_b16 v[28:29], v5 offset:128
    v_mfma_f32_16x16x32_bf16 v[196:199], v[60:63], v[72:75], v[196:199]
    ds_read_b64_tr_b16 v[30:31], v5 offset:1408
    s_add_u32 s36, s36, 1
    v_mfma_f32_16x16x32_bf16 v[216:219], v[60:63], v[76:79], v[216:219]
    s_cmp_eq_u32 s36, 4
    s_cselect_b32 s38, 4294905856, s40
    v_mfma_f32_16x16x32_bf16 v[236:239], v[60:63], v[80:83], v[236:239]
    s_cselect_b32 s36, 0, s36
    s_add_u32 s37, s37, 1
    v_mfma_f32_16x16x32_bf16 v[180:183], v[64:67], v[68:71], v[180:183]
    s_cmp_eq_u32 s37, 5
    s_cselect_b32 s39, 4294901760, s41
    v_mfma_f32_16x16x32_bf16 v[200:203], v[64:67], v[72:75], v[200:203]
    s_cselect_b32 s37, 0, s37
    v_mfma_f32_16x16x32_bf16 v[220:223], v[64:67], v[76:79], v[220:223]
    v_mfma_f32_16x16x32_bf16 v[240:243], v[64:67], v[80:83], v[240:243]
    s_waitcnt lgkmcnt(11)
    v_mfma_f32_16x16x32_bf16 v[164:167], v[12:15], v[32:35], v[164:167]
    ds_read_b64_tr_b16 v[48:49], v5 offset:10240
    v_cvt_pk_bf16_f32 v144, v144, v145
    s_waitcnt lgkmcnt(11)
    v_mfma_f32_16x16x32_bf16 v[184:187], v[12:15], v[36:39], v[184:187]
    ds_read_b64_tr_b16 v[50:51], v5 offset:11520
    v_cvt_pk_bf16_f32 v145, v146, v147
    s_waitcnt lgkmcnt(11)
    v_mfma_f32_16x16x32_bf16 v[204:207], v[12:15], v[40:43], v[204:207]
    ds_read_b128 v[68:71], v7 offset:8192
    v_cvt_pk_bf16_f32 v146, v148, v149
    s_waitcnt lgkmcnt(11)
    v_mfma_f32_16x16x32_bf16 v[224:227], v[12:15], v[44:47], v[224:227]
    ds_read_b128 v[72:75], v7 offset:9216
    v_cvt_pk_bf16_f32 v147, v150, v249
    s_waitcnt lgkmcnt(10)
    v_mfma_f32_16x16x32_bf16 v[168:171], v[16:19], v[32:35], v[168:171]
    ds_read_b128 v[76:79], v7 offset:10240
    buffer_store_dwordx4 v[144:147], v9, s[64:67], s59 offen offset:0 sc1
    v_mfma_f32_16x16x32_bf16 v[188:191], v[16:19], v[36:39], v[188:191]
    ds_read_b128 v[80:83], v7 offset:11264
    v_mfma_f32_16x16x32_bf16 v[208:211], v[16:19], v[40:43], v[208:211]
    ds_read_b64_tr_b16 v[52:53], v6 offset:10272
    v_mfma_f32_16x16x32_bf16 v[228:231], v[16:19], v[44:47], v[228:231]
    ds_read_b64_tr_b16 v[54:55], v6 offset:11552
    s_waitcnt lgkmcnt(12)
    v_mfma_f32_16x16x32_bf16 v[172:175], v[20:23], v[32:35], v[172:175]
    ds_read_b64_tr_b16 v[56:57], v5 offset:10304
    v_mfma_f32_16x16x32_bf16 v[192:195], v[20:23], v[36:39], v[192:195]
    ds_read_b64_tr_b16 v[58:59], v5 offset:11584
    v_mfma_f32_16x16x32_bf16 v[212:215], v[20:23], v[40:43], v[212:215]
    ds_read_b64_tr_b16 v[60:61], v6 offset:10336
    v_mfma_f32_16x16x32_bf16 v[232:235], v[20:23], v[44:47], v[232:235]
    ds_read_b64_tr_b16 v[62:63], v6 offset:11616
    s_waitcnt lgkmcnt(14)
    v_mfma_f32_16x16x32_bf16 v[176:179], v[24:27], v[32:35], v[176:179]
    ds_read_b64_tr_b16 v[64:65], v5 offset:10368
    v_mfma_f32_16x16x32_bf16 v[196:199], v[24:27], v[36:39], v[196:199]
    ds_read_b64_tr_b16 v[66:67], v5 offset:11648
    v_add_u32 v2, s38, v2
    v_mfma_f32_16x16x32_bf16 v[216:219], v[24:27], v[40:43], v[216:219]
    v_add_u32 v5, s38, v5
    v_add_u32 v6, s38, v6
    v_mfma_f32_16x16x32_bf16 v[236:239], v[24:27], v[44:47], v[236:239]
    v_add_u32 v3, s39, v3
    v_add_u32 v4, s39, v4
    s_waitcnt lgkmcnt(14)
    v_mfma_f32_16x16x32_bf16 v[180:183], v[28:31], v[32:35], v[180:183]
    v_add_u32 v7, s39, v7
    v_mfma_f32_16x16x32_bf16 v[200:203], v[28:31], v[36:39], v[200:203]
    v_mfma_f32_16x16x32_bf16 v[220:223], v[28:31], v[40:43], v[220:223]
    v_mfma_f32_16x16x32_bf16 v[240:243], v[28:31], v[44:47], v[240:243]
    s_waitcnt lgkmcnt(11)
    v_mfma_f32_16x16x32_bf16 v[164:167], v[48:51], v[68:71], v[164:167]
    s_waitcnt lgkmcnt(0)
    s_barrier
    ds_read_b64_tr_b16 v[12:13], v5 offset:0
    v_cvt_pk_bf16_f32 v148, v151, v152
    v_mfma_f32_16x16x32_bf16 v[184:187], v[48:51], v[72:75], v[184:187]
    ds_read_b64_tr_b16 v[14:15], v5 offset:1280
    v_cvt_pk_bf16_f32 v149, v153, v154
    v_mfma_f32_16x16x32_bf16 v[204:207], v[48:51], v[76:79], v[204:207]
    ds_read_b128 v[32:35], v7 offset:0
    v_cvt_pk_bf16_f32 v150, v155, v156
    v_mfma_f32_16x16x32_bf16 v[224:227], v[48:51], v[80:83], v[224:227]
    ds_read_b128 v[36:39], v7 offset:1024
    v_cvt_pk_bf16_f32 v151, v157, v250
    v_mfma_f32_16x16x32_bf16 v[168:171], v[52:55], v[68:71], v[168:171]
    ds_read_b128 v[40:43], v7 offset:2048
    buffer_store_dwordx4 v[148:151], v9, s[64:67], s59 offen offset:1024 sc1
    v_mfma_f32_16x16x32_bf16 v[188:191], v[52:55], v[72:75], v[188:191]
    ds_read_b128 v[44:47], v7 offset:3072
    v_mfma_f32_16x16x32_bf16 v[208:211], v[52:55], v[76:79], v[208:211]
    ds_read_b64_tr_b16 v[16:17], v6 offset:32
    v_mfma_f32_16x16x32_bf16 v[228:231], v[52:55], v[80:83], v[228:231]
    ds_read_b64_tr_b16 v[18:19], v6 offset:1312
    v_mfma_f32_16x16x32_bf16 v[172:175], v[56:59], v[68:71], v[172:175]
    ds_read_b64_tr_b16 v[20:21], v5 offset:64
    v_mfma_f32_16x16x32_bf16 v[192:195], v[56:59], v[72:75], v[192:195]
    ds_read_b64_tr_b16 v[22:23], v5 offset:1344
    v_mfma_f32_16x16x32_bf16 v[212:215], v[56:59], v[76:79], v[212:215]
    ds_read_b64_tr_b16 v[24:25], v6 offset:96
    v_mfma_f32_16x16x32_bf16 v[232:235], v[56:59], v[80:83], v[232:235]
    ds_read_b64_tr_b16 v[26:27], v6 offset:1376
    v_mfma_f32_16x16x32_bf16 v[176:179], v[60:63], v[68:71], v[176:179]
    ds_read_b64_tr_b16 v[28:29], v5 offset:128
    v_mfma_f32_16x16x32_bf16 v[196:199], v[60:63], v[72:75], v[196:199]
    ds_read_b64_tr_b16 v[30:31], v5 offset:1408
    s_add_u32 s36, s36, 1
    v_mfma_f32_16x16x32_bf16 v[216:219], v[60:63], v[76:79], v[216:219]
    s_cmp_eq_u32 s36, 4
    s_cselect_b32 s38, 4294905856, s40
    v_mfma_f32_16x16x32_bf16 v[236:239], v[60:63], v[80:83], v[236:239]
    s_cselect_b32 s36, 0, s36
    s_add_u32 s37, s37, 1
    v_mfma_f32_16x16x32_bf16 v[180:183], v[64:67], v[68:71], v[180:183]
    s_cmp_eq_u32 s37, 5
    s_cselect_b32 s39, 4294901760, s41
    v_mfma_f32_16x16x32_bf16 v[200:203], v[64:67], v[72:75], v[200:203]
    s_cselect_b32 s37, 0, s37
    v_mfma_f32_16x16x32_bf16 v[220:223], v[64:67], v[76:79], v[220:223]
    v_mfma_f32_16x16x32_bf16 v[240:243], v[64:67], v[80:83], v[240:243]
    s_waitcnt lgkmcnt(11)
    v_mfma_f32_16x16x32_bf16 v[164:167], v[12:15], v[32:35], v[164:167]
    ds_read_b64_tr_b16 v[48:49], v5 offset:10240
    v_cvt_pk_bf16_f32 v152, v158, v159
    s_waitcnt lgkmcnt(11)
    v_mfma_f32_16x16x32_bf16 v[184:187], v[12:15], v[36:39], v[184:187]
    ds_read_b64_tr_b16 v[50:51], v5 offset:11520
    v_cvt_pk_bf16_f32 v153, v160, v161
    s_waitcnt lgkmcnt(11)
    v_mfma_f32_16x16x32_bf16 v[204:207], v[12:15], v[40:43], v[204:207]
    ds_read_b128 v[68:71], v7 offset:8192
    v_cvt_pk_bf16_f32 v154, v162, v163
    s_waitcnt lgkmcnt(11)
    v_mfma_f32_16x16x32_bf16 v[224:227], v[12:15], v[44:47], v[224:227]
    ds_read_b128 v[72:75], v7 offset:9216
    s_waitcnt lgkmcnt(10)
    v_mfma_f32_16x16x32_bf16 v[168:171], v[16:19], v[32:35], v[168:171]
    ds_read_b128 v[76:79], v7 offset:10240
    v_mfma_f32_16x16x32_bf16 v[188:191], v[16:19], v[36:39], v[188:191]
    ds_read_b128 v[80:83], v7 offset:11264
    v_mfma_f32_16x16x32_bf16 v[208:211], v[16:19], v[40:43], v[208:211]
    ds_read_b64_tr_b16 v[52:53], v6 offset:10272
    v_mfma_f32_16x16x32_bf16 v[228:231], v[16:19], v[44:47], v[228:231]
    ds_read_b64_tr_b16 v[54:55], v6 offset:11552
    s_waitcnt lgkmcnt(12)
    v_mfma_f32_16x16x32_bf16 v[172:175], v[20:23], v[32:35], v[172:175]
    ds_read_b64_tr_b16 v[56:57], v5 offset:10304
    v_mfma_f32_16x16x32_bf16 v[192:195], v[20:23], v[36:39], v[192:195]
    ds_read_b64_tr_b16 v[58:59], v5 offset:11584
    v_mfma_f32_16x16x32_bf16 v[212:215], v[20:23], v[40:43], v[212:215]
    ds_read_b64_tr_b16 v[60:61], v6 offset:10336
    v_mfma_f32_16x16x32_bf16 v[232:235], v[20:23], v[44:47], v[232:235]
    ds_read_b64_tr_b16 v[62:63], v6 offset:11616
    s_waitcnt lgkmcnt(14)
    v_mfma_f32_16x16x32_bf16 v[176:179], v[24:27], v[32:35], v[176:179]
    ds_read_b64_tr_b16 v[64:65], v5 offset:10368
    v_mfma_f32_16x16x32_bf16 v[196:199], v[24:27], v[36:39], v[196:199]
    ds_read_b64_tr_b16 v[66:67], v5 offset:11648
    v_add_u32 v2, s38, v2
    v_mfma_f32_16x16x32_bf16 v[216:219], v[24:27], v[40:43], v[216:219]
    v_add_u32 v5, s38, v5
    v_add_u32 v6, s38, v6
    v_mfma_f32_16x16x32_bf16 v[236:239], v[24:27], v[44:47], v[236:239]
    v_add_u32 v3, s39, v3
    v_add_u32 v4, s39, v4
    s_waitcnt lgkmcnt(14)
    v_mfma_f32_16x16x32_bf16 v[180:183], v[28:31], v[32:35], v[180:183]
    v_add_u32 v7, s39, v7
    v_mfma_f32_16x16x32_bf16 v[200:203], v[28:31], v[36:39], v[200:203]
    v_mfma_f32_16x16x32_bf16 v[220:223], v[28:31], v[40:43], v[220:223]
    v_mfma_f32_16x16x32_bf16 v[240:243], v[28:31], v[44:47], v[240:243]
    s_waitcnt lgkmcnt(11)
    v_mfma_f32_16x16x32_bf16 v[164:167], v[48:51], v[68:71], v[164:167]
    s_waitcnt lgkmcnt(0)
    s_barrier
    ds_read_b64_tr_b16 v[12:13], v5 offset:0
    v_mov_b32 v155, v248
    v_mfma_f32_16x16x32_bf16 v[184:187], v[48:51], v[72:75], v[184:187]
    ds_read_b64_tr_b16 v[14:15], v5 offset:1280
    buffer_store_dwordx4 v[152:155], v9, s[64:67], s59 offen offset:2048 sc1
    v_mfma_f32_16x16x32_bf16 v[204:207], v[48:51], v[76:79], v[204:207]
    ds_read_b128 v[32:35], v7 offset:0
    v_mfma_f32_16x16x32_bf16 v[224:227], v[48:51], v[80:83], v[224:227]
    ds_read_b128 v[36:39], v7 offset:1024
    v_mfma_f32_16x16x32_bf16 v[168:171], v[52:55], v[68:71], v[168:171]
    ds_read_b128 v[40:43], v7 offset:2048
    v_mfma_f32_16x16x32_bf16 v[188:191], v[52:55], v[72:75], v[188:191]
    ds_read_b128 v[44:47], v7 offset:3072
    v_mfma_f32_16x16x32_bf16 v[208:211], v[52:55], v[76:79], v[208:211]
    ds_read_b64_tr_b16 v[16:17], v6 offset:32
    v_mfma_f32_16x16x32_bf16 v[228:231], v[52:55], v[80:83], v[228:231]
    ds_read_b64_tr_b16 v[18:19], v6 offset:1312
    v_mfma_f32_16x16x32_bf16 v[172:175], v[56:59], v[68:71], v[172:175]
    ds_read_b64_tr_b16 v[20:21], v5 offset:64
    v_mfma_f32_16x16x32_bf16 v[192:195], v[56:59], v[72:75], v[192:195]
    ds_read_b64_tr_b16 v[22:23], v5 offset:1344
    v_mfma_f32_16x16x32_bf16 v[212:215], v[56:59], v[76:79], v[212:215]
    ds_read_b64_tr_b16 v[24:25], v6 offset:96
    v_mfma_f32_16x16x32_bf16 v[232:235], v[56:59], v[80:83], v[232:235]
    ds_read_b64_tr_b16 v[26:27], v6 offset:1376
    v_mfma_f32_16x16x32_bf16 v[176:179], v[60:63], v[68:71], v[176:179]
    ds_read_b64_tr_b16 v[28:29], v5 offset:128
    v_mfma_f32_16x16x32_bf16 v[196:199], v[60:63], v[72:75], v[196:199]
    ds_read_b64_tr_b16 v[30:31], v5 offset:1408
    s_add_u32 s36, s36, 1
    v_mfma_f32_16x16x32_bf16 v[216:219], v[60:63], v[76:79], v[216:219]
    s_cmp_eq_u32 s36, 4
    s_cselect_b32 s38, 4294905856, s40
    v_mfma_f32_16x16x32_bf16 v[236:239], v[60:63], v[80:83], v[236:239]
    s_cselect_b32 s36, 0, s36
    s_add_u32 s37, s37, 1
    v_mfma_f32_16x16x32_bf16 v[180:183], v[64:67], v[68:71], v[180:183]
    s_cmp_eq_u32 s37, 5
    s_cselect_b32 s39, 4294901760, s41
    v_mfma_f32_16x16x32_bf16 v[200:203], v[64:67], v[72:75], v[200:203]
    s_cselect_b32 s37, 0, s37
    v_mfma_f32_16x16x32_bf16 v[220:223], v[64:67], v[76:79], v[220:223]
    v_mfma_f32_16x16x32_bf16 v[240:243], v[64:67], v[80:83], v[240:243]
    s_mov_b32 s42, -6
    s_cmp_eq_u32 s31, 2
    s_cselect_b32 s42, 6, s42
    s_cmp_eq_u32 s31, 3
    s_cselect_b32 s42, 6, s42
.f_oloop:
    s_waitcnt lgkmcnt(11)
    v_mfma_f32_16x16x32_bf16 v[164:167], v[12:15], v[32:35], v[164:167]
    ds_read_b64_tr_b16 v[48:49], v5 offset:10240
    s_waitcnt lgkmcnt(11)
    v_mfma_f32_16x16x32_bf16 v[184:187], v[12:15], v[36:39], v[184:187]
    ds_read_b64_tr_b16 v[50:51], v5 offset:11520
    s_waitcnt lgkmcnt(11)
    v_mfma_f32_16x16x32_bf16 v[204:207], v[12:15], v[40:43], v[204:207]
    ds_read_b128 v[68:71], v7 offset:8192
    s_waitcnt lgkmcnt(11)
    v_mfma_f32_16x16x32_bf16 v[224:227], v[12:15], v[44:47], v[224:227]
    ds_read_b128 v[72:75], v7 offset:9216
    s_waitcnt lgkmcnt(10)
    v_mfma_f32_16x16x32_bf16 v[168:171], v[16:19], v[32:35], v[168:171]
    ds_read_b128 v[76:79], v7 offset:10240
    v_mfma_f32_16x16x32_bf16 v[188:191], v[16:19], v[36:39], v[188:191]
    ds_read_b128 v[80:83], v7 offset:11264
    v_mfma_f32_16x16x32_bf16 v[208:211], v[16:19], v[40:43], v[208:211]
    ds_read_b64_tr_b16 v[52:53], v6 offset:10272
    v_mfma_f32_16x16x32_bf16 v[228:231], v[16:19], v[44:47], v[228:231]
    ds_read_b64_tr_b16 v[54:55], v6 offset:11552
    s_waitcnt lgkmcnt(12)
    v_mfma_f32_16x16x32_bf16 v[172:175], v[20:23], v[32:35], v[172:175]
    ds_read_b64_tr_b16 v[56:57], v5 offset:10304
    v_mfma_f32_16x16x32_bf16 v[192:195], v[20:23], v[36:39], v[192:195]
    ds_read_b64_tr_b16 v[58:59], v5 offset:11584
    v_mfma_f32_16x16x32_bf16 v[212:215], v[20:23], v[40:43], v[212:215]
    ds_read_b64_tr_b16 v[60:61], v6 offset:10336
    v_mfma_f32_16x16x32_bf16 v[232:235], v[20:23], v[44:47], v[232:235]
    ds_read_b64_tr_b16 v[62:63], v6 offset:11616
    s_waitcnt lgkmcnt(14)
    v_mfma_f32_16x16x32_bf16 v[176:179], v[24:27], v[32:35], v[176:179]
    ds_read_b64_tr_b16 v[64:65], v5 offset:10368
    v_mfma_f32_16x16x32_bf16 v[196:199], v[24:27], v[36:39], v[196:199]
    ds_read_b64_tr_b16 v[66:67], v5 offset:11648
    v_mfma_f32_16x16x32_bf16 v[216:219], v[24:27], v[40:43], v[216:219]
    v_add_u32 v2, s38, v2
    v_add_u32 v5, s38, v5
    v_mfma_f32_16x16x32_bf16 v[236:239], v[24:27], v[44:47], v[236:239]
    v_add_u32 v6, s38, v6
    v_add_u32 v3, s39, v3
    s_waitcnt lgkmcnt(14)
    v_mfma_f32_16x16x32_bf16 v[180:183], v[28:31], v[32:35], v[180:183]
    v_add_u32 v4, s39, v4
    v_add_u32 v7, s39, v7
    v_mfma_f32_16x16x32_bf16 v[200:203], v[28:31], v[36:39], v[200:203]
    v_mfma_f32_16x16x32_bf16 v[220:223], v[28:31], v[40:43], v[220:223]
    v_mfma_f32_16x16x32_bf16 v[240:243], v[28:31], v[44:47], v[240:243]
    s_waitcnt lgkmcnt(11)
    v_mfma_f32_16x16x32_bf16 v[164:167], v[48:51], v[68:71], v[164:167]
    s_waitcnt lgkmcnt(0)
    s_barrier
    ds_read_b64_tr_b16 v[12:13], v5 offset:0
    v_mfma_f32_16x16x32_bf16 v[184:187], v[48:51], v[72:75], v[184:187]
    ds_read_b64_tr_b16 v[14:15], v5 offset:1280
    v_mfma_f32_16x16x32_bf16 v[204:207], v[48:51], v[76:79], v[204:207]
    ds_read_b128 v[32:35], v7 offset:0
    v_mfma_f32_16x16x32_bf16 v[224:227], v[48:51], v[80:83], v[224:227]
    ds_read_b128 v[36:39], v7 offset:1024
    v_mfma_f32_16x16x32_bf16 v[168:171], v[52:55], v[68:71], v[168:171]
    ds_read_b128 v[40:43], v7 offset:2048
    v_mfma_f32_16x16x32_bf16 v[188:191], v[52:55], v[72:75], v[188:191]
    ds_read_b128 v[44:47], v7 offset:3072
    v_mfma_f32_16x16x32_bf16 v[208:211], v[52:55], v[76:79], v[208:211]
    ds_read_b64_tr_b16 v[16:17], v6 offset:32
    v_mfma_f32_16x16x32_bf16 v[228:231], v[52:55], v[80:83], v[228:231]
    ds_read_b64_tr_b16 v[18:19], v6 offset:1312
    v_mfma_f32_16x16x32_bf16 v[172:175], v[56:59], v[68:71], v[172:175]
    ds_read_b64_tr_b16 v[20:21], v5 offset:64
    v_mfma_f32_16x16x32_bf16 v[192:195], v[56:59], v[72:75], v[192:195]
    ds_read_b64_tr_b16 v[22:23], v5 offset:1344
    v_mfma_f32_16x16x32_bf16 v[212:215], v[56:59], v[76:79], v[212:215]
    ds_read_b64_tr_b16 v[24:25], v6 offset:96
    v_mfma_f32_16x16x32_bf16 v[232:235], v[56:59], v[80:83], v[232:235]
    ds_read_b64_tr_b16 v[26:27], v6 offset:1376
    v_mfma_f32_16x16x32_bf16 v[176:179], v[60:63], v[68:71], v[176:179]
    ds_read_b64_tr_b16 v[28:29], v5 offset:128
    v_mfma_f32_16x16x32_bf16 v[196:199], v[60:63], v[72:75], v[196:199]
    ds_read_b64_tr_b16 v[30:31], v5 offset:1408
    v_mfma_f32_16x16x32_bf16 v[216:219], v[60:63], v[76:79], v[216:219]
    s_add_u32 s36, s36, 1
    s_cmp_eq_u32 s36, 4
    v_mfma_f32_16x16x32_bf16 v[236:239], v[60:63], v[80:83], v[236:239]
    s_cselect_b32 s38, 4294905856, s40
    s_cselect_b32 s36, 0, s36
    v_mfma_f32_16x16x32_bf16 v[180:183], v[64:67], v[68:71], v[180:183]
    s_add_u32 s37, s37, 1
    s_cmp_eq_u32 s37, 5
    v_mfma_f32_16x16x32_bf16 v[200:203], v[64:67], v[72:75], v[200:203]
    s_cselect_b32 s39, 4294901760, s41
    s_cselect_b32 s37, 0, s37
    v_mfma_f32_16x16x32_bf16 v[220:223], v[64:67], v[76:79], v[220:223]
    s_sub_u32 s42, s42, 1
    s_cmp_lg_u32 s42, 0
    v_mfma_f32_16x16x32_bf16 v[240:243], v[64:67], v[80:83], v[240:243]
    s_cbranch_scc1 .f_oloop
    s_waitcnt lgkmcnt(10)
    v_mfma_f32_16x16x32_bf16 v[184:187], v[12:15], v[36:39], v[184:187]
    ds_read_b64_tr_b16 v[48:49], v5 offset:10240
    ds_read_b64_tr_b16 v[50:51], v5 offset:11520
    s_xor_b32 s57, s31, 1
    s_mul_i32 s57, s57, 81920
    s_add_u32 s57, s57, 8192
    s_waitcnt lgkmcnt(8)
    v_mfma_f32_16x16x32_bf16 v[188:191], v[16:19], v[36:39], v[188:191]
    ds_read_b128 v[72:75], v7 offset:9216
    ds_read_b64_tr_b16 v[52:53], v6 offset:10272
    s_xor_b32 s58, s31, 2
    s_mul_i32 s58, s58, 81920
    s_add_u32 s58, s58, 12288
    s_waitcnt lgkmcnt(8)
    v_mfma_f32_16x16x32_bf16 v[192:195], v[20:23], v[36:39], v[192:195]
    ds_read_b64_tr_b16 v[54:55], v6 offset:11552
    ds_read_b64_tr_b16 v[56:57], v5 offset:10304
    s_xor_b32 s59, s31, 3
    s_mul_i32 s59, s59, 81920
    s_add_u32 s59, s59, 16384
    s_waitcnt lgkmcnt(8)
    v_mfma_f32_16x16x32_bf16 v[196:199], v[24:27], v[36:39], v[196:199]
    ds_read_b64_tr_b16 v[58:59], v5 offset:11584
    ds_read_b64_tr_b16 v[60:61], v6 offset:10336
    s_waitcnt lgkmcnt(8)
    v_mfma_f32_16x16x32_bf16 v[200:203], v[28:31], v[36:39], v[200:203]
    ds_read_b64_tr_b16 v[62:63], v6 offset:11616
    ds_read_b64_tr_b16 v[64:65], v5 offset:10368
    v_mfma_f32_16x16x32_bf16 v[204:207], v[12:15], v[40:43], v[204:207]
    ds_read_b64_tr_b16 v[66:67], v5 offset:11648
    ds_read_b128 v[76:79], v7 offset:10240
    ds_write_b128 v8, v[84:87] offset:0
    ds_write_b128 v8, v[88:91] offset:1024
    ds_write_b128 v8, v[92:95] offset:2048
    v_mfma_f32_16x16x32_bf16 v[208:211], v[16:19], v[40:43], v[208:211]
    ds_read_b128 v[80:83], v7 offset:11264
    ds_read_b128 v[68:71], v7 offset:8192
    ds_write_b128 v8, v[96:99] offset:3072
    ds_write_b128 v8, v[100:103] offset:4096
    v_mfma_f32_16x16x32_bf16 v[212:215], v[20:23], v[40:43], v[212:215]
    v_mfma_f32_16x16x32_bf16 v[216:219], v[24:27], v[40:43], v[216:219]
    v_mfma_f32_16x16x32_bf16 v[220:223], v[28:31], v[40:43], v[220:223]
    s_waitcnt lgkmcnt(15)
    v_mfma_f32_16x16x32_bf16 v[184:187], v[48:51], v[72:75], v[184:187]
    s_waitcnt lgkmcnt(14)
    v_mfma_f32_16x16x32_bf16 v[188:191], v[52:55], v[72:75], v[188:191]
    s_waitcnt lgkmcnt(12)
    v_mfma_f32_16x16x32_bf16 v[192:195], v[56:59], v[72:75], v[192:195]
    s_waitcnt lgkmcnt(10)
    v_mfma_f32_16x16x32_bf16 v[196:199], v[60:63], v[72:75], v[196:199]
    s_waitcnt lgkmcnt(8)
    v_mfma_f32_16x16x32_bf16 v[200:203], v[64:67], v[72:75], v[200:203]
    s_waitcnt lgkmcnt(7)
    v_mfma_f32_16x16x32_bf16 v[204:207], v[48:51], v[76:79], v[204:207]
    buffer_store_dword v248, v10, s[64:67], s57 offen offset:3072 sc1
    v_cvt_pk_bf16_f32 v184, v184, v185
    v_cvt_pk_bf16_f32 v185, v186, v187
    v_mfma_f32_16x16x32_bf16 v[208:211], v[52:55], v[76:79], v[208:211]
    v_cvt_pk_bf16_f32 v186, v188, v189
    v_cvt_pk_bf16_f32 v187, v190, v249
    buffer_store_dwordx4 v[184:187], v9, s[64:67], s57 offen offset:0 sc1
    v_mfma_f32_16x16x32_bf16 v[212:215], v[56:59], v[76:79], v[212:215]
    v_cvt_pk_bf16_f32 v188, v191, v192
    v_cvt_pk_bf16_f32 v189, v193, v194
    v_cvt_pk_bf16_f32 v190, v195, v196
    v_mfma_f32_16x16x32_bf16 v[216:219], v[60:63], v[76:79], v[216:219]
    v_cvt_pk_bf16_f32 v191, v197, v250
    buffer_store_dwordx4 v[188:191], v9, s[64:67], s57 offen offset:1024 sc1
    v_cvt_pk_bf16_f32 v192, v198, v199
    v_mfma_f32_16x16x32_bf16 v[220:223], v[64:67], v[76:79], v[220:223]
    v_cvt_pk_bf16_f32 v193, v200, v201
    v_cvt_pk_bf16_f32 v194, v202, v203
    v_mov_b32 v195, v248
    v_mfma_f32_16x16x32_bf16 v[224:227], v[12:15], v[44:47], v[224:227]
    buffer_store_dwordx4 v[192:195], v9, s[64:67], s57 offen offset:2048 sc1
    buffer_store_dword v248, v10, s[64:67], s58 offen offset:3072 sc1
    v_cvt_pk_bf16_f32 v204, v204, v205
    v_mfma_f32_16x16x32_bf16 v[228:231], v[16:19], v[44:47], v[228:231]
    v_cvt_pk_bf16_f32 v205, v206, v207
    v_cvt_pk_bf16_f32 v206, v208, v209
    v_cvt_pk_bf16_f32 v207, v210, v249
    v_mfma_f32_16x16x32_bf16 v[232:235], v[20:23], v[44:47], v[232:235]
    buffer_store_dwordx4 v[204:207], v9, s[64:67], s58 offen offset:0 sc1
    v_cvt_pk_bf16_f32 v208, v211, v212
    v_cvt_pk_bf16_f32 v209, v213, v214
    v_mfma_f32_16x16x32_bf16 v[236:239], v[24:27], v[44:47], v[236:239]
    v_cvt_pk_bf16_f32 v210, v215, v216
    v_cvt_pk_bf16_f32 v211, v217, v250
    buffer_store_dwordx4 v[208:211], v9, s[64:67], s58 offen offset:1024 sc1
    v_mfma_f32_16x16x32_bf16 v[240:243], v[28:31], v[44:47], v[240:243]
    v_cvt_pk_bf16_f32 v212, v218, v219
    v_cvt_pk_bf16_f32 v213, v220, v221
    v_cvt_pk_bf16_f32 v214, v222, v223
    s_waitcnt lgkmcnt(3)
    v_mfma_f32_16x16x32_bf16 v[224:227], v[48:51], v[80:83], v[224:227]
    v_mov_b32 v215, v248
    buffer_store_dwordx4 v[212:215], v9, s[64:67], s58 offen offset:2048 sc1
    v_mfma_f32_16x16x32_bf16 v[228:231], v[52:55], v[80:83], v[228:231]
    v_mfma_f32_16x16x32_bf16 v[232:235], v[56:59], v[80:83], v[232:235]
    v_mfma_f32_16x16x32_bf16 v[236:239], v[60:63], v[80:83], v[236:239]
    v_mfma_f32_16x16x32_bf16 v[240:243], v[64:67], v[80:83], v[240:243]
    v_mfma_f32_16x16x32_bf16 v[164:167], v[12:15], v[32:35], v[164:167]
    buffer_store_dword v248, v10, s[64:67], s59 offen offset:3072 sc1
    v_cvt_pk_bf16_f32 v224, v224, v225
    v_cvt_pk_bf16_f32 v225, v226, v227
    v_mfma_f32_16x16x32_bf16 v[168:171], v[16:19], v[32:35], v[168:171]
    v_cvt_pk_bf16_f32 v226, v228, v229
    v_cvt_pk_bf16_f32 v227, v230, v249
    buffer_store_dwordx4 v[224:227], v9, s[64:67], s59 offen offset:0 sc1
    v_mfma_f32_16x16x32_bf16 v[172:175], v[20:23], v[32:35], v[172:175]
    v_cvt_pk_bf16_f32 v228, v231, v232
    v_cvt_pk_bf16_f32 v229, v233, v234
    v_cvt_pk_bf16_f32 v230, v235, v236
    v_mfma_f32_16x16x32_bf16 v[176:179], v[24:27], v[32:35], v[176:179]
    v_cvt_pk_bf16_f32 v231, v237, v250
    buffer_store_dwordx4 v[228:231], v9, s[64:67], s59 offen offset:1024 sc1
    v_cvt_pk_bf16_f32 v232, v238, v239
    v_mfma_f32_16x16x32_bf16 v[180:183], v[28:31], v[32:35], v[180:183]
    v_cvt_pk_bf16_f32 v233, v240, v241
    v_cvt_pk_bf16_f32 v234, v242, v243
    v_mov_b32 v235, v248
    s_waitcnt lgkmcnt(2)
    v_mfma_f32_16x16x32_bf16 v[164:167], v[48:51], v[68:71], v[164:167]
    buffer_store_dwordx4 v[232:235], v9, s[64:67], s59 offen offset:2048 sc1
    v_mfma_f32_16x16x32_bf16 v[168:171], v[52:55], v[68:71], v[168:171]
    v_mfma_f32_16x16x32_bf16 v[172:175], v[56:59], v[68:71], v[172:175]
    v_mfma_f32_16x16x32_bf16 v[176:179], v[60:63], v[68:71], v[176:179]
    v_mfma_f32_16x16x32_bf16 v[180:183], v[64:67], v[68:71], v[180:183]
    s_nop 7
    ds_write_b128 v11, v[164:167] offset:0
    ds_write_b128 v11, v[168:171] offset:1024
    ds_write_b128 v11, v[172:175] offset:2048
    ds_write_b128 v11, v[176:179] offset:3072
    ds_write_b128 v11, v[180:183] offset:4096
    ds_write_b32 v251, v248
.f_done:
    s_endpgm
.section .rodata,"a"
.p2align 6
.amdhsa_kernel recurrent_scan__spectral_fnet__glu_gated_geglu__prompt_kernel
  .amdhsa_next_free_vgpr 256
  .amdhsa_next_free_sgpr 102
  .amdhsa_accum_offset 256
  .amdhsa_group_segment_fixed_size 0
  .amdhsa_kernarg_size 96
  .amdhsa_user_sgpr_count 2
  .amdhsa_user_sgpr_kernarg_segment_ptr 1
  .amdhsa_system_sgpr_workgroup_id_x 1
  .amdhsa_float_denorm_mode_32 3
.end_amdhsa_kernel
```
